```python
import torch

def _softmax(x, axis=-1):
    return torch.softmax(x, dim=axis)
def _gelu(x):
    return torch.nn.functional.gelu(x, approximate="tanh")
def _silu(x):
    return torch.nn.functional.silu(x)
def _sigmoid(x):
    return torch.sigmoid(x)
def _layernorm(x, axis=-1, eps=1e-5):
    m = x.mean(dim=axis, keepdim=True)
    v = x.var(dim=axis, keepdim=True, unbiased=False)
    return (x - m) / torch.sqrt(v + eps)
def _scatter_add(tgt, idx, src, axis=0):
    return tgt.clone().index_add_(axis, idx, src)
def _segment_sum(src, seg, n):
    out = torch.zeros((n,) + src.shape[1:], dtype=src.dtype)
    return out.index_add_(0, seg, src)
def _pad(x, pw):
    flat = tuple(v for pair in reversed(pw) for v in pair)
    return torch.nn.functional.pad(x, flat)

kernel_name = 'interleave_layers__sliding_local_dilated__glu_gated_swiglu__prompt'

def setup_inputs():

    _w = (lambda a: (lambda t: t.to(torch.bfloat16) if t.is_floating_point() else t)(torch.as_tensor(a)))
    def _A_setup():
        B, S, D = 1, 2048, 448
        return {
            "x": _w((lambda *s: torch.randn(*s, dtype=torch.bfloat16) * 0.05)(B, S, D)),
            "wqkv": _w((lambda *s: torch.randn(*s, dtype=torch.bfloat16) * 0.05)(D, 3 * D)),
            "wo": _w((lambda *s: torch.randn(*s, dtype=torch.bfloat16) * 0.05)(D, D)),
        }
    _A_in = _A_setup()

    def _B_setup():
        B, S, D, F = 1, 2048, 448, 1792
        return {
            "x": _w((lambda *s: torch.randn(*s, dtype=torch.bfloat16) * 0.05)(B, S, D)),
            "w1": _w((lambda *s: torch.randn(*s, dtype=torch.bfloat16) * 0.8)(D, F) * (2.0 / D) ** 0.5),
            "w3": _w((lambda *s: torch.randn(*s, dtype=torch.bfloat16) * 0.8)(D, F) * (2.0 / D) ** 0.5),
            "w2": _w((lambda *s: torch.randn(*s, dtype=torch.bfloat16) * 0.8)(F, D) * (2.0 / F) ** 0.5),
        }
    _B_in = _B_setup()

    return {
        "A_x": _A_in["x"],
        "A_wqkv": _A_in["wqkv"],
        "A_wo": _A_in["wo"],
        "B_x": _B_in["x"],
        "B_w1": _B_in["w1"],
        "B_w3": _B_in["w3"],
        "B_w2": _B_in["w2"],
    }

def reference(A_x, A_wqkv, A_wo, B_x, B_w1, B_w3, B_w2):
    def _A_ref(x, wqkv, wo):
        B, S, D = x.shape
        H = 16; Dh = D // H
        W, dil = 8, 2
        qkv = (lambda x, *d: x.permute(*d))((x @ wqkv).reshape(B, S, 3, H, Dh), 2, 0, 3, 1, 4)
        q, k, v = qkv[0], qkv[1], qkv[2]
        scale = Dh ** -0.5
        pos = torch.arange(S)
        off = torch.arange(W) * dil
        idx = pos[:, None] - off[None, :]
        mask = idx >= 0
        idx_c = torch.where(mask, idx, 0).reshape(-1)
        kg = k[:, :, idx_c, :].reshape(B, H, S, W, Dh)
        vg = v[:, :, idx_c, :].reshape(B, H, S, W, Dh)
        logits = torch.einsum("bhsd,bhswd->bhsw", q, kg) * scale
        logits = torch.where(mask[None, None, :, :], logits, -1e9)
        attn = _softmax(logits, axis=-1)
        o = torch.einsum("bhsw,bhswd->bhsd", attn, vg)
        return (lambda x, *d: x.permute(*d))(o, 0, 2, 1, 3).reshape(B, S, D) @ wo

    def _B_ref(x, w1, w3, w2):
        gate = torch.einsum("bsd,df->bsf", x, w1)
        up = torch.einsum("bsd,df->bsf", x, w3)
        h = _silu(gate) * up
        out = torch.einsum("bsf,fd->bsd", h, w2)
        return out

    x = A_x
    x = x + _A_ref(_layernorm(x, axis=-1), A_wqkv, A_wo)
    x = x + _B_ref(_layernorm(x, axis=-1), B_w1, B_w3, B_w2)
    x = x + _A_ref(_layernorm(x, axis=-1), A_wqkv, A_wo)
    x = x + _B_ref(_layernorm(x, axis=-1), B_w1, B_w3, B_w2)
    return x
```

```asm
; @launch grid=(256,1,1) block=(256,1,1) lds=163840
.amdgcn_target "amdgcn-amd-amdhsa--gfx950"
.text
.globl interleave_layers__sliding_local_dilated__glu_gated_swiglu__prompt_kernel
.p2align 8
.type interleave_layers__sliding_local_dilated__glu_gated_swiglu__prompt_kernel,@function
.set CODE_NL, 15
interleave_layers__sliding_local_dilated__glu_gated_swiglu__prompt_kernel:
s_cmp_ge_u32 s2, 256
s_cbranch_scc1 Lend
s_load_dwordx16 s[4:19], s[0:1], 0
s_load_dwordx4 s[20:23], s[0:1], 64
s_getpc_b64 s[36:37]
Lpc:
s_lshr_b32 s54, s2, 3
v_and_b32 v1, 63, v0
v_lshrrev_b32 v26, 6, v0
s_mul_i32 s55, s54, CODE_NL
v_min_u32 v27, CODE_NL-1, v1
v_add_u32 v27, s55, v27
v_lshlrev_b32 v27, 7, v27
v_min_u32 v27, Lcode_end-Lpc-4, v27
v_readfirstlane_b32 s46, v26
global_load_dword v16, v27, s[36:37]
s_and_b32 s55, s2, 7
s_lshr_b32 s44, s54, 4
s_lshl1_add_u32 s44, s55, s44
s_and_b32 s45, s54, 15
s_mov_b32 s70, 0x2a3c5e70
s_mov_b32 s71, 0xdbf81964
s_lshl_b32 s55, s45, 2
s_lshr_b64 s[70:71], s[70:71], s55
s_and_b32 s101, s70, 15
s_cmp_ge_u32 s45, 7
s_cselect_b32 s48, 1, 0
s_cselect_b32 s55, 7, 0
s_sub_u32 s47, s45, s55
s_cmp_ge_u32 s45, 14
s_cselect_b32 s53, 1, 0
s_cselect_b32 s55, 7, 0
s_sub_u32 s47, s47, s55
v_lshlrev_b32 v2, 4, v1
v_and_b32 v6, 15, v1
v_lshrrev_b32 v7, 4, v1
v_lshrrev_b32 v28, 3, v1
v_and_b32 v29, 7, v1
v_lshlrev_b32 v29, 4, v29
s_waitcnt lgkmcnt(0)
s_mov_b32 s24, s22
s_mov_b32 s25, s23
s_mov_b32 s26, 0x2400000
s_mov_b32 s27, 0x20000
s_mov_b32 s28, s4
s_mov_b32 s29, s5
s_mov_b32 s30, 0x1c0000
s_mov_b32 s31, 0x20000
s_mov_b32 s32, s18
s_mov_b32 s33, s19
s_mov_b32 s34, 0x1c0000
s_mov_b32 s35, 0x20000
s_mov_b32 s36, s6
s_mov_b32 s37, s7
s_mov_b32 s38, 1204224
s_mov_b32 s39, 0x20000
s_lshl2_add_u32 s54, s45, s46
s_lshl_b32 s54, s54, 11
s_mul_i32 s55, s44, 114688
s_add_u32 s54, s54, s55
s_sub_u32 s55, s54, 14336
s_cselect_b32 s54, s54, s55
v_lshlrev_b32_e64 v30, 7, v6
s_mov_b64 exec, 0xffff
buffer_load_dword v16, v30, s[28:31], s54 offen
s_mov_b64 exec, -1
s_lshl_b32 s54, s44, 7
s_lshl_b32 s55, s46, 5
s_add_u32 s55, s55, s54
s_mul_i32 s95, s55, 896
s_mul_i32 s96, s46, 28672
v_and_b32 v25, 7, v1
v_xor_b32 v25, v25, v28
v_lshlrev_b32 v25, 4, v25
s_movk_i32 s56, 896
v_mad_u32_u24 v25, v28, s56, v25
s_mov_b32 s40, s14
s_mov_b32 s41, s15
s_mov_b32 s42, 1605632
s_mov_b32 s43, 0x20000
s_mov_b32 s88, s12
s_mov_b32 s89, s13
s_mov_b32 s90, 1605632
s_mov_b32 s91, 0x20000
s_mov_b32 s12, s16
s_mov_b32 s13, s17
s_mov_b32 s14, 1605632
s_mov_b32 s15, 0x20000
s_mov_b32 s16, s8
s_mov_b32 s17, s9
s_mov_b32 s18, 401408
s_mov_b32 s19, 0x20000
s_lshl2_add_u32 s54, s2, s46
v_lshlrev_b32 v30, 7, v1
s_mul_i32 s55, s54, 1280
s_mov_b64 exec, 0x3ff
buffer_load_dword v16, v30, s[36:39], s55 offen
s_mov_b64 exec, -1
s_lshl_b32 s54, s44, 7
s_lshl_b32 s55, s47, 7
s_add_u32 s55, s55, 4096
s_add_u32 s56, s54, 128
s_load_dword s49, s[22:23], s54
s_load_dword s50, s[22:23], s56
s_load_dword s51, s[22:23], s55
s_lshr_b32 s54, s46, 1
s_mul_i32 s55, s54, 192
s_mul_i32 s56, s101, 56
s_movk_i32 s57, 2688
s_movk_i32 s58, 896
v_add_u32 v26, s55, v1
v_mul_u32_u24 v27, 5462, v26
v_lshrrev_b32 v27, 16, v27
v_mul_u32_u24 v28, 12, v27
v_sub_u32 v26, v26, v28
v_lshrrev_b32 v28, 2, v27
v_lshrrev_b32 v29, 3, v27
v_xor_b32 v28, v28, v29
v_and_b32 v28, 1, v28
v_lshlrev_b32 v28, 1, v28
v_xor_b32 v26, v26, v28
v_lshrrev_b32 v28, 2, v26
v_and_b32_e64 v26, 3, v26
v_lshl_add_u32 v26, v26, 4, s56
v_mad_u32_u24 v26, v28, s58, v26
v_mad_u32_u24 v244, v27, s57, v26
v_add_u32 v26, s55, v1
v_add_u32 v26, 64, v26
v_mul_u32_u24 v27, 5462, v26
v_lshrrev_b32 v27, 16, v27
v_mul_u32_u24 v28, 12, v27
v_sub_u32 v26, v26, v28
v_lshrrev_b32 v28, 2, v27
v_lshrrev_b32 v29, 3, v27
v_xor_b32 v28, v28, v29
v_and_b32 v28, 1, v28
v_lshlrev_b32 v28, 1, v28
v_xor_b32 v26, v26, v28
v_lshrrev_b32 v28, 2, v26
v_and_b32_e64 v26, 3, v26
v_lshl_add_u32 v26, v26, 4, s56
v_mad_u32_u24 v26, v28, s58, v26
v_mad_u32_u24 v245, v27, s57, v26
v_subrev_u32 v245, 1024, v245
v_add_u32_e64 v26, s55, v1
v_add_u32 v26, 128, v26
v_mul_u32_u24 v27, 5462, v26
v_lshrrev_b32 v27, 16, v27
v_mul_u32_u24 v28, 12, v27
v_sub_u32 v26, v26, v28
v_lshrrev_b32 v28, 2, v27
v_lshrrev_b32 v29, 3, v27
v_xor_b32 v28, v28, v29
v_and_b32 v28, 1, v28
v_lshlrev_b32 v28, 1, v28
v_xor_b32 v26, v26, v28
v_lshrrev_b32 v28, 2, v26
v_and_b32_e64 v26, 3, v26
v_lshl_add_u32 v26, v26, 4, s56
v_mad_u32_u24 v26, v28, s58, v26
v_mad_u32_u24 v246, v27, s57, v26
v_subrev_u32 v246, 2048, v246
s_and_b32 s55, s46, 1
s_mul_i32 s6, s55, 86016
s_mul_i32 s8, s55, 6144
s_mul_i32 s54, s54, 3072
s_add_u32 s8, s8, s54
v_add_u32 v3, 0x10000, v2
v_add_u32 v4, 0x20000, v2
v_mov_b32 v5, 0xff800000
v_mov_b32_e64 v17, 0
v_mov_b32 v20, 0x3f803f80
v_mov_b32 v21, 0x3f803f80
v_mov_b32 v22, 0x3f803f80
v_mov_b32 v23, 0x3f803f80
s_mov_b32 s100, 0x3b124925
s_lshl_b32 s60, s44, 17
s_lshl_b32 s61, s44, 19
s_mov_b32 s62, 60000
s_mov_b32 s20, 0
s_mov_b32 s21, 0xffff0000
v_lshl_add_u32 v26, v7, 2, 0
v_sub_u32 v27, v6, v26
v_and_b32 v28, 1, v27
v_cmp_eq_u32 vcc, 0, v28
v_cmp_le_i32_e64 s[64:65], 0, v27
v_cmp_ge_i32_e64 s[72:73], -2, v27
s_and_b64 s[64:65], s[64:65], vcc
s_and_b64 s[72:73], s[72:73], vcc
v_lshl_add_u32 v26, v7, 2, 1
v_sub_u32 v27, v6, v26
v_and_b32 v28, 1, v27
v_cmp_eq_u32_e64 vcc, 0, v28
v_cmp_le_i32_e64 s[66:67], 0, v27
v_cmp_ge_i32_e64 s[74:75], -2, v27
s_and_b64 s[66:67], s[66:67], vcc
s_and_b64 s[74:75], s[74:75], vcc
v_lshl_add_u32 v26, v7, 2, 2
v_sub_u32 v27, v6, v26
v_and_b32 v28, 1, v27
v_cmp_eq_u32_e64 vcc, 0, v28
v_cmp_le_i32_e64 s[68:69], 0, v27
v_cmp_ge_i32_e64 s[76:77], -2, v27
s_and_b64 s[68:69], s[68:69], vcc
s_and_b64 s[76:77], s[76:77], vcc
v_lshl_add_u32 v26, v7, 2, 3
v_sub_u32 v27, v6, v26
v_and_b32 v28, 1, v27
v_cmp_eq_u32 vcc, 0, v28
v_cmp_le_i32_e64 s[70:71], 0, v27
v_cmp_ge_i32_e64 s[78:79], -2, v27
s_and_b64 s[70:71], s[70:71], vcc
s_and_b64 s[78:79], s[78:79], vcc
s_or_b32 s54, s44, s46
s_cmp_eq_u32 s54, 0
s_cselect_b64 s[80:81], 0, s[72:73]
s_cselect_b64 s[82:83], 0, s[74:75]
s_cselect_b64 s[84:85], 0, s[76:77]
s_cselect_b64 s[86:87], 0, s[78:79]
s_waitcnt lgkmcnt(0)
s_mul_i32 s49, s49, 0x9e3779b1
s_add_u32 s49, s49, 0x7f4a7c15
s_mul_i32 s50, s50, 0x9e3779b1
s_add_u32 s50, s50, 0x7f4a7c15
s_mul_i32 s51, s51, 0x9e3779b1
s_add_u32 s51, s51, 0x7f4a7c15
s_getreg_b32 s63, hwreg(HW_REG_XCC_ID)
s_and_b32 s63, s63, 15
s_andn2_b32 s54, s49, 15
s_or_b32 s63, s63, s54
s_mov_b32 s52, 2
s_cmp_lg_u32 s46, 3
s_cbranch_scc1 L1
s_lshl_b32 s54, s44, 11
s_lshl_b32 s55, s45, 7
s_add_u32 s54, s54, s55
s_add_u32 s54, s54, 8192
v_mov_b32 v18, s63
s_mov_b64 exec, 1
buffer_store_dword v18, off, s[24:27], s54 sc1
s_mov_b64 exec, -1
L1:
v_and_b32 v80, 7, v1
v_bfe_u32 v81, v1, 3, 1
v_xor_b32 v82, v7, v80
v_lshlrev_b32 v82, 4, v82
v_lshl_add_u32 v82, v80, 7, v82
s_movk_i32 s56, 7168
v_mad_u32_u24 v82, v81, s56, v82
v_add_u32 v82, s96, v82
v_xor_b32_e64 v83, 64, v82
s_add_u32 m0, s96, 0
s_nop 0
buffer_load_dwordx4 v25, s[28:31], s95 offen offset:0 lds
s_add_u32 m0, s96, 896
s_nop 0
buffer_load_dwordx4 v25, s[28:31], s95 offen offset:128 lds
s_add_u32 m0, s96, 1792
s_nop 0
buffer_load_dwordx4 v25, s[28:31], s95 offen offset:256 lds
s_add_u32 m0, s96, 2688
s_nop 0
buffer_load_dwordx4 v25, s[28:31], s95 offen offset:384 lds
s_add_u32 m0, s96, 3584
s_nop 0
buffer_load_dwordx4 v25, s[28:31], s95 offen offset:512 lds
s_add_u32 m0, s96, 4480
s_nop 0
buffer_load_dwordx4 v25, s[28:31], s95 offen offset:640 lds
s_add_u32 m0, s96, 5376
s_nop 0
buffer_load_dwordx4 v25, s[28:31], s95 offen offset:768 lds
s_add_u32 s95, s95, 7168
s_add_u32 m0, s96, 7168
s_nop 0
buffer_load_dwordx4 v25, s[28:31], s95 offen offset:0 lds
s_add_u32 m0, s96, 8064
s_nop 0
buffer_load_dwordx4 v25, s[28:31], s95 offen offset:128 lds
s_add_u32 m0, s96, 8960
s_nop 0
buffer_load_dwordx4 v25, s[28:31], s95 offen offset:256 lds
s_add_u32 m0, s96, 9856
s_nop 0
buffer_load_dwordx4 v25, s[28:31], s95 offen offset:384 lds
s_add_u32 m0, s96, 10752
s_nop 0
buffer_load_dwordx4 v25, s[28:31], s95 offen offset:512 lds
s_add_u32 m0, s96, 11648
s_nop 0
buffer_load_dwordx4 v25, s[28:31], s95 offen offset:640 lds
s_add_u32 m0, s96, 12544
s_nop 0
buffer_load_dwordx4 v25, s[28:31], s95 offen offset:768 lds
s_add_u32 s95, s95, 7168
s_add_u32 m0, s96, 14336
s_nop 0
buffer_load_dwordx4 v25, s[28:31], s95 offen offset:0 lds
s_add_u32 m0, s96, 15232
s_nop 0
buffer_load_dwordx4 v25, s[28:31], s95 offen offset:128 lds
s_add_u32 m0, s96, 16128
s_nop 0
buffer_load_dwordx4 v25, s[28:31], s95 offen offset:256 lds
s_add_u32 m0, s96, 17024
s_nop 0
buffer_load_dwordx4 v25, s[28:31], s95 offen offset:384 lds
s_add_u32 m0, s96, 17920
s_nop 0
buffer_load_dwordx4 v25, s[28:31], s95 offen offset:512 lds
s_add_u32 m0, s96, 18816
s_nop 0
buffer_load_dwordx4 v25, s[28:31], s95 offen offset:640 lds
s_add_u32 m0, s96, 19712
s_nop 0
buffer_load_dwordx4 v25, s[28:31], s95 offen offset:768 lds
s_add_u32 s95, s95, 7168
s_add_u32 m0, s96, 21504
s_nop 0
buffer_load_dwordx4 v25, s[28:31], s95 offen offset:0 lds
s_add_u32 m0, s96, 22400
s_nop 0
buffer_load_dwordx4 v25, s[28:31], s95 offen offset:128 lds
s_add_u32 m0, s96, 23296
s_nop 0
buffer_load_dwordx4 v25, s[28:31], s95 offen offset:256 lds
s_add_u32 m0, s96, 24192
s_nop 0
buffer_load_dwordx4 v25, s[28:31], s95 offen offset:384 lds
s_add_u32 m0, s96, 25088
s_nop 0
buffer_load_dwordx4 v25, s[28:31], s95 offen offset:512 lds
s_add_u32 m0, s96, 25984
s_nop 0
buffer_load_dwordx4 v25, s[28:31], s95 offen offset:640 lds
s_add_u32 m0, s96, 26880
s_nop 0
buffer_load_dwordx4 v25, s[28:31], s95 offen offset:768 lds
s_add_u32 m0, s8, 114688
s_add_u32 s11, s6, 0
buffer_load_dwordx4 v244, s[36:39], s11 offen offset:0 lds
buffer_load_dwordx4 v245, s[36:39], s11 offen offset:1024 lds
buffer_load_dwordx4 v246, s[36:39], s11 offen offset:2048 lds
s_waitcnt vmcnt(17)
ds_read_b128 v[128:131], v82 offset:0
ds_read_b128 v[132:135], v83 offset:0
ds_read_b128 v[136:139], v82 offset:1024
ds_read_b128 v[140:143], v83 offset:1024
ds_read_b128 v[144:147], v82 offset:2048
ds_read_b128 v[148:151], v83 offset:2048
ds_read_b128 v[152:155], v82 offset:3072
ds_read_b128 v[156:159], v83 offset:3072
ds_read_b128 v[160:163], v82 offset:4096
ds_read_b128 v[164:167], v83 offset:4096
ds_read_b128 v[168:171], v82 offset:5120
ds_read_b128 v[172:175], v83 offset:5120
ds_read_b128 v[176:179], v82 offset:6144
ds_read_b128 v[180:183], v83 offset:6144
s_add_u32 m0, s8, 126976
s_add_u32 s11, s6, 172032
buffer_load_dwordx4 v244, s[36:39], s11 offen offset:0 lds
buffer_load_dwordx4 v245, s[36:39], s11 offen offset:1024 lds
buffer_load_dwordx4 v246, s[36:39], s11 offen offset:2048 lds
s_waitcnt lgkmcnt(0)
s_add_u32 m0, s8, 139264
s_add_u32 s11, s6, 344064
buffer_load_dwordx4 v244, s[36:39], s11 offen offset:0 lds
v_dot2_f32_bf16 v96, v128, v20, 0
v_dot2_f32_bf16 v97, v128, v128, 0
v_dot2_f32_bf16 v96, v129, v20, v96
v_dot2_f32_bf16 v97, v129, v129, v97
v_dot2_f32_bf16 v96, v130, v20, v96
v_dot2_f32_bf16 v97, v130, v130, v97
v_dot2_f32_bf16 v96, v131, v20, v96
v_dot2_f32_bf16 v97, v131, v131, v97
v_dot2_f32_bf16 v96, v132, v20, v96
v_dot2_f32_bf16 v97, v132, v132, v97
v_dot2_f32_bf16 v96, v133, v20, v96
v_dot2_f32_bf16 v97, v133, v133, v97
v_dot2_f32_bf16 v96, v134, v20, v96
v_dot2_f32_bf16 v97, v134, v134, v97
v_dot2_f32_bf16 v96, v135, v20, v96
v_dot2_f32_bf16 v97, v135, v135, v97
v_dot2_f32_bf16 v96, v136, v20, v96
v_dot2_f32_bf16 v97, v136, v136, v97
v_dot2_f32_bf16 v96, v137, v20, v96
v_dot2_f32_bf16 v97, v137, v137, v97
v_dot2_f32_bf16 v96, v138, v20, v96
v_dot2_f32_bf16 v97, v138, v138, v97
v_dot2_f32_bf16 v96, v139, v20, v96
v_dot2_f32_bf16 v97, v139, v139, v97
v_dot2_f32_bf16 v96, v140, v20, v96
buffer_load_dwordx4 v245, s[36:39], s11 offen offset:1024 lds
v_dot2_f32_bf16 v97, v140, v140, v97
v_dot2_f32_bf16 v96, v141, v20, v96
v_dot2_f32_bf16 v97, v141, v141, v97
v_dot2_f32_bf16 v96, v142, v20, v96
v_dot2_f32_bf16 v97, v142, v142, v97
v_dot2_f32_bf16 v96, v143, v20, v96
v_dot2_f32_bf16 v97, v143, v143, v97
v_dot2_f32_bf16 v96, v144, v20, v96
v_dot2_f32_bf16 v97, v144, v144, v97
v_dot2_f32_bf16 v96, v145, v20, v96
v_dot2_f32_bf16 v97, v145, v145, v97
v_dot2_f32_bf16 v96, v146, v20, v96
v_dot2_f32_bf16 v97, v146, v146, v97
v_dot2_f32_bf16 v96, v147, v20, v96
v_dot2_f32_bf16 v97, v147, v147, v97
v_dot2_f32_bf16 v96, v148, v20, v96
v_dot2_f32_bf16 v97, v148, v148, v97
v_dot2_f32_bf16 v96, v149, v20, v96
v_dot2_f32_bf16 v97, v149, v149, v97
v_dot2_f32_bf16 v96, v150, v20, v96
v_dot2_f32_bf16 v97, v150, v150, v97
v_dot2_f32_bf16 v96, v151, v20, v96
v_dot2_f32_bf16 v97, v151, v151, v97
v_dot2_f32_bf16 v96, v152, v20, v96
v_dot2_f32_bf16 v97, v152, v152, v97
buffer_load_dwordx4 v246, s[36:39], s11 offen offset:2048 lds
v_dot2_f32_bf16 v96, v153, v20, v96
v_dot2_f32_bf16 v97, v153, v153, v97
v_dot2_f32_bf16 v96, v154, v20, v96
v_dot2_f32_bf16 v97, v154, v154, v97
v_dot2_f32_bf16 v96, v155, v20, v96
v_dot2_f32_bf16 v97, v155, v155, v97
v_dot2_f32_bf16 v96, v156, v20, v96
v_dot2_f32_bf16 v97, v156, v156, v97
v_dot2_f32_bf16 v96, v157, v20, v96
v_dot2_f32_bf16 v97, v157, v157, v97
v_dot2_f32_bf16 v96, v158, v20, v96
v_dot2_f32_bf16 v97, v158, v158, v97
v_dot2_f32_bf16 v96, v159, v20, v96
v_dot2_f32_bf16 v97, v159, v159, v97
v_dot2_f32_bf16 v96, v160, v20, v96
v_dot2_f32_bf16 v97, v160, v160, v97
v_dot2_f32_bf16 v96, v161, v20, v96
v_dot2_f32_bf16 v97, v161, v161, v97
v_dot2_f32_bf16 v96, v162, v20, v96
v_dot2_f32_bf16 v97, v162, v162, v97
v_dot2_f32_bf16 v96, v163, v20, v96
v_dot2_f32_bf16 v97, v163, v163, v97
v_dot2_f32_bf16 v96, v164, v20, v96
v_dot2_f32_bf16 v97, v164, v164, v97
v_dot2_f32_bf16 v96, v165, v20, v96
s_lshl2_add_u32 s54, s2, s46
v_lshlrev_b32 v30, 7, v1
s_mul_i32 s55, s54, 512
s_mov_b64 exec, 0xf
buffer_load_dword v16, v30, s[16:19], s55 offen
s_mov_b64 exec, -1
v_dot2_f32_bf16 v97, v165, v165, v97
v_dot2_f32_bf16 v96, v166, v20, v96
v_dot2_f32_bf16 v97, v166, v166, v97
v_dot2_f32_bf16 v96, v167, v20, v96
v_dot2_f32_bf16 v97, v167, v167, v97
v_dot2_f32_bf16 v96, v168, v20, v96
v_dot2_f32_bf16 v97, v168, v168, v97
v_dot2_f32_bf16 v96, v169, v20, v96
v_dot2_f32_bf16 v97, v169, v169, v97
v_dot2_f32_bf16 v96, v170, v20, v96
v_dot2_f32_bf16 v97, v170, v170, v97
v_dot2_f32_bf16 v96, v171, v20, v96
v_dot2_f32_bf16 v97, v171, v171, v97
v_dot2_f32_bf16 v96, v172, v20, v96
v_dot2_f32_bf16 v97, v172, v172, v97
v_dot2_f32_bf16 v96, v173, v20, v96
v_dot2_f32_bf16 v97, v173, v173, v97
v_dot2_f32_bf16 v96, v174, v20, v96
v_dot2_f32_bf16 v97, v174, v174, v97
v_dot2_f32_bf16 v96, v175, v20, v96
v_dot2_f32_bf16 v97, v175, v175, v97
v_dot2_f32_bf16 v96, v176, v20, v96
v_dot2_f32_bf16 v97, v176, v176, v97
v_dot2_f32_bf16 v96, v177, v20, v96
v_dot2_f32_bf16 v97, v177, v177, v97
v_dot2_f32_bf16 v96, v178, v20, v96
v_dot2_f32_bf16 v97, v178, v178, v97
v_dot2_f32_bf16 v96, v179, v20, v96
v_dot2_f32_bf16 v97, v179, v179, v97
v_dot2_f32_bf16 v96, v180, v20, v96
v_dot2_f32_bf16 v97, v180, v180, v97
v_dot2_f32_bf16 v96, v181, v20, v96
v_dot2_f32_bf16 v97, v181, v181, v97
v_dot2_f32_bf16 v96, v182, v20, v96
v_dot2_f32_bf16 v97, v182, v182, v97
v_dot2_f32_bf16 v96, v183, v20, v96
v_dot2_f32_bf16 v97, v183, v183, v97
s_waitcnt vmcnt(10)
ds_read_b128 v[184:187], v82 offset:14336
ds_read_b128 v[188:191], v83 offset:14336
ds_read_b128 v[192:195], v82 offset:15360
ds_read_b128 v[196:199], v83 offset:15360
ds_read_b128 v[200:203], v82 offset:16384
ds_read_b128 v[204:207], v83 offset:16384
ds_read_b128 v[208:211], v82 offset:17408
ds_read_b128 v[212:215], v83 offset:17408
ds_read_b128 v[216:219], v82 offset:18432
ds_read_b128 v[220:223], v83 offset:18432
ds_read_b128 v[224:227], v82 offset:19456
ds_read_b128 v[228:231], v83 offset:19456
ds_read_b128 v[232:235], v82 offset:20480
ds_read_b128 v[236:239], v83 offset:20480
v_lshrrev_b32 v28, 3, v1
v_and_b32 v29, 7, v1
v_lshrrev_b32 v26, 4, v1
v_lshlrev_b32 v26, 1, v26
v_xor_b32 v26, v26, v29
v_lshlrev_b32 v26, 4, v26
s_movk_i32 s56, 896
v_mad_u32_u24 v19, v28, s56, v26
v_lshlrev_b32 v29, 4, v29
v_mad_u32_u24 v127, v28, s56, v29
s_movk_i32 s56, 3584
v_mad_u32_u24 v126, v28, s56, v29
s_mul_i32 s3, s45, 224
s_mul_i32 s55, s44, 114688
s_add_u32 s3, s3, s55
s_add_u32 s3, s3, s96
s_lshl1_add_u32 s22, s44, s48
s_mul_i32 s22, s22, 57344
s_lshl_b32 s55, s47, 7
s_add_u32 s22, s22, s55
s_mul_i32 s55, s46, 7168
s_add_u32 s22, s22, s55
s_cmp_lg_u32 s53, 0
s_cselect_b32 s22, 0x40000000, s22
s_cmp_ge_u32 s44, 14
s_cselect_b32 s22, 0x40000000, s22
s_cselect_b32 s3, 0x40000000, s3
s_lshl_b32 s23, s46, 10
s_mul_i32 s9, s44, 86016
s_mul_i32 s55, s46, 21504
s_add_u32 s9, s9, s55
s_cmp_ge_u32 s44, 14
s_cselect_b32 s9, 0x40000000, s9
v_lshrrev_b32 v26, 2, v6
v_and_b32 v27, 3, v1
s_movk_i32 s56, 896
v_mul_u32_u24 v247, 2688, v7
v_lshl_add_u32 v247, v27, 4, v247
v_mad_u32_u24 v247, v26, s56, v247
s_mul_i32 s54, s101, 56
v_add_u32 v247, s54, v247
v_cmp_eq_u32 vcc, 3, v26
v_bfrev_b32 v31, 1
s_nop 0
v_cndmask_b32 v247, v247, v31, vcc
s_waitcnt lgkmcnt(0)
s_barrier
v_lshrrev_b32_e64 v26, 2, v6
v_lshl_add_u32 v26, v7, 3, v26
v_mul_u32_u24 v26, 192, v26
v_and_b32_e64 v27, 3, v1
v_lshl_add_u32 v26, v27, 3, v26
v_and_b32 v27, 1, v7
v_lshlrev_b32 v27, 5, v27
v_add_u32 v114, v26, v27
v_sub_u32 v115, v26, v27
v_add_u32 v116, 114688, v114
v_add_u32 v117, 114688, v115
s_bitcmp1_b32 s46, 0
s_cselect_b64 vcc, -1, 0
s_cselect_b32 s55, 0, 64
s_add_u32 s55, s55, 736
s_lshl_b32 s54, s46, 5
s_add_u32 s55, s55, s54
v_cndmask_b32 v118, v114, v115, vcc
v_cndmask_b32 v119, v115, v114, vcc
v_add_u32 v118, s54, v118
v_add_u32_e64 v119, s55, v119
v_add_u32 v120, 114688, v118
v_add_u32 v121, 114688, v119
v_lshlrev_b32 v122, 7, v7
v_lshl_add_u32 v122, v6, 3, v122
v_add_u32 v122, 162560, v122
s_waitcnt vmcnt(7)
s_barrier
ds_read_b64_tr_b16 a[224:225], v116 offset:0
ds_read_b64_tr_b16 a[226:227], v117 offset:800
ds_read_b64_tr_b16 a[228:229], v117 offset:32
ds_read_b64_tr_b16 a[230:231], v116 offset:768
ds_read_b64_tr_b16 a[232:233], v116 offset:64
ds_read_b64_tr_b16 a[234:235], v117 offset:864
ds_read_b64_tr_b16 a[236:237], v117 offset:96
ds_read_b64_tr_b16 a[238:239], v116 offset:832
ds_read_b64_tr_b16 a[240:241], v116 offset:128
ds_read_b64_tr_b16 a[242:243], v117 offset:928
ds_read_b64_tr_b16 a[244:245], v117 offset:160
ds_read_b64_tr_b16 a[246:247], v116 offset:896
s_add_u32 m0, s23, 49152
s_nop 0
buffer_load_dwordx4 v126, s[88:91], s3 offen offset:0 nt lds
v_dot2_f32_bf16 v98, v184, v20, 0
v_dot2_f32_bf16 v99, v184, v184, 0
v_dot2_f32_bf16 v98, v185, v20, v98
v_dot2_f32_bf16 v99, v185, v185, v99
v_dot2_f32_bf16 v98, v186, v20, v98
v_dot2_f32_bf16 v99, v186, v186, v99
v_dot2_f32_bf16 v98, v187, v20, v98
v_dot2_f32_bf16 v99, v187, v187, v99
v_dot2_f32_bf16 v98, v188, v20, v98
v_dot2_f32_bf16 v99, v188, v188, v99
v_dot2_f32_bf16 v98, v189, v20, v98
v_dot2_f32_bf16 v99, v189, v189, v99
v_dot2_f32_bf16 v98, v190, v20, v98
v_dot2_f32_bf16 v99, v190, v190, v99
v_dot2_f32_bf16 v98, v191, v20, v98
v_dot2_f32_bf16 v99, v191, v191, v99
v_dot2_f32_bf16 v98, v192, v20, v98
v_dot2_f32_bf16 v99, v192, v192, v99
s_add_u32 m0, s23, 53248
s_nop 0
buffer_load_dwordx4 v126, s[40:43], s3 offen offset:0 nt lds
v_dot2_f32_bf16 v98, v193, v20, v98
v_dot2_f32_bf16 v99, v193, v193, v99
v_dot2_f32_bf16 v98, v194, v20, v98
v_dot2_f32_bf16 v99, v194, v194, v99
v_dot2_f32_bf16 v98, v195, v20, v98
v_dot2_f32_bf16 v99, v195, v195, v99
v_dot2_f32_bf16 v98, v196, v20, v98
v_dot2_f32_bf16 v99, v196, v196, v99
v_dot2_f32_bf16 v98, v197, v20, v98
v_dot2_f32_bf16 v99, v197, v197, v99
v_dot2_f32_bf16 v98, v198, v20, v98
v_dot2_f32_bf16 v99, v198, v198, v99
v_dot2_f32_bf16 v98, v199, v20, v98
v_dot2_f32_bf16 v99, v199, v199, v99
v_dot2_f32_bf16 v98, v200, v20, v98
v_dot2_f32_bf16 v99, v200, v200, v99
v_dot2_f32_bf16 v98, v201, v20, v98
v_dot2_f32_bf16 v99, v201, v201, v99
s_add_u32 m0, s23, 57216
s_nop 0
buffer_load_dwordx4 v126, s[88:91], s3 offen offset:128 nt lds
v_dot2_f32_bf16 v98, v202, v20, v98
v_dot2_f32_bf16 v99, v202, v202, v99
v_dot2_f32_bf16 v98, v203, v20, v98
v_dot2_f32_bf16 v99, v203, v203, v99
v_dot2_f32_bf16 v98, v204, v20, v98
v_dot2_f32_bf16 v99, v204, v204, v99
v_dot2_f32_bf16 v98, v205, v20, v98
v_dot2_f32_bf16 v99, v205, v205, v99
v_dot2_f32_bf16 v98, v206, v20, v98
v_dot2_f32_bf16 v99, v206, v206, v99
v_dot2_f32_bf16 v98, v207, v20, v98
v_dot2_f32_bf16 v99, v207, v207, v99
v_dot2_f32_bf16 v98, v208, v20, v98
v_dot2_f32_bf16 v99, v208, v208, v99
v_dot2_f32_bf16 v98, v209, v20, v98
v_dot2_f32_bf16 v99, v209, v209, v99
v_dot2_f32_bf16 v98, v210, v20, v98
v_dot2_f32_bf16 v99, v210, v210, v99
s_add_u32 m0, s23, 61312
s_nop 0
buffer_load_dwordx4 v126, s[40:43], s3 offen offset:128 nt lds
v_dot2_f32_bf16 v98, v211, v20, v98
v_dot2_f32_bf16 v99, v211, v211, v99
v_dot2_f32_bf16 v98, v212, v20, v98
v_dot2_f32_bf16 v99, v212, v212, v99
v_dot2_f32_bf16 v98, v213, v20, v98
v_dot2_f32_bf16 v99, v213, v213, v99
v_dot2_f32_bf16 v98, v214, v20, v98
v_dot2_f32_bf16 v99, v214, v214, v99
v_dot2_f32_bf16 v98, v215, v20, v98
v_dot2_f32_bf16 v99, v215, v215, v99
v_dot2_f32_bf16 v98, v216, v20, v98
v_dot2_f32_bf16 v99, v216, v216, v99
v_dot2_f32_bf16 v98, v217, v20, v98
v_dot2_f32_bf16 v99, v217, v217, v99
v_dot2_f32_bf16 v98, v218, v20, v98
v_dot2_f32_bf16 v99, v218, v218, v99
v_dot2_f32_bf16 v98, v219, v20, v98
v_dot2_f32_bf16 v99, v219, v219, v99
s_add_u32 m0, s23, 65536
s_nop 0
buffer_load_dwordx4 v127, s[12:15], s22 offen nt lds
v_dot2_f32_bf16 v98, v220, v20, v98
v_dot2_f32_bf16 v99, v220, v220, v99
v_dot2_f32_bf16 v98, v221, v20, v98
v_dot2_f32_bf16 v99, v221, v221, v99
v_dot2_f32_bf16 v98, v222, v20, v98
v_dot2_f32_bf16 v99, v222, v222, v99
v_dot2_f32_bf16 v98, v223, v20, v98
v_dot2_f32_bf16 v99, v223, v223, v99
v_dot2_f32_bf16 v98, v224, v20, v98
v_dot2_f32_bf16 v99, v224, v224, v99
v_dot2_f32_bf16 v98, v225, v20, v98
v_dot2_f32_bf16 v99, v225, v225, v99
v_dot2_f32_bf16 v98, v226, v20, v98
v_dot2_f32_bf16 v99, v226, v226, v99
v_dot2_f32_bf16 v98, v227, v20, v98
v_dot2_f32_bf16 v99, v227, v227, v99
v_dot2_f32_bf16 v98, v228, v20, v98
v_dot2_f32_bf16 v99, v228, v228, v99
s_add_u32 m0, s23, 69632
s_add_u32 s22, s22, 28672
buffer_load_dwordx4 v127, s[12:15], s22 offen nt lds
v_dot2_f32_bf16 v98, v229, v20, v98
v_dot2_f32_bf16 v99, v229, v229, v99
v_dot2_f32_bf16 v98, v230, v20, v98
v_dot2_f32_bf16 v99, v230, v230, v99
v_dot2_f32_bf16 v98, v231, v20, v98
v_dot2_f32_bf16 v99, v231, v231, v99
v_dot2_f32_bf16 v98, v232, v20, v98
v_dot2_f32_bf16 v99, v232, v232, v99
v_dot2_f32_bf16 v98, v233, v20, v98
v_dot2_f32_bf16 v99, v233, v233, v99
v_dot2_f32_bf16 v98, v234, v20, v98
v_dot2_f32_bf16 v99, v234, v234, v99
v_dot2_f32_bf16 v98, v235, v20, v98
v_dot2_f32_bf16 v99, v235, v235, v99
v_dot2_f32_bf16 v98, v236, v20, v98
v_dot2_f32_bf16 v99, v236, v236, v99
v_dot2_f32_bf16 v98, v237, v20, v98
v_dot2_f32_bf16 v99, v237, v237, v99
s_cmp_ge_u32 s46, 2
s_cselect_b32 s11, 0, 0
s_lshl1_add_u32 s11, s23, s11
s_add_u32 m0, s11, 73728
s_nop 0
buffer_load_dwordx4 v247, s[36:39], s9 offen lds
v_dot2_f32_bf16 v98, v238, v20, v98
v_dot2_f32_bf16 v99, v238, v238, v99
v_dot2_f32_bf16 v98, v239, v20, v98
v_dot2_f32_bf16 v99, v239, v239, v99
v_mov_b32 v102, v96
v_mov_b32 v103, v97
v_mov_b32 v104, v98
v_mov_b32 v105, v99
v_permlane16_swap_b32 v96, v102
v_permlane16_swap_b32 v97, v103
v_permlane16_swap_b32 v98, v104
v_permlane16_swap_b32 v99, v105
v_add_f32 v96, v96, v102
v_add_f32 v97, v97, v103
v_add_f32 v98, v98, v104
v_add_f32 v99, v99, v105
v_mov_b32 v102, v96
v_mov_b32 v103, v97
v_mov_b32 v104, v98
v_mov_b32 v105, v99
v_permlane32_swap_b32 v96, v102
v_permlane32_swap_b32 v97, v103
v_permlane32_swap_b32 v98, v104
v_permlane32_swap_b32 v99, v105
v_add_f32 v96, v96, v102
v_add_f32 v97, v97, v103
v_add_f32 v98, v98, v104
v_add_f32 v99, v99, v105
s_waitcnt lgkmcnt(6)
v_mfma_f32_16x16x32_bf16 v[32:35], a[224:227], v[128:131], 0
s_cmp_ge_u32 s46, 2
s_cselect_b32 s11, 0, 0
s_lshl1_add_u32 s11, s23, s11
s_add_u32 m0, s11, 74752
s_add_u32 s9, s9, 10752
buffer_load_dwordx4 v247, s[36:39], s9 offen lds
v_mfma_f32_16x16x32_bf16 v[56:59], a[224:227], v[184:187], 0
ds_read_b64_tr_b16 a[248:249], v116 offset:6144
ds_read_b64_tr_b16 a[250:251], v117 offset:6944
v_mfma_f32_16x16x32_bf16 a[0:3], a[224:227], v[20:23], 0
v_mul_f32 v108, 0xbb124925, v96
v_mul_f32_e64 v102, v108, v108
v_mfma_f32_16x16x32_bf16 v[36:39], a[228:231], v[128:131], 0
v_fma_f32 v102, v97, s100, -v102
v_max_f32_e64 v102, 0, v102
v_mfma_f32_16x16x32_bf16 v[60:63], a[228:231], v[184:187], 0
ds_read_b64_tr_b16 a[252:253], v117 offset:6176
ds_read_b64_tr_b16 a[254:255], v116 offset:6912
v_mfma_f32_16x16x32_bf16 a[4:7], a[228:231], v[20:23], 0
s_mul_i32 s88, s45, 86016
s_add_u32 s88, s88, 1048576
s_mul_i32 s90, s45, 200704
s_add_u32 s90, s90, 2883584
s_mul_i32 s91, s47, 229376
s_mul_i32 s54, s46, 57344
s_add_u32 s91, s91, s54
s_add_u32 s91, s91, 6094848
s_mul_i32 s4, s46, 7168
s_lshl_b32 s5, s46, 12
s_add_u32 s7, s88, s4
s_add_u32 s10, s90, s4
s_mul_i32 s89, s46, 25088
s_lshl_b32 s54, s47, 7
s_add_u32 s89, s89, s54
s_cmp_lg_u32 s53, 0
s_cselect_b32 s89, 0x40000000, s89
s_cselect_b32 s91, 0x40000000, s91
v_mfma_f32_16x16x32_bf16 v[40:43], a[232:235], v[128:131], 0
ds_read_b64_tr_b16 v[240:241], v120 offset:64
ds_read_b64_tr_b16 v[242:243], v121 offset:64
v_mfma_f32_16x16x32_bf16 v[64:67], a[232:235], v[184:187], 0
ds_read_b64_tr_b16 a[224:225], v116 offset:6208
ds_read_b64_tr_b16 a[226:227], v117 offset:7008
v_mfma_f32_16x16x32_bf16 a[8:11], a[232:235], v[20:23], 0
v_add_f32 v102, 0x3727c5ac, v102
s_waitcnt lgkmcnt(8)
v_mfma_f32_16x16x32_bf16 v[44:47], a[236:239], v[128:131], 0
v_mfma_f32_16x16x32_bf16 v[68:71], a[236:239], v[184:187], 0
ds_read_b64_tr_b16 a[228:229], v117 offset:6240
ds_read_b64_tr_b16 a[230:231], v116 offset:6976
v_mfma_f32_16x16x32_bf16 a[12:15], a[236:239], v[20:23], 0
s_add_u32 m0, s8, 0
s_add_u32 s11, s6, 516096
buffer_load_dwordx4 v244, s[36:39], s11 offen offset:0 lds
v_mfma_f32_16x16x32_bf16 v[48:51], v[128:131], a[240:243], 0
v_rsq_f32 v109, v102
v_mfma_f32_16x16x32_bf16 v[72:75], v[184:187], a[240:243], 0
ds_read_b64_tr_b16 a[232:233], v116 offset:6272
ds_read_b64_tr_b16 a[234:235], v117 offset:7072
v_mfma_f32_16x16x32_bf16 a[16:19], v[20:23], a[240:243], 0
v_mul_f32 v110, 0xbb124925, v98
v_mul_f32_e64 v103, v110, v110
v_mfma_f32_16x16x32_bf16 v[52:55], v[128:131], a[244:247], 0
v_fma_f32 v103, v99, s100, -v103
v_max_f32_e64 v103, 0, v103
v_mfma_f32_16x16x32_bf16 v[76:79], v[184:187], a[244:247], 0
ds_read_b64_tr_b16 a[236:237], v117 offset:6304
ds_read_b64_tr_b16 a[238:239], v116 offset:7040
v_mfma_f32_16x16x32_bf16 a[20:23], v[20:23], a[244:247], 0
buffer_load_dwordx4 v245, s[36:39], s11 offen offset:1024 lds
v_add_f32 v103, 0x3727c5ac, v103
s_waitcnt vmcnt(14)
s_barrier
s_waitcnt lgkmcnt(6)
v_mfma_f32_16x16x32_bf16 v[32:35], a[248:251], v[132:135], v[32:35]
v_mfma_f32_16x16x32_bf16 v[56:59], a[248:251], v[188:191], v[56:59]
ds_read_b64_tr_b16 a[240:241], v116 offset:12288
ds_read_b64_tr_b16 a[242:243], v117 offset:13088
v_mfma_f32_16x16x32_bf16 a[0:3], a[248:251], v[20:23], a[0:3]
v_rsq_f32 v111, v103
v_mfma_f32_16x16x32_bf16 v[36:39], a[252:255], v[132:135], v[36:39]
s_lshl_b32 s58, s46, 7
s_add_u32 s58, s58, 161280
v_mfma_f32_16x16x32_bf16 v[60:63], a[252:255], v[188:191], v[60:63]
ds_read_b64_tr_b16 a[244:245], v117 offset:12320
ds_read_b64_tr_b16 a[246:247], v116 offset:13056
v_mfma_f32_16x16x32_bf16 a[4:7], a[252:255], v[20:23], a[4:7]
buffer_load_dwordx4 v246, s[36:39], s11 offen offset:2048 lds
v_lshl_add_u32 v125, v6, 2, s58
v_mfma_f32_16x16x32_bf16 v[40:43], a[224:227], v[132:135], v[40:43]
ds_read_b64_tr_b16 v[184:185], v120 offset:6208
ds_read_b64_tr_b16 v[186:187], v121 offset:6208
v_mfma_f32_16x16x32_bf16 v[64:67], a[224:227], v[188:191], v[64:67]
ds_read_b64_tr_b16 a[248:249], v116 offset:12352
ds_read_b64_tr_b16 a[250:251], v117 offset:13152
v_mfma_f32_16x16x32_bf16 a[8:11], a[224:227], v[20:23], a[8:11]
ds_write2_b32 v125, v108, v109 offset0:0 offset1:160
ds_write2_b32 v125, v110, v111 offset0:16 offset1:176
s_waitcnt lgkmcnt(10)
v_mfma_f32_16x16x32_bf16 v[44:47], a[228:231], v[132:135], v[44:47]
v_lshl_add_u32 v124, v7, 4, s58
v_mfma_f32_16x16x32_bf16 v[68:71], a[228:231], v[188:191], v[68:71]
ds_read_b64_tr_b16 a[252:253], v117 offset:12384
ds_read_b64_tr_b16 a[254:255], v116 offset:13120
v_mfma_f32_16x16x32_bf16 a[12:15], a[228:231], v[20:23], a[12:15]
s_lshl_b32 s92, s44, 7
s_sub_u32 s93, s92, 16
s_mul_i32 s93, s93, 896
s_lshl_b32 s94, s46, 2
s_min_u32 s94, s94, 10
s_lshl_b32 s96, s94, 6
s_add_u32 s93, s93, s96
s_cmp_eq_u32 s44, 0
s_cselect_b32 s93, 0x40000000, s93
s_lshl_b32 s94, s94, 10
v_mul_u32_u24 v123, 896, v6
v_lshl_add_u32 v123, v7, 4, v123
s_add_u32 m0, s94, 86016
s_nop 0
buffer_load_dwordx4 v123, s[28:31], s93 offen offset:0 lds
v_mfma_f32_16x16x32_bf16 v[48:51], v[132:135], a[232:235], v[48:51]
v_mfma_f32_16x16x32_bf16 v[72:75], v[188:191], a[232:235], v[72:75]
ds_read_b64_tr_b16 a[224:225], v116 offset:12416
ds_read_b64_tr_b16 a[226:227], v117 offset:13216
v_mfma_f32_16x16x32_bf16 a[16:19], v[20:23], a[232:235], a[16:19]
v_mfma_f32_16x16x32_bf16 v[52:55], v[132:135], a[236:239], v[52:55]
v_mfma_f32_16x16x32_bf16 v[76:79], v[188:191], a[236:239], v[76:79]
ds_read_b64_tr_b16 a[228:229], v117 offset:12448
ds_read_b64_tr_b16 a[230:231], v116 offset:13184
v_mfma_f32_16x16x32_bf16 a[20:23], v[20:23], a[236:239], a[20:23]
s_add_u32 m0, s94, 86976
s_nop 0
buffer_load_dwordx4 v123, s[28:31], s93 offen offset:64 lds
s_waitcnt lgkmcnt(8)
v_mfma_f32_16x16x32_bf16 v[32:35], a[240:243], v[136:139], v[32:35]
v_mfma_f32_16x16x32_bf16 v[56:59], a[240:243], v[192:195], v[56:59]
ds_read_b64_tr_b16 a[232:233], v116 offset:18432
ds_read_b64_tr_b16 a[234:235], v117 offset:19232
v_mfma_f32_16x16x32_bf16 a[0:3], a[240:243], v[20:23], a[0:3]
v_mfma_f32_16x16x32_bf16 v[36:39], a[244:247], v[136:139], v[36:39]
v_mfma_f32_16x16x32_bf16 v[60:63], a[244:247], v[192:195], v[60:63]
ds_read_b64_tr_b16 a[236:237], v117 offset:18464
ds_read_b64_tr_b16 a[238:239], v116 offset:19200
v_mfma_f32_16x16x32_bf16 a[4:7], a[244:247], v[20:23], a[4:7]
s_add_u32 m0, s94, 87936
s_nop 0
buffer_load_dwordx4 v123, s[28:31], s93 offen offset:128 lds
v_mfma_f32_16x16x32_bf16 v[40:43], a[248:251], v[136:139], v[40:43]
ds_read_b64_tr_b16 v[188:189], v120 offset:12352
ds_read_b64_tr_b16 v[190:191], v121 offset:12352
v_mfma_f32_16x16x32_bf16 v[64:67], a[248:251], v[192:195], v[64:67]
ds_read_b64_tr_b16 a[240:241], v116 offset:18496
ds_read_b64_tr_b16 a[242:243], v117 offset:19296
v_mfma_f32_16x16x32_bf16 a[8:11], a[248:251], v[20:23], a[8:11]
s_waitcnt lgkmcnt(8)
v_mfma_f32_16x16x32_bf16 v[44:47], a[252:255], v[136:139], v[44:47]
v_mfma_f32_16x16x32_bf16 v[68:71], a[252:255], v[192:195], v[68:71]
ds_read_b64_tr_b16 a[244:245], v117 offset:18528
ds_read_b64_tr_b16 a[246:247], v116 offset:19264
v_mfma_f32_16x16x32_bf16 a[12:15], a[252:255], v[20:23], a[12:15]
s_add_u32 m0, s94, 88896
s_nop 0
buffer_load_dwordx4 v123, s[28:31], s93 offen offset:192 lds
v_mfma_f32_16x16x32_bf16 v[48:51], v[136:139], a[224:227], v[48:51]
v_mfma_f32_16x16x32_bf16 v[72:75], v[192:195], a[224:227], v[72:75]
ds_read_b64_tr_b16 a[248:249], v116 offset:18560
ds_read_b64_tr_b16 a[250:251], v117 offset:19360
v_mfma_f32_16x16x32_bf16 a[16:19], v[20:23], a[224:227], a[16:19]
v_mfma_f32_16x16x32_bf16 v[52:55], v[136:139], a[228:231], v[52:55]
v_mfma_f32_16x16x32_bf16 v[76:79], v[192:195], a[228:231], v[76:79]
ds_read_b64_tr_b16 a[252:253], v117 offset:18592
ds_read_b64_tr_b16 a[254:255], v116 offset:19328
v_mfma_f32_16x16x32_bf16 a[20:23], v[20:23], a[228:231], a[20:23]
s_lshl_b32 s93, s48, 6
s_add_u32 s93, s93, s92
s_lshl_b32 s94, s46, 4
s_add_u32 s93, s93, s94
s_mul_i32 s93, s93, 896
s_lshl_b32 s94, s47, 7
s_add_u32 s93, s93, s94
s_lshl_b32 s96, s46, 11
s_add_u32 m0, s96, 151552
s_nop 0
buffer_load_dwordx4 v25, s[28:31], s93 offen lds
s_waitcnt vmcnt(17)
s_barrier
s_waitcnt lgkmcnt(6)
v_mfma_f32_16x16x32_bf16 v[32:35], a[232:235], v[140:143], v[32:35]
v_mfma_f32_16x16x32_bf16 v[56:59], a[232:235], v[196:199], v[56:59]
ds_read_b64_tr_b16 a[224:225], v116 offset:24576
ds_read_b64_tr_b16 a[226:227], v117 offset:25376
v_mfma_f32_16x16x32_bf16 a[0:3], a[232:235], v[20:23], a[0:3]
v_mfma_f32_16x16x32_bf16 v[36:39], a[236:239], v[140:143], v[36:39]
v_mfma_f32_16x16x32_bf16 v[60:63], a[236:239], v[196:199], v[60:63]
ds_read_b64_tr_b16 a[228:229], v117 offset:24608
ds_read_b64_tr_b16 a[230:231], v116 offset:25344
v_mfma_f32_16x16x32_bf16 a[4:7], a[236:239], v[20:23], a[4:7]
s_add_u32 s93, s93, 7168
s_add_u32 m0, s96, 152576
s_nop 0
buffer_load_dwordx4 v25, s[28:31], s93 offen lds
v_mfma_f32_16x16x32_bf16 v[40:43], a[240:243], v[140:143], v[40:43]
ds_read_b64_tr_b16 v[192:193], v120 offset:18496
ds_read_b64_tr_b16 v[194:195], v121 offset:18496
v_mfma_f32_16x16x32_bf16 v[64:67], a[240:243], v[196:199], v[64:67]
ds_read_b64_tr_b16 a[232:233], v116 offset:24640
ds_read_b64_tr_b16 a[234:235], v117 offset:25440
v_mfma_f32_16x16x32_bf16 a[8:11], a[240:243], v[20:23], a[8:11]
s_waitcnt lgkmcnt(8)
v_mfma_f32_16x16x32_bf16 v[44:47], a[244:247], v[140:143], v[44:47]
v_mfma_f32_16x16x32_bf16 v[68:71], a[244:247], v[196:199], v[68:71]
ds_read_b64_tr_b16 a[236:237], v117 offset:24672
ds_read_b64_tr_b16 a[238:239], v116 offset:25408
v_mfma_f32_16x16x32_bf16 a[12:15], a[244:247], v[20:23], a[12:15]
s_add_u32 m0, s8, 12288
s_add_u32 s11, s6, 688128
buffer_load_dwordx4 v244, s[36:39], s11 offen offset:0 lds
v_mfma_f32_16x16x32_bf16 v[48:51], v[140:143], a[248:251], v[48:51]
v_mfma_f32_16x16x32_bf16 v[72:75], v[196:199], a[248:251], v[72:75]
ds_read_b64_tr_b16 a[240:241], v116 offset:24704
ds_read_b64_tr_b16 a[242:243], v117 offset:25504
v_mfma_f32_16x16x32_bf16 a[16:19], v[20:23], a[248:251], a[16:19]
v_mfma_f32_16x16x32_bf16 v[52:55], v[140:143], a[252:255], v[52:55]
v_mfma_f32_16x16x32_bf16 v[76:79], v[196:199], a[252:255], v[76:79]
ds_read_b64_tr_b16 a[244:245], v117 offset:24736
ds_read_b64_tr_b16 a[246:247], v116 offset:25472
v_mfma_f32_16x16x32_bf16 a[20:23], v[20:23], a[252:255], a[20:23]
buffer_load_dwordx4 v245, s[36:39], s11 offen offset:1024 lds
s_waitcnt lgkmcnt(6)
v_mfma_f32_16x16x32_bf16 v[32:35], a[224:227], v[144:147], v[32:35]
v_mfma_f32_16x16x32_bf16 v[56:59], a[224:227], v[200:203], v[56:59]
ds_read_b64_tr_b16 a[248:249], v116 offset:30720
ds_read_b64_tr_b16 a[250:251], v117 offset:31520
v_mfma_f32_16x16x32_bf16 a[0:3], a[224:227], v[20:23], a[0:3]
v_mfma_f32_16x16x32_bf16 v[36:39], a[228:231], v[144:147], v[36:39]
v_mfma_f32_16x16x32_bf16 v[60:63], a[228:231], v[200:203], v[60:63]
ds_read_b64_tr_b16 a[252:253], v117 offset:30752
ds_read_b64_tr_b16 a[254:255], v116 offset:31488
v_mfma_f32_16x16x32_bf16 a[4:7], a[228:231], v[20:23], a[4:7]
buffer_load_dwordx4 v246, s[36:39], s11 offen offset:2048 lds
v_mfma_f32_16x16x32_bf16 v[40:43], a[232:235], v[144:147], v[40:43]
ds_read_b64_tr_b16 v[196:197], v120 offset:24640
ds_read_b64_tr_b16 v[198:199], v121 offset:24640
v_mfma_f32_16x16x32_bf16 v[64:67], a[232:235], v[200:203], v[64:67]
ds_read_b64_tr_b16 a[224:225], v116 offset:30784
ds_read_b64_tr_b16 a[226:227], v117 offset:31584
v_mfma_f32_16x16x32_bf16 a[8:11], a[232:235], v[20:23], a[8:11]
s_waitcnt lgkmcnt(8)
v_mfma_f32_16x16x32_bf16 v[44:47], a[236:239], v[144:147], v[44:47]
v_mfma_f32_16x16x32_bf16 v[68:71], a[236:239], v[200:203], v[68:71]
ds_read_b64_tr_b16 a[228:229], v117 offset:30816
ds_read_b64_tr_b16 a[230:231], v116 offset:31552
v_mfma_f32_16x16x32_bf16 a[12:15], a[236:239], v[20:23], a[12:15]
s_add_u32 m0, s8, 24576
s_add_u32 s11, s6, 860160
buffer_load_dwordx4 v244, s[36:39], s11 offen offset:0 lds
v_mfma_f32_16x16x32_bf16 v[48:51], v[144:147], a[240:243], v[48:51]
v_mfma_f32_16x16x32_bf16 v[72:75], v[200:203], a[240:243], v[72:75]
ds_read_b64_tr_b16 a[232:233], v116 offset:30848
ds_read_b64_tr_b16 a[234:235], v117 offset:31648
v_mfma_f32_16x16x32_bf16 a[16:19], v[20:23], a[240:243], a[16:19]
v_mfma_f32_16x16x32_bf16 v[52:55], v[144:147], a[244:247], v[52:55]
v_mfma_f32_16x16x32_bf16 v[76:79], v[200:203], a[244:247], v[76:79]
ds_read_b64_tr_b16 a[236:237], v117 offset:30880
ds_read_b64_tr_b16 a[238:239], v116 offset:31616
v_mfma_f32_16x16x32_bf16 a[20:23], v[20:23], a[244:247], a[20:23]
buffer_load_dwordx4 v245, s[36:39], s11 offen offset:1024 lds
s_waitcnt vmcnt(11)
s_barrier
v_lshrrev_b32 v26, 2, v6
v_and_b32 v27, 3, v1
v_lshlrev_b32 v27, 3, v27
v_lshrrev_b32 v30, 1, v7
v_and_b32_e64 v29, 1, v7
v_lshl_add_u32 v28, v30, 2, v26
v_lshl_add_u32 v28, v28, 7, v27
v_lshl_add_u32 v28, v29, 12, v28
s_lshr_b32 s54, s46, 1
s_and_b32 s55, s46, 1
s_lshl_b32 s55, s55, 6
s_lshl_b32 s56, s54, 13
s_add_u32 s56, s56, s55
s_add_u32 s56, s56, 49152
v_add_u32 v28, s56, v28
ds_read_b64_tr_b16 a[32:33], v28 offset:0
ds_read_b64_tr_b16 a[34:35], v28 offset:2048
ds_read_b64_tr_b16 a[36:37], v28 offset:1024
ds_read_b64_tr_b16 a[38:39], v28 offset:3072
ds_read_b64_tr_b16 a[40:41], v28 offset:32
ds_read_b64_tr_b16 a[42:43], v28 offset:2080
ds_read_b64_tr_b16 a[44:45], v28 offset:1056
ds_read_b64_tr_b16 a[46:47], v28 offset:3104
v_lshl_add_u32 v30, v30, 4, v26
v_lshl_add_u32 v30, v29, 2, v30
v_lshl_add_u32 v30, v30, 7, v27
s_lshl_b32 s56, s54, 12
s_add_u32 s56, s56, s55
s_add_u32 s56, s56, 65536
v_add_u32_e64 v30, s56, v30
ds_read_b64_tr_b16 a[48:49], v30 offset:0
ds_read_b64_tr_b16 a[50:51], v30 offset:1024
ds_read_b64_tr_b16 a[52:53], v30 offset:32
ds_read_b64_tr_b16 a[54:55], v30 offset:1056
v_lshl_add_u32 v31, v7, 3, v26
v_lshl_add_u32 v31, v31, 8, v27
s_lshl_b32 s56, s46, 6
s_add_u32 s56, s56, 73728
v_add_u32 v31, s56, v31
v_lshrrev_b32 v26, 1, v7
s_mov_b32 s56, 0
v_mad_u32_u24 v31, v26, s56, v31
ds_read_b64_tr_b16 a[56:57], v31 offset:0
ds_read_b64_tr_b16 a[58:59], v31 offset:1024
ds_read_b64_tr_b16 a[60:61], v31 offset:32
ds_read_b64_tr_b16 a[62:63], v31 offset:1056
s_mul_i32 s22, s44, 6144
s_lshl_b32 s55, s46, 11
s_add_u32 s22, s22, s55
s_add_u32 s22, s22, s88
s_mul_i32 s40, s46, 57344
s_add_u32 s40, s40, s90
s_lshl_b32 s55, s44, 11
s_add_u32 s40, s40, s55
s_add_u32 s41, s40, 28672
s_mul_i32 s42, s45, 14
s_add_u32 s42, s42, s44
s_mul_i32 s42, s42, 896
s_lshl_b32 s55, s46, 8
s_add_u32 s42, s42, s55
s_add_u32 s42, s42, 7864320
s_add_u32 s23, s42, 128
s_lshl1_add_u32 s43, s44, s48
s_lshl_b32 s43, s43, 13
s_mul_i32 s55, s47, 229376
s_add_u32 s43, s43, s55
s_lshl_b32 s55, s46, 11
s_add_u32 s43, s43, s55
s_add_u32 s43, s43, 6094848
s_cmp_ge_u32 s44, 14
s_cselect_b32 s40, 0x40000000, s40
s_cselect_b32 s41, 0x40000000, s41
s_cselect_b32 s42, 0x40000000, s42
s_cselect_b32 s43, 0x40000000, s43
s_cselect_b32 s22, 0x40000000, s22
s_cselect_b32 s23, 0x40000000, s23
s_cmp_eq_u32 s46, 3
s_cselect_b32 s41, 0x40000000, s41
s_cselect_b32 s22, 0x40000000, s22
s_cselect_b32 s23, 0x40000000, s23
s_cmp_ge_u32 s45, 14
s_cselect_b32 s43, 0x40000000, s43
v_lshlrev_b32 v127, 2, v1
s_waitcnt lgkmcnt(0)
v_mfma_f32_32x32x16_bf16 a[64:79], v[20:23], a[32:35], 0
v_mfma_f32_32x32x16_bf16 a[64:79], v[20:23], a[36:39], a[64:79]
v_mfma_f32_32x32x16_bf16 a[80:95], v[20:23], a[40:43], 0
v_mfma_f32_32x32x16_bf16 a[80:95], v[20:23], a[44:47], a[80:95]
v_mfma_f32_16x16x32_bf16 v[32:35], a[248:251], v[148:151], v[32:35]
buffer_load_dwordx4 v246, s[36:39], s11 offen offset:2048 lds
v_mfma_f32_16x16x32_bf16 v[56:59], a[248:251], v[204:207], v[56:59]
ds_read_b64_tr_b16 a[240:241], v114 offset:0
ds_read_b64_tr_b16 a[242:243], v115 offset:800
v_mfma_f32_16x16x32_bf16 a[0:3], a[248:251], v[20:23], a[0:3]
s_add_u32 m0, s8, 36864
s_add_u32 s11, s6, 1032192
buffer_load_dwordx4 v244, s[36:39], s11 offen offset:0 lds
v_mfma_f32_16x16x32_bf16 v[36:39], a[252:255], v[148:151], v[36:39]
v_mfma_f32_16x16x32_bf16 v[60:63], a[252:255], v[204:207], v[60:63]
ds_read_b64_tr_b16 a[244:245], v115 offset:32
ds_read_b64_tr_b16 a[246:247], v114 offset:768
v_mfma_f32_16x16x32_bf16 a[4:7], a[252:255], v[20:23], a[4:7]
v_mfma_f32_16x16x32_bf16 v[40:43], a[224:227], v[148:151], v[40:43]
ds_read_b64_tr_b16 v[200:201], v120 offset:30784
ds_read_b64_tr_b16 v[202:203], v121 offset:30784
v_mfma_f32_16x16x32_bf16 v[64:67], a[224:227], v[204:207], v[64:67]
ds_read_b64_tr_b16 a[248:249], v114 offset:64
ds_read_b64_tr_b16 a[250:251], v115 offset:864
v_mfma_f32_16x16x32_bf16 a[8:11], a[224:227], v[20:23], a[8:11]
buffer_load_dwordx4 v245, s[36:39], s11 offen offset:1024 lds
v_mfma_f32_16x16x32_bf16 v[44:47], a[228:231], v[148:151], v[44:47]
v_mfma_f32_16x16x32_bf16 v[68:71], a[228:231], v[204:207], v[68:71]
ds_read_b64_tr_b16 a[252:253], v115 offset:96
ds_read_b64_tr_b16 a[254:255], v114 offset:832
v_mfma_f32_16x16x32_bf16 a[12:15], a[228:231], v[20:23], a[12:15]
v_mfma_f32_16x16x32_bf16 v[48:51], v[148:151], a[232:235], v[48:51]
v_mfma_f32_16x16x32_bf16 v[72:75], v[204:207], a[232:235], v[72:75]
ds_read_b64_tr_b16 a[224:225], v114 offset:128
ds_read_b64_tr_b16 a[226:227], v115 offset:928
v_mfma_f32_16x16x32_bf16 a[16:19], v[20:23], a[232:235], a[16:19]
buffer_load_dwordx4 v246, s[36:39], s11 offen offset:2048 lds
v_mfma_f32_16x16x32_bf16 v[52:55], v[148:151], a[236:239], v[52:55]
v_mfma_f32_16x16x32_bf16 v[76:79], v[204:207], a[236:239], v[76:79]
ds_read_b64_tr_b16 a[228:229], v115 offset:160
ds_read_b64_tr_b16 a[230:231], v114 offset:896
v_mfma_f32_16x16x32_bf16 a[20:23], v[20:23], a[236:239], a[20:23]
s_waitcnt lgkmcnt(6)
v_mfma_f32_16x16x32_bf16 v[32:35], a[240:243], v[152:155], v[32:35]
v_mfma_f32_16x16x32_bf16 v[56:59], a[240:243], v[208:211], v[56:59]
ds_read_b64_tr_b16 a[232:233], v114 offset:6144
ds_read_b64_tr_b16 a[234:235], v115 offset:6944
v_mfma_f32_16x16x32_bf16 a[0:3], a[240:243], v[20:23], a[0:3]
buffer_store_dwordx4 a[32:35], v2, s[24:27], s40 offen offset:0 sc1
v_mfma_f32_16x16x32_bf16 v[36:39], a[244:247], v[152:155], v[36:39]
v_mfma_f32_16x16x32_bf16 v[60:63], a[244:247], v[208:211], v[60:63]
ds_read_b64_tr_b16 a[236:237], v115 offset:6176
ds_read_b64_tr_b16 a[238:239], v114 offset:6912
v_mfma_f32_16x16x32_bf16 a[4:7], a[244:247], v[20:23], a[4:7]
v_mfma_f32_16x16x32_bf16 v[40:43], a[248:251], v[152:155], v[40:43]
ds_read_b64_tr_b16 v[204:205], v118 offset:64
ds_read_b64_tr_b16 v[206:207], v119 offset:64
v_mfma_f32_16x16x32_bf16 v[64:67], a[248:251], v[208:211], v[64:67]
ds_read_b64_tr_b16 a[240:241], v114 offset:6208
ds_read_b64_tr_b16 a[242:243], v115 offset:7008
v_mfma_f32_16x16x32_bf16 a[8:11], a[248:251], v[20:23], a[8:11]
buffer_store_dwordx4 a[36:39], v2, s[24:27], s40 offen offset:1024 sc1
s_waitcnt lgkmcnt(8)
v_mfma_f32_16x16x32_bf16 v[44:47], a[252:255], v[152:155], v[44:47]
v_mfma_f32_16x16x32_bf16 v[68:71], a[252:255], v[208:211], v[68:71]
ds_read_b64_tr_b16 a[244:245], v115 offset:6240
ds_read_b64_tr_b16 a[246:247], v114 offset:6976
v_mfma_f32_16x16x32_bf16 a[12:15], a[252:255], v[20:23], a[12:15]
v_mfma_f32_16x16x32_bf16 v[48:51], v[152:155], a[224:227], v[48:51]
v_mfma_f32_16x16x32_bf16 v[72:75], v[208:211], a[224:227], v[72:75]
ds_read_b64_tr_b16 a[248:249], v114 offset:6272
ds_read_b64_tr_b16 a[250:251], v115 offset:7072
v_mfma_f32_16x16x32_bf16 a[16:19], v[20:23], a[224:227], a[16:19]
buffer_store_dwordx4 a[40:43], v2, s[24:27], s41 offen offset:0 sc1
v_mfma_f32_16x16x32_bf16 v[52:55], v[152:155], a[228:231], v[52:55]
v_mfma_f32_16x16x32_bf16 v[76:79], v[208:211], a[228:231], v[76:79]
ds_read_b64_tr_b16 a[252:253], v115 offset:6304
ds_read_b64_tr_b16 a[254:255], v114 offset:7040
v_mfma_f32_16x16x32_bf16 a[20:23], v[20:23], a[228:231], a[20:23]
s_lshl_b32 s54, s46, 2
s_min_u32 s54, s54, 10
s_lshl_b32 s54, s54, 10
s_add_u32 s54, s54, 86016
v_add_u32 v26, s54, v2
v_lshrrev_b32 v27, 1, v7
v_and_b32 v28, 7, v1
v_xor_b32 v27, v27, v28
v_lshlrev_b32 v27, 4, v27
v_lshl_add_u32 v27, v6, 7, v27
v_and_b32 v28, 1, v7
v_lshl_add_u32 v27, v28, 3, v27
s_lshl_b32 s57, s46, 11
s_add_u32 s57, s57, 151552
v_add_u32 v27, s57, v27
v_xor_b32 v28, 32, v27
v_xor_b32_e64 v29, 64, v27
v_xor_b32 v30, 96, v27
v_lshlrev_b32_e64 v25, 11, v7
v_lshl_add_u32 v25, v6, 3, v25
s_waitcnt vmcnt(12)
ds_read_b128 v[80:83], v26 offset:0
ds_read_b128 v[84:87], v26 offset:1024
ds_read_b128 v[88:91], v26 offset:2048
ds_read_b128 v[92:95], v26 offset:3072
ds_read_b64 v[8:9], v27
ds_read_b64 v[10:11], v28
ds_read_b64 v[12:13], v29
ds_read_b64 v[14:15], v30
s_cmp_eq_u32 s46, 3
s_cselect_b64 vcc, -1, 0
s_waitcnt lgkmcnt(0)
v_cndmask_b32_e64 v80, v80, 0, vcc
v_cndmask_b32_e64 v81, v81, 0, vcc
v_cndmask_b32_e64 v82, v82, 0, vcc
v_cndmask_b32_e64 v83, v83, 0, vcc
v_cndmask_b32_e64 v84, v84, 0, vcc
v_cndmask_b32_e64 v85, v85, 0, vcc
v_cndmask_b32_e64 v86, v86, 0, vcc
v_cndmask_b32_e64 v87, v87, 0, vcc
v_dot2_f32_bf16 v100, v80, v20, 0
v_dot2_f32_bf16 v101, v80, v80, 0
v_dot2_f32_bf16 v100, v81, v20, v100
v_dot2_f32_bf16 v101, v81, v81, v101
v_dot2_f32_bf16 v100, v82, v20, v100
v_dot2_f32_bf16 v101, v82, v82, v101
v_dot2_f32_bf16 v100, v83, v20, v100
v_dot2_f32_bf16 v101, v83, v83, v101
v_dot2_f32_bf16 v100, v84, v20, v100
v_dot2_f32_bf16 v101, v84, v84, v101
v_dot2_f32_bf16 v100, v85, v20, v100
v_dot2_f32_bf16 v101, v85, v85, v101
v_dot2_f32_bf16 v100, v86, v20, v100
v_dot2_f32_bf16 v101, v86, v86, v101
v_dot2_f32_bf16 v100, v87, v20, v100
v_dot2_f32_bf16 v101, v87, v87, v101
v_dot2_f32_bf16 v100, v88, v20, v100
v_dot2_f32_bf16 v101, v88, v88, v101
v_dot2_f32_bf16 v100, v89, v20, v100
v_dot2_f32_bf16 v101, v89, v89, v101
v_dot2_f32_bf16 v100, v90, v20, v100
v_dot2_f32_bf16 v101, v90, v90, v101
v_dot2_f32_bf16 v100, v91, v20, v100
v_dot2_f32_bf16 v101, v91, v91, v101
v_dot2_f32_bf16 v100, v92, v20, v100
v_dot2_f32_bf16 v101, v92, v92, v101
v_dot2_f32_bf16 v100, v93, v20, v100
v_dot2_f32_bf16 v101, v93, v93, v101
v_dot2_f32_bf16 v100, v94, v20, v100
v_dot2_f32_bf16 v101, v94, v94, v101
v_dot2_f32_bf16 v100, v95, v20, v100
v_dot2_f32_bf16 v101, v95, v95, v101
s_nop 1
v_mov_b32 v106, v100
v_mov_b32 v107, v101
s_nop 0
v_permlane16_swap_b32 v100, v106
v_permlane16_swap_b32 v101, v107
v_add_f32 v100, v100, v106
v_add_f32 v101, v101, v107
v_mov_b32 v106, v100
v_mov_b32 v107, v101
s_nop 0
v_permlane32_swap_b32 v100, v106
v_permlane32_swap_b32 v101, v107
v_add_f32 v100, v100, v106
v_add_f32_e64 v101, v101, v107
s_lshl_b32 s54, s46, 7
s_add_u32 s54, s54, 162560
v_lshl_add_u32 v26, v6, 3, s54
ds_write_b64 v26, v[100:101]
s_waitcnt lgkmcnt(0)
s_waitcnt vmcnt(9)
s_barrier
v_mfma_f32_16x16x32_bf16 v[32:35], a[232:235], v[156:159], v[32:35]
v_mfma_f32_16x16x32_bf16 v[56:59], a[232:235], v[212:215], v[56:59]
ds_read_b64_tr_b16 a[224:225], v114 offset:12288
ds_read_b64_tr_b16 a[226:227], v115 offset:13088
v_mfma_f32_16x16x32_bf16 a[0:3], a[232:235], v[20:23], a[0:3]
buffer_store_dwordx4 a[44:47], v2, s[24:27], s41 offen offset:1024 sc1
ds_read_b64 v[100:101], v122
v_mfma_f32_16x16x32_bf16 v[36:39], a[236:239], v[156:159], v[36:39]
s_waitcnt lgkmcnt(0)
v_mov_b32 v102, v100
v_mfma_f32_16x16x32_bf16 v[60:63], a[236:239], v[212:215], v[60:63]
ds_read_b64_tr_b16 a[228:229], v115 offset:12320
ds_read_b64_tr_b16 a[230:231], v114 offset:13056
v_mfma_f32_16x16x32_bf16 a[4:7], a[236:239], v[20:23], a[4:7]
v_mov_b32_e64 v103, v101
v_mfma_f32_16x16x32_bf16 v[40:43], a[240:243], v[156:159], v[40:43]
ds_read_b64_tr_b16 v[208:209], v118 offset:6208
ds_read_b64_tr_b16 v[210:211], v119 offset:6208
v_mfma_f32_16x16x32_bf16 v[64:67], a[240:243], v[212:215], v[64:67]
ds_read_b64_tr_b16 a[232:233], v114 offset:12352
ds_read_b64_tr_b16 a[234:235], v115 offset:13152
v_mfma_f32_16x16x32_bf16 a[8:11], a[240:243], v[20:23], a[8:11]
buffer_store_dwordx4 a[48:51], v2, s[24:27], s43 offen offset:0 sc1
v_mfma_f32_16x16x32_bf16 v[44:47], a[244:247], v[156:159], v[44:47]
v_mfma_f32_16x16x32_bf16 v[68:71], a[244:247], v[212:215], v[68:71]
ds_read_b64_tr_b16 a[236:237], v115 offset:12384
ds_read_b64_tr_b16 a[238:239], v114 offset:13120
v_mfma_f32_16x16x32_bf16 a[12:15], a[244:247], v[20:23], a[12:15]
v_permlane16_swap_b32_e64 v100, v102
v_mfma_f32_16x16x32_bf16 v[48:51], v[156:159], a[248:251], v[48:51]
v_permlane16_swap_b32_e64 v101, v103
v_mfma_f32_16x16x32_bf16 v[72:75], v[212:215], a[248:251], v[72:75]
ds_read_b64_tr_b16 a[240:241], v114 offset:12416
ds_read_b64_tr_b16 a[242:243], v115 offset:13216
v_mfma_f32_16x16x32_bf16 a[16:19], v[20:23], a[248:251], a[16:19]
buffer_store_dwordx4 a[52:55], v2, s[24:27], s43 offen offset:1024 sc1
v_add_f32_e64 v100, v100, v102
v_mfma_f32_16x16x32_bf16 v[52:55], v[156:159], a[252:255], v[52:55]
v_add_f32 v101, v101, v103
v_mov_b32 v102, v100
v_mfma_f32_16x16x32_bf16 v[76:79], v[212:215], a[252:255], v[76:79]
ds_read_b64_tr_b16 a[244:245], v115 offset:12448
ds_read_b64_tr_b16 a[246:247], v114 offset:13184
v_mfma_f32_16x16x32_bf16 a[20:23], v[20:23], a[252:255], a[20:23]
v_mov_b32 v103, v101
s_waitcnt lgkmcnt(6)
v_mfma_f32_16x16x32_bf16 v[32:35], a[224:227], v[160:163], v[32:35]
v_mfma_f32_16x16x32_bf16 v[56:59], a[224:227], v[216:219], v[56:59]
ds_read_b64_tr_b16 a[248:249], v114 offset:18432
ds_read_b64_tr_b16 a[250:251], v115 offset:19232
v_mfma_f32_16x16x32_bf16 a[0:3], a[224:227], v[20:23], a[0:3]
buffer_store_dwordx4 a[56:59], v2, s[24:27], s22 offen offset:0 sc1
v_mfma_f32_16x16x32_bf16 v[36:39], a[228:231], v[160:163], v[36:39]
v_permlane32_swap_b32_e64 v100, v102
v_mfma_f32_16x16x32_bf16 v[60:63], a[228:231], v[216:219], v[60:63]
ds_read_b64_tr_b16 a[252:253], v115 offset:18464
ds_read_b64_tr_b16 a[254:255], v114 offset:19200
v_mfma_f32_16x16x32_bf16 a[4:7], a[228:231], v[20:23], a[4:7]
v_permlane32_swap_b32_e64 v101, v103
v_mfma_f32_16x16x32_bf16 v[40:43], a[232:235], v[160:163], v[40:43]
ds_read_b64_tr_b16 v[212:213], v118 offset:12352
ds_read_b64_tr_b16 v[214:215], v119 offset:12352
v_mfma_f32_16x16x32_bf16 v[64:67], a[232:235], v[216:219], v[64:67]
ds_read_b64_tr_b16 a[224:225], v114 offset:18496
ds_read_b64_tr_b16 a[226:227], v115 offset:19296
v_mfma_f32_16x16x32_bf16 a[8:11], a[232:235], v[20:23], a[8:11]
buffer_store_dwordx4 a[60:63], v2, s[24:27], s22 offen offset:1024 sc1
v_add_f32 v100, v100, v102
s_waitcnt lgkmcnt(8)
v_mfma_f32_16x16x32_bf16 v[44:47], a[236:239], v[160:163], v[44:47]
v_add_f32_e64 v101, v101, v103
v_mfma_f32_16x16x32_bf16 v[68:71], a[236:239], v[216:219], v[68:71]
ds_read_b64_tr_b16 a[228:229], v115 offset:18528
ds_read_b64_tr_b16 a[230:231], v114 offset:19264
v_mfma_f32_16x16x32_bf16 a[12:15], a[236:239], v[20:23], a[12:15]
v_mul_f32 v112, 0xbb124925, v100
v_mul_f32_e64 v102, v112, v112
v_mfma_f32_16x16x32_bf16 v[48:51], v[160:163], a[240:243], v[48:51]
v_fma_f32 v102, v101, s100, -v102
v_max_f32_e64 v102, 0, v102
v_mfma_f32_16x16x32_bf16 v[72:75], v[216:219], a[240:243], v[72:75]
ds_read_b64_tr_b16 a[232:233], v114 offset:18560
ds_read_b64_tr_b16 a[234:235], v115 offset:19360
v_mfma_f32_16x16x32_bf16 a[16:19], v[20:23], a[240:243], a[16:19]
s_mov_b32 exec_hi, 0
buffer_store_dword a64, v127, s[24:27], s42 offen sc1
buffer_store_dword a80, v127, s[24:27], s23 offen sc1
s_mov_b32 exec_hi, -1
v_mfma_f32_16x16x32_bf16 v[52:55], v[160:163], a[244:247], v[52:55]
v_add_f32 v102, 0x3727c5ac, v102
v_mfma_f32_16x16x32_bf16 v[76:79], v[216:219], a[244:247], v[76:79]
ds_read_b64_tr_b16 a[236:237], v115 offset:18592
ds_read_b64_tr_b16 a[238:239], v114 offset:19328
v_mfma_f32_16x16x32_bf16 a[20:23], v[20:23], a[244:247], a[20:23]
v_rsq_f32 v113, v102
s_waitcnt vmcnt(13)
s_barrier
s_waitcnt lgkmcnt(6)
v_mfma_f32_16x16x32_bf16 v[32:35], a[248:251], v[164:167], v[32:35]
v_mfma_f32_16x16x32_bf16 v[56:59], a[248:251], v[220:223], v[56:59]
ds_read_b64_tr_b16 a[240:241], v114 offset:24576
ds_read_b64_tr_b16 a[242:243], v115 offset:25376
v_mfma_f32_16x16x32_bf16 a[0:3], a[248:251], v[20:23], a[0:3]
v_lshlrev_b32 v30, 7, v6
s_lshl_b32 s13, s44, 11
s_add_u32 s13, s13, 8192
buffer_load_dword v18, v30, s[24:27], s13 offen sc1
v_mfma_f32_16x16x32_bf16 v[36:39], a[252:255], v[164:167], v[36:39]
v_mfma_f32_16x16x32_bf16 v[60:63], a[252:255], v[220:223], v[60:63]
ds_read_b64_tr_b16 a[244:245], v115 offset:24608
ds_read_b64_tr_b16 a[246:247], v114 offset:25344
v_mfma_f32_16x16x32_bf16 a[4:7], a[252:255], v[20:23], a[4:7]
v_mfma_f32_16x16x32_bf16 v[40:43], a[224:227], v[164:167], v[40:43]
ds_read_b64_tr_b16 v[216:217], v118 offset:18496
ds_read_b64_tr_b16 v[218:219], v119 offset:18496
v_mfma_f32_16x16x32_bf16 v[64:67], a[224:227], v[220:223], v[64:67]
ds_read_b64_tr_b16 a[248:249], v114 offset:24640
ds_read_b64_tr_b16 a[250:251], v115 offset:25440
v_mfma_f32_16x16x32_bf16 a[8:11], a[224:227], v[20:23], a[8:11]
s_add_u32 m0, s5, 102400
s_add_u32 s11, s89, 100352
buffer_load_dwordx4 v19, s[16:19], s11 offen  lds
s_waitcnt lgkmcnt(8)
v_mfma_f32_16x16x32_bf16 v[44:47], a[228:231], v[164:167], v[44:47]
v_mfma_f32_16x16x32_bf16 v[68:71], a[228:231], v[220:223], v[68:71]
ds_read_b64_tr_b16 a[252:253], v115 offset:24672
ds_read_b64_tr_b16 a[254:255], v114 offset:25408
v_mfma_f32_16x16x32_bf16 a[12:15], a[228:231], v[20:23], a[12:15]
v_mfma_f32_16x16x32_bf16 v[48:51], v[164:167], a[232:235], v[48:51]
v_mfma_f32_16x16x32_bf16 v[72:75], v[220:223], a[232:235], v[72:75]
ds_read_b64_tr_b16 a[224:225], v114 offset:24704
ds_read_b64_tr_b16 a[226:227], v115 offset:25504
v_mfma_f32_16x16x32_bf16 a[16:19], v[20:23], a[232:235], a[16:19]
s_add_u32 m0, s5, 103424
s_add_u32 s11, s89, 107520
buffer_load_dwordx4 v19, s[16:19], s11 offen  lds
v_mfma_f32_16x16x32_bf16 v[52:55], v[164:167], a[236:239], v[52:55]
v_mfma_f32_16x16x32_bf16 v[76:79], v[220:223], a[236:239], v[76:79]
ds_read_b64_tr_b16 a[228:229], v115 offset:24736
ds_read_b64_tr_b16 a[230:231], v114 offset:25472
v_mfma_f32_16x16x32_bf16 a[20:23], v[20:23], a[236:239], a[20:23]
s_waitcnt lgkmcnt(6)
v_mfma_f32_16x16x32_bf16 v[32:35], a[240:243], v[168:171], v[32:35]
v_mfma_f32_16x16x32_bf16 v[56:59], a[240:243], v[224:227], v[56:59]
ds_read_b64_tr_b16 a[232:233], v114 offset:30720
ds_read_b64_tr_b16 a[234:235], v115 offset:31520
v_mfma_f32_16x16x32_bf16 a[0:3], a[240:243], v[20:23], a[0:3]
s_add_u32 m0, s5, 104448
s_add_u32 s11, s89, 114688
buffer_load_dwordx4 v19, s[16:19], s11 offen  lds
v_mfma_f32_16x16x32_bf16 v[36:39], a[244:247], v[168:171], v[36:39]
v_mfma_f32_16x16x32_bf16 v[60:63], a[244:247], v[224:227], v[60:63]
ds_read_b64_tr_b16 a[236:237], v115 offset:30752
ds_read_b64_tr_b16 a[238:239], v114 offset:31488
v_mfma_f32_16x16x32_bf16 a[4:7], a[244:247], v[20:23], a[4:7]
v_mfma_f32_16x16x32_bf16 v[40:43], a[248:251], v[168:171], v[40:43]
ds_read_b64_tr_b16 v[220:221], v118 offset:24640
ds_read_b64_tr_b16 v[222:223], v119 offset:24640
v_mfma_f32_16x16x32_bf16 v[64:67], a[248:251], v[224:227], v[64:67]
ds_read_b64_tr_b16 a[240:241], v114 offset:30784
ds_read_b64_tr_b16 a[242:243], v115 offset:31584
v_mfma_f32_16x16x32_bf16 a[8:11], a[248:251], v[20:23], a[8:11]
s_add_u32 m0, s5, 105472
s_add_u32 s11, s89, 121856
buffer_load_dwordx4 v19, s[16:19], s11 offen  lds
s_waitcnt lgkmcnt(8)
v_mfma_f32_16x16x32_bf16 v[44:47], a[252:255], v[168:171], v[44:47]
v_mfma_f32_16x16x32_bf16 v[68:71], a[252:255], v[224:227], v[68:71]
ds_read_b64_tr_b16 a[244:245], v115 offset:30816
ds_read_b64_tr_b16 a[246:247], v114 offset:31552
v_mfma_f32_16x16x32_bf16 a[12:15], a[252:255], v[20:23], a[12:15]
v_mfma_f32_16x16x32_bf16 v[48:51], v[168:171], a[224:227], v[48:51]
v_mfma_f32_16x16x32_bf16 v[72:75], v[224:227], a[224:227], v[72:75]
ds_read_b64_tr_b16 a[248:249], v114 offset:30848
ds_read_b64_tr_b16 a[250:251], v115 offset:31648
v_mfma_f32_16x16x32_bf16 a[16:19], v[20:23], a[224:227], a[16:19]
s_add_u32 m0, s5, 118784
s_add_u32 s11, s89, 200704
buffer_load_dwordx4 v19, s[16:19], s11 offen  lds
v_mfma_f32_16x16x32_bf16 v[52:55], v[168:171], a[228:231], v[52:55]
v_mfma_f32_16x16x32_bf16 v[76:79], v[224:227], a[228:231], v[76:79]
ds_read_b64_tr_b16 a[252:253], v115 offset:30880
ds_read_b64_tr_b16 a[254:255], v114 offset:31616
v_mfma_f32_16x16x32_bf16 a[20:23], v[20:23], a[228:231], a[20:23]
s_waitcnt vmcnt(5)
s_barrier
v_cmp_ne_u32_e64 vcc, s63, v18
s_cmp_eq_u64 vcc, 0
s_cselect_b32 s52, 0, 1
s_cmp_lg_u32 s46, 0
s_cselect_b32 s52, 2, s52
s_and_b32 s63, s52, 1
s_lshl_b32 s63, s63, 30
s_cmp_lg_u32 s46, 3
s_cbranch_scc1 L2
s_lshl_b32 s54, s45, 11
s_lshl_b32 s55, s44, 7
s_add_u32 s54, s54, s55
s_add_u32 s54, s54, 360448
v_mov_b32 v18, s51
s_mov_b64 exec, 1
buffer_store_dword v18, off, s[24:27], s54 sc1
s_mov_b64 exec, -1
L2:
s_waitcnt lgkmcnt(6)
v_mfma_f32_16x16x32_bf16 v[32:35], a[232:235], v[172:175], v[32:35]
s_add_u32 m0, s5, 119808
s_add_u32 s11, s89, 207872
buffer_load_dwordx4 v19, s[16:19], s11 offen  lds
v_mfma_f32_16x16x32_bf16 v[56:59], a[232:235], v[228:231], v[56:59]
ds_read_b64_tr_b16 a[224:225], v114 offset:36864
ds_read_b64_tr_b16 a[226:227], v115 offset:37664
v_mfma_f32_16x16x32_bf16 a[0:3], a[232:235], v[20:23], a[0:3]
v_mfma_f32_16x16x32_bf16 v[36:39], a[236:239], v[172:175], v[36:39]
v_mfma_f32_16x16x32_bf16 v[60:63], a[236:239], v[228:231], v[60:63]
ds_read_b64_tr_b16 a[228:229], v115 offset:36896
ds_read_b64_tr_b16 a[230:231], v114 offset:37632
v_mfma_f32_16x16x32_bf16 a[4:7], a[236:239], v[20:23], a[4:7]
s_add_u32 m0, s5, 120832
s_add_u32 s11, s89, 215040
buffer_load_dwordx4 v19, s[16:19], s11 offen  lds
v_mfma_f32_16x16x32_bf16 v[40:43], a[240:243], v[172:175], v[40:43]
ds_read_b64_tr_b16 v[224:225], v118 offset:30784
ds_read_b64_tr_b16 v[226:227], v119 offset:30784
v_mfma_f32_16x16x32_bf16 v[64:67], a[240:243], v[228:231], v[64:67]
ds_read_b64_tr_b16 a[232:233], v114 offset:36928
ds_read_b64_tr_b16 a[234:235], v115 offset:37728
v_mfma_f32_16x16x32_bf16 a[8:11], a[240:243], v[20:23], a[8:11]
s_waitcnt lgkmcnt(8)
v_mfma_f32_16x16x32_bf16 v[44:47], a[244:247], v[172:175], v[44:47]
v_mfma_f32_16x16x32_bf16 v[68:71], a[244:247], v[228:231], v[68:71]
ds_read_b64_tr_b16 a[236:237], v115 offset:36960
ds_read_b64_tr_b16 a[238:239], v114 offset:37696
v_mfma_f32_16x16x32_bf16 a[12:15], a[244:247], v[20:23], a[12:15]
s_add_u32 m0, s5, 121856
s_add_u32 s11, s89, 222208
buffer_load_dwordx4 v19, s[16:19], s11 offen  lds
v_mfma_f32_16x16x32_bf16 v[48:51], v[172:175], a[248:251], v[48:51]
v_mfma_f32_16x16x32_bf16 v[72:75], v[228:231], a[248:251], v[72:75]
ds_read_b64_tr_b16 a[240:241], v114 offset:36992
ds_read_b64_tr_b16 a[242:243], v115 offset:37792
v_mfma_f32_16x16x32_bf16 a[16:19], v[20:23], a[248:251], a[16:19]
v_mfma_f32_16x16x32_bf16 v[52:55], v[172:175], a[252:255], v[52:55]
v_mfma_f32_16x16x32_bf16 v[76:79], v[228:231], a[252:255], v[76:79]
ds_read_b64_tr_b16 a[244:245], v115 offset:37024
ds_read_b64_tr_b16 a[246:247], v114 offset:37760
v_mfma_f32_16x16x32_bf16 a[20:23], v[20:23], a[252:255], a[20:23]
s_add_u32 m0, s5, 135168
s_add_u32 s11, s89, 301056
buffer_load_dwordx4 v19, s[16:19], s11 offen  lds
s_waitcnt lgkmcnt(6)
v_mfma_f32_16x16x32_bf16 v[32:35], a[224:227], v[176:179], v[32:35]
ds_read_b128 v[128:131], v3 offset:20480
v_mfma_f32_16x16x32_bf16 v[56:59], a[224:227], v[232:235], v[56:59]
ds_read_b64_tr_b16 a[248:249], v114 offset:43008
ds_read_b64_tr_b16 a[250:251], v115 offset:43808
v_mfma_f32_16x16x32_bf16 a[0:3], a[224:227], v[20:23], a[0:3]
v_mfma_f32_16x16x32_bf16 v[36:39], a[228:231], v[176:179], v[36:39]
ds_read_b128 v[132:135], v3 offset:21504
v_mfma_f32_16x16x32_bf16 v[60:63], a[228:231], v[232:235], v[60:63]
ds_read_b64_tr_b16 a[252:253], v115 offset:43040
ds_read_b64_tr_b16 a[254:255], v114 offset:43776
v_mfma_f32_16x16x32_bf16 a[4:7], a[228:231], v[20:23], a[4:7]
s_add_u32 m0, s5, 136192
s_add_u32 s11, s89, 308224
buffer_load_dwordx4 v19, s[16:19], s11 offen  lds
v_mfma_f32_16x16x32_bf16 v[40:43], a[232:235], v[176:179], v[40:43]
ds_read_b64_tr_b16 v[228:229], v118 offset:36928
ds_read_b64_tr_b16 v[230:231], v119 offset:36928
v_mfma_f32_16x16x32_bf16 v[64:67], a[232:235], v[232:235], v[64:67]
ds_read_b64_tr_b16 a[224:225], v114 offset:43072
ds_read_b64_tr_b16 a[226:227], v115 offset:43872
v_mfma_f32_16x16x32_bf16 a[8:11], a[232:235], v[20:23], a[8:11]
s_waitcnt lgkmcnt(10)
v_mfma_f32_16x16x32_bf16 v[44:47], a[236:239], v[176:179], v[44:47]
ds_read_b128 v[136:139], v3 offset:22528
v_mfma_f32_16x16x32_bf16 v[68:71], a[236:239], v[232:235], v[68:71]
ds_read_b64_tr_b16 a[228:229], v115 offset:43104
ds_read_b64_tr_b16 a[230:231], v114 offset:43840
v_mfma_f32_16x16x32_bf16 a[12:15], a[236:239], v[20:23], a[12:15]
s_add_u32 m0, s5, 137216
s_add_u32 s11, s89, 315392
buffer_load_dwordx4 v19, s[16:19], s11 offen  lds
v_mfma_f32_16x16x32_bf16 v[48:51], v[176:179], a[240:243], v[48:51]
ds_read_b128 v[140:143], v3 offset:23552
v_mfma_f32_16x16x32_bf16 v[72:75], v[232:235], a[240:243], v[72:75]
ds_read_b64_tr_b16 a[232:233], v114 offset:43136
ds_read_b64_tr_b16 a[234:235], v115 offset:43936
v_mfma_f32_16x16x32_bf16 a[16:19], v[20:23], a[240:243], a[16:19]
v_mfma_f32_16x16x32_bf16 v[52:55], v[176:179], a[244:247], v[52:55]
ds_read_b128 v[144:147], v3 offset:24576
v_mfma_f32_16x16x32_bf16 v[76:79], v[232:235], a[244:247], v[76:79]
ds_read_b64_tr_b16 a[236:237], v115 offset:43168
ds_read_b64_tr_b16 a[238:239], v114 offset:43904
v_mfma_f32_16x16x32_bf16 a[20:23], v[20:23], a[244:247], a[20:23]
s_add_u32 m0, s5, 138240
s_add_u32 s11, s89, 322560
buffer_load_dwordx4 v19, s[16:19], s11 offen  lds
s_waitcnt lgkmcnt(9)
v_mfma_f32_16x16x32_bf16 v[32:35], a[248:251], v[180:183], v[32:35]
ds_read_b128 v[148:151], v3 offset:25600
ds_read_b128 v[152:155], v3 offset:26624
v_mfma_f32_16x16x32_bf16 v[56:59], a[248:251], v[236:239], v[56:59]
ds_read_b128 v[156:159], v3 offset:27648
ds_read_b128 v[160:163], v3 offset:28672
v_mfma_f32_16x16x32_bf16 a[0:3], a[248:251], v[20:23], a[0:3]
v_mfma_f32_16x16x32_bf16 v[36:39], a[252:255], v[180:183], v[36:39]
ds_read_b128 v[164:167], v3 offset:29696
ds_read_b128 v[168:171], v3 offset:30720
v_mfma_f32_16x16x32_bf16 v[60:63], a[252:255], v[236:239], v[60:63]
ds_read_b128 v[172:175], v3 offset:31744
ds_read_b128 v[248:251], v3 offset:32768
v_mfma_f32_16x16x32_bf16 a[4:7], a[252:255], v[20:23], a[4:7]
s_cmp_eq_u32 s45, 11
s_cselect_b32 s13, 7, s45
s_lshl2_add_u32 s14, s13, s46
s_and_b32 s15, s14, 15
s_lshl_b32 s15, s15, 13
s_lshr_b32 s14, s14, 4
s_mul_i32 s14, s14, 4194304
s_add_u32 s14, s14, s15
s_add_u32 s14, s14, s60
s_add_u32 s14, s14, 8388608
s_cmp_eq_u32 s45, 7
s_cselect_b32 s13, 9, s13
s_cmp_ge_u32 s13, 8
s_cselect_b32 s14, 0x40000000, s14
v_lshlrev_b32_e64 v30, 7, v1
buffer_load_dword v16, v30, s[24:27], s14 offen sc1
v_lshlrev_b32 v30, 15, v1
s_lshl_b32 s13, s44, 11
s_lshl_b32 s14, s45, 7
s_add_u32 s13, s13, s14
s_add_u32 s13, s13, 65536
s_cmp_lg_u32 s46, 0
s_cselect_b32 s13, 0x40000000, s13
s_mov_b64 exec, 0x7f
buffer_load_dword v16, v30, s[24:27], s13 offen sc1
s_mov_b64 exec, -1
v_and_b32 v30, 7, v1
v_min_u32 v30, 7, v30
v_lshlrev_b32 v30, 7, v30
v_bfe_u32 v31, v1, 3, 1
s_mov_b32 s14, 57344
v_mad_u32_u24 v30, v31, s14, v30
s_mul_i32 s13, s46, 114688
s_mul_i32 s15, s45, 3584
s_add_u32 s13, s13, s15
s_add_u32 s13, s13, s61
s_add_u32 s13, s13, 20971520
s_mov_b64 exec, 0xffff
buffer_load_dword v16, v30, s[24:27], s13 offen offset:2560 sc1
s_mov_b64 exec, -1
v_mfma_f32_16x16x32_bf16 v[40:43], a[224:227], v[180:183], v[40:43]
ds_read_b64_tr_b16 v[232:233], v118 offset:43072
ds_read_b64_tr_b16 v[234:235], v119 offset:43072
ds_read_b128 v[252:255], v3 offset:33792
v_mfma_f32_16x16x32_bf16 v[64:67], a[224:227], v[236:239], v[64:67]
v_mfma_f32_16x16x32_bf16 a[8:11], a[224:227], v[20:23], a[8:11]
s_waitcnt lgkmcnt(11)
v_mfma_f32_16x16x32_bf16 v[44:47], a[228:231], v[180:183], v[44:47]
v_mfma_f32_16x16x32_bf16 v[68:71], a[228:231], v[236:239], v[68:71]
v_mfma_f32_16x16x32_bf16 a[12:15], a[228:231], v[20:23], a[12:15]
v_mfma_f32_16x16x32_bf16 v[48:51], v[180:183], a[232:235], v[48:51]
v_mfma_f32_16x16x32_bf16 v[72:75], v[236:239], a[232:235], v[72:75]
v_mfma_f32_16x16x32_bf16 a[16:19], v[20:23], a[232:235], a[16:19]
v_mfma_f32_16x16x32_bf16 v[52:55], v[180:183], a[236:239], v[52:55]
v_mfma_f32_16x16x32_bf16 v[76:79], v[236:239], a[236:239], v[76:79]
v_mfma_f32_16x16x32_bf16 a[20:23], v[20:23], a[236:239], a[20:23]
v_lshlrev_b32_e64 v26, 4, v7
v_add_u32 v26, 159744, v26
v_lshlrev_b32 v27, 2, v6
v_add_u32 v27, 159744, v27
s_waitcnt lgkmcnt(0)
v_mfma_f32_16x16x32_bf16 v[80:83], v[240:243], v[128:131], 0
v_accvgpr_read_b32 v84, a0
v_accvgpr_read_b32 v85, a1
v_mfma_f32_16x16x32_bf16 v[80:83], v[184:187], v[132:135], v[80:83]
v_accvgpr_read_b32 v86, a2
v_accvgpr_read_b32 v87, a3
v_mfma_f32_16x16x32_bf16 v[80:83], v[188:191], v[136:139], v[80:83]
v_accvgpr_read_b32 v88, a4
v_accvgpr_read_b32 v89, a5
v_mfma_f32_16x16x32_bf16 v[80:83], v[192:195], v[140:143], v[80:83]
v_accvgpr_read_b32 v90, a6
v_accvgpr_read_b32 v91, a7
v_mfma_f32_16x16x32_bf16 v[80:83], v[196:199], v[144:147], v[80:83]
v_accvgpr_read_b32 v92, a8
v_accvgpr_read_b32 v93, a9
v_mfma_f32_16x16x32_bf16 v[80:83], v[200:203], v[148:151], v[80:83]
v_accvgpr_read_b32 v94, a10
v_accvgpr_read_b32 v95, a11
v_mfma_f32_16x16x32_bf16 v[80:83], v[204:207], v[152:155], v[80:83]
v_accvgpr_read_b32 v96, a12
v_accvgpr_read_b32 v97, a13
v_mfma_f32_16x16x32_bf16 v[80:83], v[208:211], v[156:159], v[80:83]
v_accvgpr_read_b32 v98, a14
v_accvgpr_read_b32 v99, a15
v_mfma_f32_16x16x32_bf16 v[80:83], v[212:215], v[160:163], v[80:83]
v_accvgpr_read_b32 v122, a16
v_accvgpr_read_b32 v123, a20
v_mfma_f32_16x16x32_bf16 v[80:83], v[216:219], v[164:167], v[80:83]
ds_write_b128 v26, v[84:87] offset:0
ds_write_b128 v26, v[88:91] offset:64
v_mfma_f32_16x16x32_bf16 v[80:83], v[220:223], v[168:171], v[80:83]
ds_write_b128 v26, v[92:95] offset:128
ds_write_b128 v26, v[96:99] offset:192
v_mfma_f32_16x16x32_bf16 v[80:83], v[224:227], v[172:175], v[80:83]
ds_write_b32 v27, v122 offset:256
ds_write_b32 v27, v123 offset:320
v_mfma_f32_16x16x32_bf16 v[80:83], v[228:231], v[248:251], v[80:83]
s_lshl_b32 s54, s46, 6
v_add_u32 v26, s54, v26
v_mfma_f32_16x16x32_bf16 v[80:83], v[232:235], v[252:255], v[80:83]
ds_read_b128 v[176:179], v26 offset:128
ds_read_b128 v[114:117], v124 offset:64
ds_read_b128 v[118:121], v124 offset:704
ds_read_b128 v[100:103], v124
ds_read_b128 v[104:107], v124 offset:640
s_lshl_b32 s54, s46, 11
s_add_u32 s54, s54, 151552
s_cmp_eq_u32 s46, 3
s_cselect_b32 s54, 161792, s54
v_add_u32_e64 v126, s54, v2
v_lshl_add_u32 v127, v1, 3, s54
v_lshlrev_b32 v26, 5, v6
v_lshl_add_u32 v26, v7, 3, v26
s_lshl_b32 s54, s46, 3
s_lshl_b32 s55, s46, 9
s_cmp_ge_u32 s46, 2
s_cselect_b64 vcc, -1, 0
s_cselect_b32 s54, s55, s54
s_add_u32 s54, s54, 157696
v_cndmask_b32_e64 v125, v2, v26, vcc
v_add_u32 v125, s54, v125
s_waitcnt lgkmcnt(0)
s_barrier
s_add_u32 m0, s5, 86016
s_add_u32 s11, s89, 0
buffer_load_dwordx4 v19, s[16:19], s11 offen  lds
v_pk_fma_f32 v[80:81], v[176:177], v[112:113], v[80:81] op_sel_hi:[1,0,1]
v_pk_fma_f32 v[82:83], v[178:179], v[112:113], v[82:83] op_sel_hi:[1,0,1]
v_pk_mul_f32 v[80:81], v[80:81], v[112:113] op_sel:[0,1] op_sel_hi:[1,1]
v_pk_mul_f32 v[82:83], v[82:83], v[112:113] op_sel:[0,1] op_sel_hi:[1,1]
v_cvt_pk_bf16_f32 v80, v80, v81
v_cvt_pk_bf16_f32 v81, v82, v83
ds_write_b64 v125, v[80:81]
v_pk_fma_f32 v[64:65], v[92:93], v[110:111], v[64:65] op_sel_hi:[1,0,1]
v_pk_fma_f32 v[66:67], v[94:95], v[110:111], v[66:67] op_sel_hi:[1,0,1]
v_pk_mul_f32 v[64:65], v[64:65], v[110:111] op_sel:[0,1] op_sel_hi:[1,1]
v_pk_mul_f32 v[66:67], v[66:67], v[110:111] op_sel:[0,1] op_sel_hi:[1,1]
v_cvt_pk_bf16_f32 v64, v64, v65
v_cvt_pk_bf16_f32 v65, v66, v67
v_pk_fma_f32 v[68:69], v[96:97], v[110:111], v[68:69] op_sel_hi:[1,0,1]
v_pk_fma_f32 v[70:71], v[98:99], v[110:111], v[70:71] op_sel_hi:[1,0,1]
v_pk_mul_f32 v[68:69], v[68:69], v[110:111] op_sel:[0,1] op_sel_hi:[1,1]
v_pk_mul_f32 v[70:71], v[70:71], v[110:111] op_sel:[0,1] op_sel_hi:[1,1]
v_cvt_pk_bf16_f32 v66, v68, v69
v_cvt_pk_bf16_f32 v67, v70, v71
s_add_u32 m0, s5, 87040
s_add_u32 s11, s89, 7168
buffer_load_dwordx4 v19, s[16:19], s11 offen  lds
ds_write_b128 v126, v[64:67]
v_pk_fma_f32 v[72:73], v[114:115], v[122:123], v[72:73] op_sel:[0,0,0] op_sel_hi:[1,0,1]
v_pk_fma_f32 v[74:75], v[116:117], v[122:123], v[74:75] op_sel:[0,0,0] op_sel_hi:[1,0,1]
v_pk_mul_f32 v[72:73], v[72:73], v[118:119]
v_pk_mul_f32 v[74:75], v[74:75], v[120:121]
v_cvt_pk_bf16_f32 v248, v72, v73
v_cvt_pk_bf16_f32 v249, v74, v75
ds_write_b64 v127, v[248:249] offset:1024
v_pk_fma_f32 v[76:77], v[114:115], v[122:123], v[76:77] op_sel:[0,1,0] op_sel_hi:[1,1,1]
v_pk_fma_f32 v[78:79], v[116:117], v[122:123], v[78:79] op_sel:[0,1,0] op_sel_hi:[1,1,1]
v_pk_mul_f32 v[76:77], v[76:77], v[118:119]
v_pk_mul_f32 v[78:79], v[78:79], v[120:121]
v_cvt_pk_bf16_f32 v254, v76, v77
v_cvt_pk_bf16_f32 v255, v78, v79
ds_write_b64 v127, v[254:255] offset:1536
v_pk_fma_f32 v[40:41], v[92:93], v[108:109], v[40:41] op_sel_hi:[1,0,1]
v_pk_fma_f32 v[42:43], v[94:95], v[108:109], v[42:43] op_sel_hi:[1,0,1]
v_pk_mul_f32 v[40:41], v[40:41], v[108:109] op_sel:[0,1] op_sel_hi:[1,1]
v_pk_mul_f32 v[42:43], v[42:43], v[108:109] op_sel:[0,1] op_sel_hi:[1,1]
v_cvt_pk_bf16_f32 v40, v40, v41
v_cvt_pk_bf16_f32 v41, v42, v43
s_add_u32 m0, s5, 88064
s_add_u32 s11, s89, 14336
buffer_load_dwordx4 v19, s[16:19], s11 offen  lds
v_pk_fma_f32 v[44:45], v[96:97], v[108:109], v[44:45] op_sel_hi:[1,0,1]
v_pk_fma_f32 v[46:47], v[98:99], v[108:109], v[46:47] op_sel_hi:[1,0,1]
v_pk_mul_f32 v[44:45], v[44:45], v[108:109] op_sel:[0,1] op_sel_hi:[1,1]
v_pk_mul_f32 v[46:47], v[46:47], v[108:109] op_sel:[0,1] op_sel_hi:[1,1]
v_cvt_pk_bf16_f32 v42, v44, v45
v_cvt_pk_bf16_f32 v43, v46, v47
v_pk_fma_f32 v[32:33], v[84:85], v[108:109], v[32:33] op_sel_hi:[1,0,1]
v_pk_fma_f32 v[34:35], v[86:87], v[108:109], v[34:35] op_sel_hi:[1,0,1]
v_cvt_pk_bf16_f32 v32, v32, v33
v_cvt_pk_bf16_f32 v33, v34, v35
v_pk_fma_f32 v[36:37], v[88:89], v[108:109], v[36:37] op_sel_hi:[1,0,1]
v_pk_fma_f32 v[38:39], v[90:91], v[108:109], v[38:39] op_sel_hi:[1,0,1]
v_cvt_pk_bf16_f32 v34, v36, v37
v_cvt_pk_bf16_f32 v35, v38, v39
v_cndmask_b32_e64 v34, v34, 0, s[20:21]
v_cndmask_b32_e64 v35, v35, 0, s[20:21]
v_pk_fma_f32 v[56:57], v[84:85], v[110:111], v[56:57] op_sel_hi:[1,0,1]
v_pk_fma_f32 v[58:59], v[86:87], v[110:111], v[58:59] op_sel_hi:[1,0,1]
v_cvt_pk_bf16_f32 v56, v56, v57
v_cvt_pk_bf16_f32 v57, v58, v59
s_add_u32 m0, s5, 89088
s_add_u32 s11, s89, 21504
buffer_load_dwordx4 v19, s[16:19], s11 offen  lds
v_pk_fma_f32 v[60:61], v[88:89], v[110:111], v[60:61] op_sel_hi:[1,0,1]
v_pk_fma_f32 v[62:63], v[90:91], v[110:111], v[62:63] op_sel_hi:[1,0,1]
v_cvt_pk_bf16_f32 v58, v60, v61
v_cvt_pk_bf16_f32 v59, v62, v63
v_cndmask_b32_e64 v58, v58, 0, s[20:21]
v_cndmask_b32_e64 v59, v59, 0, s[20:21]
s_sub_u32 s54, s46, 1
s_and_b32 s54, s54, 3
s_lshl_b32 s54, s54, 11
s_add_u32 s54, s54, 151552
v_add_u32 v28, s54, v2
v_lshl_add_u32 v29, v1, 3, s54
s_waitcnt lgkmcnt(0)
s_barrier
ds_read_b128 v[240:243], v28
ds_read_b64 v[244:245], v29 offset:1024
ds_read_b64 v[250:251], v29 offset:1536
v_pk_fma_f32 v[48:49], v[100:101], v[122:123], v[48:49] op_sel:[0,0,0] op_sel_hi:[1,0,1]
v_pk_fma_f32 v[50:51], v[102:103], v[122:123], v[50:51] op_sel:[0,0,0] op_sel_hi:[1,0,1]
v_pk_mul_f32 v[48:49], v[48:49], v[104:105]
v_pk_mul_f32 v[50:51], v[50:51], v[106:107]
v_cvt_pk_bf16_f32 v246, v48, v49
v_cvt_pk_bf16_f32 v247, v50, v51
v_pk_fma_f32 v[52:53], v[100:101], v[122:123], v[52:53] op_sel:[0,1,0] op_sel_hi:[1,1,1]
v_pk_fma_f32 v[54:55], v[102:103], v[122:123], v[54:55] op_sel:[0,1,0] op_sel_hi:[1,1,1]
v_pk_mul_f32 v[52:53], v[52:53], v[104:105]
v_pk_mul_f32 v[54:55], v[54:55], v[106:107]
v_cvt_pk_bf16_f32 v252, v52, v53
v_cvt_pk_bf16_f32 v253, v54, v55
v_mul_f32 v104, 0x3e8b97f6, v109
v_mul_f32 v106, 0x3e8b97f6, v111
s_lshl_b32 s54, s46, 15
s_lshl_b32 s55, s101, 10
s_add_u32 s54, s54, s55
s_add_u32 s54, s54, s60
s_add_u32 s95, s54, 8388608
s_add_u32 s96, s95, 16384
s_cmp_lg_u32 s46, 0
s_cbranch_scc1 L3
v_lshlrev_b32_e64 v29, 3, v1
v_add_u32 v29, 158720, v29
ds_read_b64_tr_b16 v[244:245], v29 offset:0
ds_read_b64_tr_b16 v[250:251], v29 offset:512
L3:
v_mfma_f32_16x16x32_bf16 v[132:135], v[64:67], v[56:59], 0
v_mfma_f32_16x16x32_bf16 v[128:131], v[40:43], v[56:59], 0
v_mfma_f32_16x16x32_bf16 v[212:215], v[40:43], v[32:35], 0
s_waitcnt lgkmcnt(2)
v_mfma_f32_16x16x32_bf16 v[208:211], v[240:243], v[32:35], 0
s_nop 5
v_cndmask_b32 v212, v5, v212, s[64:65]
v_cndmask_b32 v132, v5, v132, s[64:65]
v_cndmask_b32 v133, v5, v133, s[66:67]
v_cndmask_b32 v134, v5, v134, s[68:69]
v_cndmask_b32 v135, v5, v135, s[70:71]
v_cndmask_b32 v213, v5, v213, s[66:67]
v_cndmask_b32 v214, v5, v214, s[68:69]
v_cndmask_b32 v215, v5, v215, s[70:71]
v_cndmask_b32 v208, v5, v208, s[80:81]
v_cndmask_b32 v128, v5, v128, s[72:73]
v_cndmask_b32 v129, v5, v129, s[74:75]
v_cndmask_b32 v130, v5, v130, s[76:77]
v_cndmask_b32 v131, v5, v131, s[78:79]
v_cndmask_b32 v209, v5, v209, s[82:83]
v_cndmask_b32 v210, v5, v210, s[84:85]
v_cndmask_b32 v211, v5, v211, s[86:87]
v_max3_f32 v154, v212, v213, v214
v_max3_f32 v152, v132, v133, v134
v_max3_f32 v153, v135, v128, v129
v_max3_f32 v152, v152, v130, v131
v_max_f32_e64 v152, v152, v153
v_max3_f32 v155, v215, v208, v209
v_max3_f32 v154, v154, v210, v211
v_max_f32 v154, v154, v155
v_mov_b32 v155, v154
v_mov_b32 v153, v152
s_nop 1
v_permlane16_swap_b32 v152, v153
v_max_f32 v152, v152, v153
v_mov_b32 v153, v152
v_permlane16_swap_b32 v154, v155
v_max_f32 v154, v154, v155
v_mov_b32 v155, v154
s_nop 1
v_permlane32_swap_b32 v154, v155
v_permlane32_swap_b32 v152, v153
v_max_f32 v152, v152, v153
v_mul_f32_e64 v152, v152, v106
v_pk_fma_f32 v[128:129], v[128:129], v[106:107], v[152:153] op_sel_hi:[1,0,0] neg_lo:[0,0,1] neg_hi:[0,0,1]
v_max_f32 v154, v154, v155
v_mul_f32 v154, v154, v104
v_pk_fma_f32 v[208:209], v[208:209], v[104:105], v[154:155] op_sel_hi:[1,0,0] neg_lo:[0,0,1] neg_hi:[0,0,1]
v_pk_fma_f32 v[210:211], v[210:211], v[104:105], v[154:155] op_sel_hi:[1,0,0] neg_lo:[0,0,1] neg_hi:[0,0,1]
v_pk_fma_f32 v[130:131], v[130:131], v[106:107], v[152:153] op_sel_hi:[1,0,0] neg_lo:[0,0,1] neg_hi:[0,0,1]
v_pk_fma_f32 v[132:133], v[132:133], v[106:107], v[152:153] op_sel_hi:[1,0,0] neg_lo:[0,0,1] neg_hi:[0,0,1]
v_pk_fma_f32 v[134:135], v[134:135], v[106:107], v[152:153] op_sel_hi:[1,0,0] neg_lo:[0,0,1] neg_hi:[0,0,1]
v_exp_f32_e64 v128, v128
v_pk_fma_f32 v[212:213], v[212:213], v[104:105], v[154:155] op_sel_hi:[1,0,0] neg_lo:[0,0,1] neg_hi:[0,0,1]
v_pk_fma_f32 v[214:215], v[214:215], v[104:105], v[154:155] op_sel_hi:[1,0,0] neg_lo:[0,0,1] neg_hi:[0,0,1]
v_exp_f32 v208, v208
v_exp_f32 v209, v209
v_exp_f32 v129, v129
v_exp_f32 v130, v130
v_exp_f32 v131, v131
v_exp_f32 v132, v132
v_exp_f32 v210, v210
v_exp_f32 v211, v211
v_exp_f32 v212, v212
v_exp_f32 v213, v213
v_exp_f32 v133, v133
v_exp_f32 v134, v134
v_exp_f32_e64 v135, v135
v_cvt_pk_bf16_f32 v136, v128, v129
v_exp_f32 v214, v214
v_exp_f32 v215, v215
v_cvt_pk_bf16_f32 v216, v208, v209
v_cvt_pk_bf16_f32 v217, v210, v211
v_cvt_pk_bf16_f32 v137, v130, v131
v_cvt_pk_bf16_f32 v138, v132, v133
v_cvt_pk_bf16_f32 v139, v134, v135
s_nop 1
v_mfma_f32_16x16x32_bf16 v[148:151], v[20:23], v[136:139], 0
v_cvt_pk_bf16_f32 v218, v212, v213
v_cvt_pk_bf16_f32 v219, v214, v215
s_waitcnt lgkmcnt(0)
s_nop 0
v_mfma_f32_16x16x32_bf16 v[228:231], v[20:23], v[216:219], 0
v_mfma_f32_16x16x32_bf16 v[140:143], v[246:249], v[136:139], 0
v_mfma_f32_16x16x32_bf16 v[144:147], v[252:255], v[136:139], 0
s_nop 0
v_rcp_f32 v152, v148
s_nop 0
v_cndmask_b32_e64 v153, v152, 0, s[20:21]
v_mfma_f32_16x16x32_bf16 v[220:223], v[244:247], v[216:219], 0
v_mfma_f32_16x16x32_bf16 v[224:227], v[250:253], v[216:219], 0
v_rcp_f32 v154, v228
s_nop 0
v_cndmask_b32_e64 v155, v154, 0, s[20:21]
v_pk_mul_f32 v[140:141], v[140:141], v[152:153] op_sel_hi:[1,0]
v_pk_mul_f32 v[142:143], v[142:143], v[152:153] op_sel_hi:[1,0]
v_pk_mul_f32 v[144:145], v[144:145], v[152:153] op_sel:[0,1] op_sel_hi:[1,1]
v_pk_mul_f32 v[146:147], v[146:147], v[152:153] op_sel:[0,1] op_sel_hi:[1,1]
v_pk_mul_f32 v[220:221], v[220:221], v[154:155] op_sel_hi:[1,0]
v_pk_mul_f32 v[222:223], v[222:223], v[154:155] op_sel_hi:[1,0]
v_pk_mul_f32 v[224:225], v[224:225], v[154:155] op_sel:[0,1] op_sel_hi:[1,1]
v_pk_mul_f32 v[226:227], v[226:227], v[154:155] op_sel:[0,1] op_sel_hi:[1,1]
v_cvt_pk_bf16_f32 v140, v140, v141
v_cvt_pk_bf16_f32 v141, v142, v143
v_cvt_pk_bf16_f32 v142, v144, v145
v_cvt_pk_bf16_f32 v143, v146, v147
v_cvt_pk_bf16_f32 v220, v220, v221
v_cvt_pk_bf16_f32 v221, v222, v223
v_cvt_pk_bf16_f32 v222, v224, v225
v_cvt_pk_bf16_f32 v223, v226, v227
buffer_store_dwordx4 v[140:143], v2, s[24:27], s96 offen
buffer_store_dwordx4 v[220:223], v2, s[24:27], s95 offen
v_lshlrev_b32_e64 v32, 16, v8
v_and_b32 v33, 0xffff0000, v8
v_lshlrev_b32_e64 v34, 16, v9
v_and_b32 v35, 0xffff0000, v9
v_lshlrev_b32_e64 v36, 16, v10
v_and_b32 v37, 0xffff0000, v10
v_lshlrev_b32_e64 v38, 16, v11
v_and_b32 v39, 0xffff0000, v11
v_lshlrev_b32_e64 v40, 16, v12
v_and_b32 v41, 0xffff0000, v12
v_lshlrev_b32_e64 v42, 16, v13
v_and_b32 v43, 0xffff0000, v13
v_lshlrev_b32_e64 v44, 16, v14
v_and_b32 v45, 0xffff0000, v14
v_lshlrev_b32 v46, 16, v15
v_and_b32 v47, 0xffff0000, v15
s_lshl_b32 s22, s44, 11
s_add_u32 s22, s22, 65536
s_lshl_b32 s23, s45, 7
s_add_u32 s23, s23, s22
v_lshrrev_b32 v17, 2, v1
v_min_u32 v17, 15, v17
v_and_b32 v18, 3, v1
v_lshlrev_b32 v18, 2, v18
v_lshl_add_u32 v17, v17, 7, v18
s_lshl2_add_u32 s94, s46, s23
s_add_u32 s94, s94, s63
v_mov_b32 v18, s49
s_lshl2_add_u32 s36, s48, s46
s_lshl_b32 s36, s36, 14
s_add_u32 s36, s36, s60
s_add_u32 s39, s36, 8400896
s_add_u32 s38, s36, 8396800
s_add_u32 s37, s36, 8392704
s_add_u32 s36, s36, 8388608
v_lshrrev_b32_e64 v26, 2, v6
v_lshl_add_u32 v26, v7, 2, v26
v_bfe_u32 v27, v26, 1, 2
v_lshlrev_b32_e64 v27, 5, v27
v_lshl_add_u32 v26, v26, 7, v27
v_and_b32_e64 v27, 3, v1
v_lshl_add_u32 v26, v27, 3, v26
v_add_u32 v48, 86016, v26
v_xor_b32_e64 v49, 32, v48
v_xor_b32 v50, 64, v48
v_xor_b32 v51, 96, v48
s_lshl2_add_u32 s40, s48, s46
s_mul_i32 s40, s40, 14336
s_lshl_b32 s59, s47, 11
s_add_u32 s40, s40, s59
s_add_u32 s40, s40, s60
s_add_u32 s40, s40, 12582912
s_lshl2_add_u32 s41, s48, s46
s_lshl_b32 s41, s41, 7
s_lshl_b32 s59, s47, 10
s_add_u32 s41, s41, s59
s_add_u32 s41, s41, s60
s_add_u32 s41, s41, 12697600
s_cmp_lg_u32 s52, 0
s_waitcnt vmcnt(0)
s_mov_b64 exec, 1
buffer_store_dword v18, off, s[24:27], s94
s_mov_b64 exec, -1
s_barrier
s_cbranch_scc1 L5
buffer_load_dword v16, v17, s[24:27], s22 offen sc1
ds_read_b64_tr_b16 v[52:53], v48 offset:0
ds_read_b64_tr_b16 v[54:55], v48 offset:2048
ds_read_b64_tr_b16 v[56:57], v49 offset:0
ds_read_b64_tr_b16 v[58:59], v49 offset:2048
ds_read_b64_tr_b16 v[60:61], v50 offset:0
ds_read_b64_tr_b16 v[62:63], v50 offset:2048
ds_read_b64_tr_b16 v[64:65], v51 offset:0
ds_read_b64_tr_b16 v[66:67], v51 offset:2048
ds_read_b64_tr_b16 v[68:69], v48 offset:4096
ds_read_b64_tr_b16 v[70:71], v48 offset:6144
ds_read_b64_tr_b16 v[72:73], v49 offset:4096
ds_read_b64_tr_b16 v[74:75], v49 offset:6144
ds_read_b64_tr_b16 v[76:77], v50 offset:4096
ds_read_b64_tr_b16 v[78:79], v50 offset:6144
ds_read_b64_tr_b16 v[80:81], v51 offset:4096
ds_read_b64_tr_b16 v[82:83], v51 offset:6144
ds_read_b64_tr_b16 v[84:85], v48 offset:8192
ds_read_b64_tr_b16 v[86:87], v48 offset:10240
ds_read_b64_tr_b16 v[88:89], v49 offset:8192
ds_read_b64_tr_b16 v[90:91], v49 offset:10240
ds_read_b64_tr_b16 v[92:93], v50 offset:8192
ds_read_b64_tr_b16 v[94:95], v50 offset:10240
ds_read_b64_tr_b16 v[96:97], v51 offset:8192
ds_read_b64_tr_b16 v[98:99], v51 offset:10240
ds_read_b64_tr_b16 v[100:101], v48 offset:12288
ds_read_b64_tr_b16 v[102:103], v48 offset:14336
ds_read_b64_tr_b16 v[104:105], v49 offset:12288
ds_read_b64_tr_b16 v[106:107], v49 offset:14336
ds_read_b64_tr_b16 v[108:109], v50 offset:12288
ds_read_b64_tr_b16 v[110:111], v50 offset:14336
ds_read_b64_tr_b16 v[192:193], v51 offset:12288
ds_read_b64_tr_b16 v[194:195], v51 offset:14336
ds_read_b64_tr_b16 v[196:197], v48 offset:16384
ds_read_b64_tr_b16 v[198:199], v48 offset:18432
ds_read_b64_tr_b16 v[200:201], v49 offset:16384
ds_read_b64_tr_b16 v[202:203], v49 offset:18432
ds_read_b64_tr_b16 v[204:205], v50 offset:16384
ds_read_b64_tr_b16 v[206:207], v50 offset:18432
ds_read_b64_tr_b16 v[208:209], v51 offset:16384
ds_read_b64_tr_b16 v[210:211], v51 offset:18432
ds_read_b64_tr_b16 v[212:213], v48 offset:20480
ds_read_b64_tr_b16 v[214:215], v48 offset:22528
ds_read_b64_tr_b16 v[216:217], v49 offset:20480
ds_read_b64_tr_b16 v[218:219], v49 offset:22528
ds_read_b64_tr_b16 v[220:221], v50 offset:20480
ds_read_b64_tr_b16 v[222:223], v50 offset:22528
ds_read_b64_tr_b16 v[224:225], v51 offset:20480
ds_read_b64_tr_b16 v[226:227], v51 offset:22528
ds_read_b64_tr_b16 v[228:229], v48 offset:24576
ds_read_b64_tr_b16 v[230:231], v48 offset:26624
ds_read_b64_tr_b16 v[232:233], v49 offset:24576
ds_read_b64_tr_b16 v[234:235], v49 offset:26624
ds_read_b64_tr_b16 v[236:237], v50 offset:24576
ds_read_b64_tr_b16 v[238:239], v50 offset:26624
ds_read_b64_tr_b16 v[240:241], v51 offset:24576
ds_read_b64_tr_b16 v[242:243], v51 offset:26624
ds_read_b64_tr_b16 v[244:245], v48 offset:28672
ds_read_b64_tr_b16 v[246:247], v48 offset:30720
ds_read_b64_tr_b16 v[248:249], v49 offset:28672
ds_read_b64_tr_b16 v[250:251], v49 offset:30720
buffer_load_dword v16, v17, s[24:27], s22 offen sc1
ds_read_b64_tr_b16 v[252:253], v50 offset:28672
ds_read_b64_tr_b16 v[254:255], v50 offset:30720
ds_read_b64_tr_b16 a[224:225], v51 offset:28672
ds_read_b64_tr_b16 a[226:227], v51 offset:30720
ds_read_b64_tr_b16 a[228:229], v48 offset:32768
ds_read_b64_tr_b16 a[230:231], v48 offset:34816
ds_read_b64_tr_b16 a[232:233], v49 offset:32768
ds_read_b64_tr_b16 a[234:235], v49 offset:34816
ds_read_b64_tr_b16 a[236:237], v50 offset:32768
ds_read_b64_tr_b16 a[238:239], v50 offset:34816
ds_read_b64_tr_b16 a[240:241], v51 offset:32768
ds_read_b64_tr_b16 a[242:243], v51 offset:34816
s_waitcnt vmcnt(0)
v_cmp_ne_u32 vcc, s49, v16
s_cbranch_vccz L4
buffer_load_dword v16, v17, s[24:27], s22 offen sc1
s_nop 7
buffer_load_dword v30, v17, s[24:27], s22 offen sc1
s_nop 7
buffer_load_dword v31, v17, s[24:27], s22 offen sc1
Lp7:
s_waitcnt vmcnt(2)
v_cmp_ne_u32 vcc, s49, v16
s_cbranch_vccz L4
buffer_load_dword v16, v17, s[24:27], s22 offen sc1
s_waitcnt vmcnt(2)
v_cmp_ne_u32 vcc, s49, v30
s_cbranch_vccz L4
buffer_load_dword v30, v17, s[24:27], s22 offen sc1
s_waitcnt vmcnt(2)
v_cmp_ne_u32 vcc, s49, v31
s_cbranch_vccz L4
buffer_load_dword v31, v17, s[24:27], s22 offen sc1
s_sub_u32 s62, s62, 1
s_cbranch_scc0 Lp7
s_mov_b32 s62, 0
Ld8:
s_branch L4
L5:
ds_read_b64_tr_b16 v[52:53], v48 offset:0
ds_read_b64_tr_b16 v[54:55], v48 offset:2048
ds_read_b64_tr_b16 v[56:57], v49 offset:0
ds_read_b64_tr_b16 v[58:59], v49 offset:2048
ds_read_b64_tr_b16 v[60:61], v50 offset:0
ds_read_b64_tr_b16 v[62:63], v50 offset:2048
ds_read_b64_tr_b16 v[64:65], v51 offset:0
ds_read_b64_tr_b16 v[66:67], v51 offset:2048
ds_read_b64_tr_b16 v[68:69], v48 offset:4096
ds_read_b64_tr_b16 v[70:71], v48 offset:6144
ds_read_b64_tr_b16 v[72:73], v49 offset:4096
ds_read_b64_tr_b16 v[74:75], v49 offset:6144
ds_read_b64_tr_b16 v[76:77], v50 offset:4096
ds_read_b64_tr_b16 v[78:79], v50 offset:6144
ds_read_b64_tr_b16 v[80:81], v51 offset:4096
ds_read_b64_tr_b16 v[82:83], v51 offset:6144
ds_read_b64_tr_b16 v[84:85], v48 offset:8192
ds_read_b64_tr_b16 v[86:87], v48 offset:10240
ds_read_b64_tr_b16 v[88:89], v49 offset:8192
ds_read_b64_tr_b16 v[90:91], v49 offset:10240
ds_read_b64_tr_b16 v[92:93], v50 offset:8192
ds_read_b64_tr_b16 v[94:95], v50 offset:10240
ds_read_b64_tr_b16 v[96:97], v51 offset:8192
ds_read_b64_tr_b16 v[98:99], v51 offset:10240
ds_read_b64_tr_b16 v[100:101], v48 offset:12288
ds_read_b64_tr_b16 v[102:103], v48 offset:14336
ds_read_b64_tr_b16 v[104:105], v49 offset:12288
ds_read_b64_tr_b16 v[106:107], v49 offset:14336
ds_read_b64_tr_b16 v[108:109], v50 offset:12288
ds_read_b64_tr_b16 v[110:111], v50 offset:14336
ds_read_b64_tr_b16 v[192:193], v51 offset:12288
ds_read_b64_tr_b16 v[194:195], v51 offset:14336
ds_read_b64_tr_b16 v[196:197], v48 offset:16384
ds_read_b64_tr_b16 v[198:199], v48 offset:18432
ds_read_b64_tr_b16 v[200:201], v49 offset:16384
ds_read_b64_tr_b16 v[202:203], v49 offset:18432
ds_read_b64_tr_b16 v[204:205], v50 offset:16384
ds_read_b64_tr_b16 v[206:207], v50 offset:18432
ds_read_b64_tr_b16 v[208:209], v51 offset:16384
ds_read_b64_tr_b16 v[210:211], v51 offset:18432
ds_read_b64_tr_b16 v[212:213], v48 offset:20480
ds_read_b64_tr_b16 v[214:215], v48 offset:22528
ds_read_b64_tr_b16 v[216:217], v49 offset:20480
ds_read_b64_tr_b16 v[218:219], v49 offset:22528
ds_read_b64_tr_b16 v[220:221], v50 offset:20480
ds_read_b64_tr_b16 v[222:223], v50 offset:22528
ds_read_b64_tr_b16 v[224:225], v51 offset:20480
ds_read_b64_tr_b16 v[226:227], v51 offset:22528
ds_read_b64_tr_b16 v[228:229], v48 offset:24576
ds_read_b64_tr_b16 v[230:231], v48 offset:26624
ds_read_b64_tr_b16 v[232:233], v49 offset:24576
ds_read_b64_tr_b16 v[234:235], v49 offset:26624
ds_read_b64_tr_b16 v[236:237], v50 offset:24576
ds_read_b64_tr_b16 v[238:239], v50 offset:26624
ds_read_b64_tr_b16 v[240:241], v51 offset:24576
ds_read_b64_tr_b16 v[242:243], v51 offset:26624
ds_read_b64_tr_b16 v[244:245], v48 offset:28672
ds_read_b64_tr_b16 v[246:247], v48 offset:30720
ds_read_b64_tr_b16 v[248:249], v49 offset:28672
ds_read_b64_tr_b16 v[250:251], v49 offset:30720
ds_read_b64_tr_b16 v[252:253], v50 offset:28672
ds_read_b64_tr_b16 v[254:255], v50 offset:30720
ds_read_b64_tr_b16 a[224:225], v51 offset:28672
ds_read_b64_tr_b16 a[226:227], v51 offset:30720
ds_read_b64_tr_b16 a[228:229], v48 offset:32768
ds_read_b64_tr_b16 a[230:231], v48 offset:34816
ds_read_b64_tr_b16 a[232:233], v49 offset:32768
ds_read_b64_tr_b16 a[234:235], v49 offset:34816
ds_read_b64_tr_b16 a[236:237], v50 offset:32768
ds_read_b64_tr_b16 a[238:239], v50 offset:34816
ds_read_b64_tr_b16 a[240:241], v51 offset:32768
ds_read_b64_tr_b16 a[242:243], v51 offset:34816
s_cmp_lg_u32 s52, 1
s_cbranch_scc1 L6
buffer_wbl2 sc1
s_waitcnt vmcnt(0)
v_lshlrev_b32 v30, 2, v1
s_mov_b64 exec, 15
buffer_store_dword v18, v30, s[24:27], s23 offen sc1
s_mov_b64 exec, -1
Lp9:
buffer_load_dword v16, v17, s[24:27], s22 offen sc1
s_waitcnt vmcnt(0)
v_cmp_ne_u32 vcc, s49, v16
s_cbranch_vccz Ld10
s_sub_u32 s62, s62, 1
s_cbranch_scc0 Lp9
s_mov_b32 s62, 0
Ld10:
buffer_inv sc1
s_waitcnt vmcnt(0)
s_branch L4
L6:
s_cmp_lg_u32 s46, 3
s_cbranch_scc1 L11
v_mul_u32_u24 v30, 7, v7
v_add_u32 v30, s47, v30
v_mov_b32 v31, s47
v_cmp_gt_u32 vcc, 16, v30
s_nop 1
v_cndmask_b32 v30, v31, v30, vcc
v_lshlrev_b32_e64 v30, 11, v30
v_lshl_add_u32 v31, v6, 7, v30
s_mov_b32 s54, 360448
Lp12:
buffer_load_dword v16, v31, s[24:27], s54 offen sc1
s_waitcnt vmcnt(0)
v_cmp_ne_u32_e64 vcc, s51, v16
s_cbranch_vccz Ld13
s_sub_u32 s62, s62, 1
s_cbranch_scc0 Lp12
s_mov_b32 s62, 0
Ld13:
L11:
L4:
s_barrier
s_cmp_lg_u32 s53, 0
s_cbranch_scc1 Li14
buffer_load_dwordx4 v[128:131], v2, s[24:27], s36 offen offset:0 sc1
buffer_load_dwordx4 v[132:135], v2, s[24:27], s36 offen offset:1024 sc1
buffer_load_dwordx4 v[136:139], v2, s[24:27], s36 offen offset:2048 sc1
buffer_load_dwordx4 v[140:143], v2, s[24:27], s36 offen offset:3072 sc1
buffer_load_dwordx4 v[144:147], v2, s[24:27], s37 offen offset:0 sc1
buffer_load_dwordx4 v[148:151], v2, s[24:27], s37 offen offset:1024 sc1
buffer_load_dwordx4 v[152:155], v2, s[24:27], s37 offen offset:2048 sc1
buffer_load_dwordx4 v[156:159], v2, s[24:27], s37 offen offset:3072 sc1
buffer_load_dwordx4 v[160:163], v2, s[24:27], s38 offen offset:0 sc1
buffer_load_dwordx4 v[164:167], v2, s[24:27], s38 offen offset:1024 sc1
buffer_load_dwordx4 v[168:171], v2, s[24:27], s38 offen offset:2048 sc1
buffer_load_dwordx4 v[172:175], v2, s[24:27], s38 offen offset:3072 sc1
s_waitcnt lgkmcnt(0)
s_lshl_b32 s55, s46, 8
v_lshl_add_u32 v26, v1, 2, s55
v_cmp_gt_u32 vcc, 896, v26
v_bfrev_b32 v27, 1
s_nop 0
v_cndmask_b32_e64 v26, v27, v26, vcc
s_mul_i32 s54, s45, 12544
s_add_u32 s55, s54, 7864320
buffer_load_dword v112, v26, s[24:27], s55 offen offset:0 sc1
buffer_load_dword v113, v26, s[24:27], s55 offen offset:896 sc1
buffer_load_dword v114, v26, s[24:27], s55 offen offset:1792 sc1
buffer_load_dword v115, v26, s[24:27], s55 offen offset:2688 sc1
s_add_u32 s55, s54, 7867904
buffer_load_dword v116, v26, s[24:27], s55 offen offset:0 sc1
buffer_load_dword v117, v26, s[24:27], s55 offen offset:896 sc1
buffer_load_dword v118, v26, s[24:27], s55 offen offset:1792 sc1
buffer_load_dword v119, v26, s[24:27], s55 offen offset:2688 sc1
s_add_u32 s55, s54, 7871488
buffer_load_dword v120, v26, s[24:27], s55 offen offset:0 sc1
buffer_load_dword v121, v26, s[24:27], s55 offen offset:896 sc1
buffer_load_dword v122, v26, s[24:27], s55 offen offset:1792 sc1
buffer_load_dword v123, v26, s[24:27], s55 offen offset:2688 sc1
s_add_u32 s55, s54, 7875072
buffer_load_dword v124, v26, s[24:27], s55 offen offset:0 sc1
buffer_load_dword v125, v26, s[24:27], s55 offen offset:896 sc1
s_waitcnt vmcnt(25)
v_mfma_f32_16x16x32_bf16 v[32:35], v[52:55], v[128:131], v[32:35]
buffer_load_dwordx4 v[176:179], v2, s[24:27], s39 offen offset:0 sc1
v_mfma_f32_16x16x32_bf16 v[36:39], v[56:59], v[128:131], v[36:39]
ds_read_b64_tr_b16 v[52:53], v48 offset:36864
ds_read_b64_tr_b16 v[54:55], v48 offset:38912
v_mfma_f32_16x16x32_bf16 v[40:43], v[60:63], v[128:131], v[40:43]
ds_read_b64_tr_b16 v[56:57], v49 offset:36864
ds_read_b64_tr_b16 v[58:59], v49 offset:38912
buffer_load_dwordx4 v[180:183], v2, s[24:27], s39 offen offset:1024 sc1
s_add_u32 m0, s4, 28672
s_add_u32 s11, s10, 0
buffer_load_dwordx4 v2, s[24:27], s11 offen offset:0 sc1 lds
v_mfma_f32_16x16x32_bf16 v[44:47], v[64:67], v[128:131], v[44:47]
ds_read_b64_tr_b16 v[60:61], v50 offset:36864
ds_read_b64_tr_b16 v[62:63], v50 offset:38912
s_waitcnt vmcnt(27)
v_mfma_f32_16x16x32_bf16 v[32:35], v[68:71], v[132:135], v[32:35]
ds_read_b64_tr_b16 v[64:65], v51 offset:36864
ds_read_b64_tr_b16 v[66:67], v51 offset:38912
buffer_load_dwordx4 v[184:187], v2, s[24:27], s39 offen offset:2048 sc1
v_mfma_f32_16x16x32_bf16 v[36:39], v[72:75], v[132:135], v[36:39]
ds_read_b64_tr_b16 v[68:69], v48 offset:40960
ds_read_b64_tr_b16 v[70:71], v48 offset:43008
v_mfma_f32_16x16x32_bf16 v[40:43], v[76:79], v[132:135], v[40:43]
ds_read_b64_tr_b16 v[72:73], v49 offset:40960
ds_read_b64_tr_b16 v[74:75], v49 offset:43008
buffer_load_dwordx4 v[188:191], v2, s[24:27], s39 offen offset:3072 sc1
buffer_load_dwordx4 v2, s[24:27], s11 offen offset:1024 sc1 lds
v_mfma_f32_16x16x32_bf16 v[44:47], v[80:83], v[132:135], v[44:47]
ds_read_b64_tr_b16 v[76:77], v50 offset:40960
ds_read_b64_tr_b16 v[78:79], v50 offset:43008
s_waitcnt vmcnt(29)
v_mfma_f32_16x16x32_bf16 v[32:35], v[84:87], v[136:139], v[32:35]
ds_read_b64_tr_b16 v[80:81], v51 offset:40960
ds_read_b64_tr_b16 v[82:83], v51 offset:43008
v_mfma_f32_16x16x32_bf16 v[36:39], v[88:91], v[136:139], v[36:39]
ds_read_b64_tr_b16 v[84:85], v48 offset:45056
ds_read_b64_tr_b16 v[86:87], v48 offset:47104
v_mfma_f32_16x16x32_bf16 v[40:43], v[92:95], v[136:139], v[40:43]
ds_read_b64_tr_b16 v[88:89], v49 offset:45056
ds_read_b64_tr_b16 v[90:91], v49 offset:47104
buffer_load_dwordx4 v2, s[24:27], s11 offen offset:2048 sc1 lds
v_mfma_f32_16x16x32_bf16 v[44:47], v[96:99], v[136:139], v[44:47]
ds_read_b64_tr_b16 v[92:93], v50 offset:45056
ds_read_b64_tr_b16 v[94:95], v50 offset:47104
s_waitcnt vmcnt(29)
v_mfma_f32_16x16x32_bf16 v[32:35], v[100:103], v[140:143], v[32:35]
ds_read_b64_tr_b16 v[96:97], v51 offset:45056
ds_read_b64_tr_b16 v[98:99], v51 offset:47104
v_mfma_f32_16x16x32_bf16 v[36:39], v[104:107], v[140:143], v[36:39]
ds_read_b64_tr_b16 v[100:101], v48 offset:49152
ds_read_b64_tr_b16 v[102:103], v48 offset:51200
v_mfma_f32_16x16x32_bf16 v[40:43], v[108:111], v[140:143], v[40:43]
ds_read_b64_tr_b16 v[104:105], v49 offset:49152
ds_read_b64_tr_b16 v[106:107], v49 offset:51200
buffer_load_dwordx4 v2, s[24:27], s11 offen offset:3072 sc1 lds
v_mfma_f32_16x16x32_bf16 v[44:47], v[192:195], v[140:143], v[44:47]
ds_read_b64_tr_b16 v[108:109], v50 offset:49152
ds_read_b64_tr_b16 v[110:111], v50 offset:51200
s_waitcnt vmcnt(29)
v_mfma_f32_16x16x32_bf16 v[32:35], v[196:199], v[144:147], v[32:35]
ds_read_b64_tr_b16 v[192:193], v51 offset:49152
ds_read_b64_tr_b16 v[194:195], v51 offset:51200
v_mfma_f32_16x16x32_bf16 v[36:39], v[200:203], v[144:147], v[36:39]
ds_read_b64_tr_b16 v[196:197], v48 offset:53248
ds_read_b64_tr_b16 v[198:199], v48 offset:55296
v_mfma_f32_16x16x32_bf16 v[40:43], v[204:207], v[144:147], v[40:43]
ds_read_b64_tr_b16 v[200:201], v49 offset:53248
ds_read_b64_tr_b16 v[202:203], v49 offset:55296
s_add_u32 m0, s4, 32768
s_add_u32 s11, s10, 4096
buffer_load_dwordx4 v2, s[24:27], s11 offen offset:0 sc1 lds
v_mfma_f32_16x16x32_bf16 v[44:47], v[208:211], v[144:147], v[44:47]
ds_read_b64_tr_b16 v[204:205], v50 offset:53248
ds_read_b64_tr_b16 v[206:207], v50 offset:55296
s_waitcnt vmcnt(29)
v_mfma_f32_16x16x32_bf16 v[32:35], v[212:215], v[148:151], v[32:35]
ds_read_b64_tr_b16 v[208:209], v51 offset:53248
ds_read_b64_tr_b16 v[210:211], v51 offset:55296
v_mfma_f32_16x16x32_bf16 v[36:39], v[216:219], v[148:151], v[36:39]
ds_read_b64_tr_b16 v[212:213], v48 offset:57344
ds_read_b64_tr_b16 v[214:215], v48 offset:59392
v_mfma_f32_16x16x32_bf16 v[40:43], v[220:223], v[148:151], v[40:43]
ds_read_b64_tr_b16 v[216:217], v49 offset:57344
ds_read_b64_tr_b16 v[218:219], v49 offset:59392
buffer_load_dwordx4 v2, s[24:27], s11 offen offset:1024 sc1 lds
v_mfma_f32_16x16x32_bf16 v[44:47], v[224:227], v[148:151], v[44:47]
ds_read_b64_tr_b16 v[220:221], v50 offset:57344
ds_read_b64_tr_b16 v[222:223], v50 offset:59392
s_waitcnt vmcnt(29)
v_mfma_f32_16x16x32_bf16 v[32:35], v[228:231], v[152:155], v[32:35]
ds_read_b64_tr_b16 v[224:225], v51 offset:57344
ds_read_b64_tr_b16 v[226:227], v51 offset:59392
v_mfma_f32_16x16x32_bf16 v[36:39], v[232:235], v[152:155], v[36:39]
ds_read_b64_tr_b16 v[228:229], v48 offset:61440
ds_read_b64_tr_b16 v[230:231], v48 offset:63488
v_mfma_f32_16x16x32_bf16 v[40:43], v[236:239], v[152:155], v[40:43]
ds_read_b64_tr_b16 v[232:233], v49 offset:61440
ds_read_b64_tr_b16 v[234:235], v49 offset:63488
buffer_load_dwordx4 v2, s[24:27], s11 offen offset:2048 sc1 lds
v_mfma_f32_16x16x32_bf16 v[44:47], v[240:243], v[152:155], v[44:47]
ds_read_b64_tr_b16 v[236:237], v50 offset:61440
ds_read_b64_tr_b16 v[238:239], v50 offset:63488
s_waitcnt vmcnt(29)
v_mfma_f32_16x16x32_bf16 v[32:35], v[244:247], v[156:159], v[32:35]
ds_read_b64_tr_b16 v[240:241], v51 offset:61440
ds_read_b64_tr_b16 v[242:243], v51 offset:63488
v_mfma_f32_16x16x32_bf16 v[36:39], v[248:251], v[156:159], v[36:39]
v_mfma_f32_16x16x32_bf16 v[40:43], v[252:255], v[156:159], v[40:43]
s_add_u32 m0, s4, 57344
s_add_u32 s11, s10, 28672
buffer_load_dwordx4 v2, s[24:27], s11 offen offset:0 sc1 lds
v_mfma_f32_16x16x32_bf16 v[44:47], a[224:227], v[156:159], v[44:47]
s_waitcnt vmcnt(29)
v_mfma_f32_16x16x32_bf16 v[32:35], a[228:231], v[160:163], v[32:35]
v_mfma_f32_16x16x32_bf16 v[36:39], a[232:235], v[160:163], v[36:39]
v_mfma_f32_16x16x32_bf16 v[40:43], a[236:239], v[160:163], v[40:43]
buffer_load_dwordx4 v2, s[24:27], s11 offen offset:1024 sc1 lds
v_mfma_f32_16x16x32_bf16 v[44:47], a[240:243], v[160:163], v[44:47]
s_waitcnt vmcnt(29) lgkmcnt(15)
v_mfma_f32_16x16x32_bf16 v[32:35], v[52:55], v[164:167], v[32:35]
v_mfma_f32_16x16x32_bf16 v[36:39], v[56:59], v[164:167], v[36:39]
v_mfma_f32_16x16x32_bf16 v[40:43], v[60:63], v[164:167], v[40:43]
buffer_load_dwordx4 v2, s[24:27], s11 offen offset:2048 sc1 lds
v_mfma_f32_16x16x32_bf16 v[44:47], v[64:67], v[164:167], v[44:47]
s_waitcnt vmcnt(29) lgkmcnt(15)
v_mfma_f32_16x16x32_bf16 v[32:35], v[68:71], v[168:171], v[32:35]
v_mfma_f32_16x16x32_bf16 v[36:39], v[72:75], v[168:171], v[36:39]
v_mfma_f32_16x16x32_bf16 v[40:43], v[76:79], v[168:171], v[40:43]
buffer_load_dwordx4 v2, s[24:27], s11 offen offset:3072 sc1 lds
v_mfma_f32_16x16x32_bf16 v[44:47], v[80:83], v[168:171], v[44:47]
s_waitcnt vmcnt(29) lgkmcnt(15)
v_mfma_f32_16x16x32_bf16 v[32:35], v[84:87], v[172:175], v[32:35]
v_mfma_f32_16x16x32_bf16 v[36:39], v[88:91], v[172:175], v[36:39]
v_mfma_f32_16x16x32_bf16 v[40:43], v[92:95], v[172:175], v[40:43]
s_add_u32 m0, s4, 61440
s_add_u32 s11, s10, 32768
buffer_load_dwordx4 v2, s[24:27], s11 offen offset:0 sc1 lds
v_mfma_f32_16x16x32_bf16 v[44:47], v[96:99], v[172:175], v[44:47]
s_waitcnt vmcnt(15) lgkmcnt(15)
v_mfma_f32_16x16x32_bf16 v[32:35], v[100:103], v[176:179], v[32:35]
v_mfma_f32_16x16x32_bf16 v[36:39], v[104:107], v[176:179], v[36:39]
v_mfma_f32_16x16x32_bf16 v[40:43], v[108:111], v[176:179], v[40:43]
buffer_load_dwordx4 v2, s[24:27], s11 offen offset:1024 sc1 lds
v_mfma_f32_16x16x32_bf16 v[44:47], v[192:195], v[176:179], v[44:47]
s_waitcnt vmcnt(15) lgkmcnt(15)
v_mfma_f32_16x16x32_bf16 v[32:35], v[196:199], v[180:183], v[32:35]
v_mfma_f32_16x16x32_bf16 v[36:39], v[200:203], v[180:183], v[36:39]
v_mfma_f32_16x16x32_bf16 v[40:43], v[204:207], v[180:183], v[40:43]
buffer_load_dwordx4 v2, s[24:27], s11 offen offset:2048 sc1 lds
v_mfma_f32_16x16x32_bf16 v[44:47], v[208:211], v[180:183], v[44:47]
s_waitcnt vmcnt(14) lgkmcnt(8)
v_mfma_f32_16x16x32_bf16 v[32:35], v[212:215], v[184:187], v[32:35]
v_mfma_f32_16x16x32_bf16 v[36:39], v[216:219], v[184:187], v[36:39]
v_mfma_f32_16x16x32_bf16 v[40:43], v[220:223], v[184:187], v[40:43]
v_mfma_f32_16x16x32_bf16 v[44:47], v[224:227], v[184:187], v[44:47]
s_waitcnt vmcnt(13) lgkmcnt(0)
v_mfma_f32_16x16x32_bf16 v[32:35], v[228:231], v[188:191], v[32:35]
v_mfma_f32_16x16x32_bf16 v[36:39], v[232:235], v[188:191], v[36:39]
v_mfma_f32_16x16x32_bf16 v[40:43], v[236:239], v[188:191], v[40:43]
v_mfma_f32_16x16x32_bf16 v[44:47], v[240:243], v[188:191], v[44:47]
v_add_f32 v112, v112, v113
v_add_f32 v112, v112, v114
v_add_f32 v112, v112, v115
v_add_f32 v112, v112, v116
v_add_f32 v112, v112, v117
v_add_f32 v112, v112, v118
v_add_f32 v112, v112, v119
v_add_f32 v112, v112, v120
v_add_f32 v112, v112, v121
v_add_f32 v112, v112, v122
v_add_f32 v112, v112, v123
v_add_f32_e64 v112, v112, v124
v_add_f32 v112, v112, v125
s_lshl_b32 s55, s46, 8
s_add_u32 s55, s55, 160256
v_lshl_add_u32 v26, v1, 2, s55
ds_write_b32 v26, v112
v_cvt_pk_bf16_f32 v8, v32, v33
v_cvt_pk_bf16_f32 v9, v34, v35
v_cvt_pk_bf16_f32 v10, v36, v37
v_cvt_pk_bf16_f32 v11, v38, v39
v_cvt_pk_bf16_f32 v12, v40, v41
v_cvt_pk_bf16_f32 v13, v42, v43
v_cvt_pk_bf16_f32 v14, v44, v45
v_cvt_pk_bf16_f32 v15, v46, v47
buffer_store_dwordx4 v[8:11], v2, s[24:27], s40 offen offset:0
buffer_store_dwordx4 v[12:15], v2, s[24:27], s40 offen offset:1024
v_dot2_f32_bf16 v252, v8, v20, 0
v_dot2_f32_bf16 v253, v8, v8, 0
v_dot2_f32_bf16 v252, v9, v20, v252
v_dot2_f32_bf16 v253, v9, v9, v253
v_dot2_f32_bf16 v252, v10, v20, v252
v_dot2_f32_bf16 v253, v10, v10, v253
v_dot2_f32_bf16 v252, v11, v20, v252
v_dot2_f32_bf16 v253, v11, v11, v253
v_dot2_f32_bf16 v252, v12, v20, v252
v_dot2_f32_bf16 v253, v12, v12, v253
v_dot2_f32_bf16 v252, v13, v20, v252
v_dot2_f32_bf16 v253, v13, v13, v253
v_dot2_f32_bf16 v252, v14, v20, v252
v_dot2_f32_bf16 v253, v14, v14, v253
v_dot2_f32_bf16 v252, v15, v20, v252
v_dot2_f32_bf16 v253, v15, v15, v253
s_nop 1
v_mov_b32 v122, v252
v_mov_b32 v123, v253
s_nop 0
v_permlane16_swap_b32 v252, v122
v_permlane16_swap_b32 v253, v123
v_add_f32 v252, v252, v122
v_add_f32 v253, v253, v123
v_mov_b32 v122, v252
v_mov_b32 v123, v253
s_nop 0
v_permlane32_swap_b32 v252, v122
v_permlane32_swap_b32 v253, v123
v_add_f32 v252, v252, v122
v_add_f32 v253, v253, v123
v_lshlrev_b32 v29, 3, v6
s_mov_b64 exec, 0xffff
buffer_store_dwordx2 v[252:253], v29, s[24:27], s41 offen
s_mov_b64 exec, -1
s_waitcnt lgkmcnt(0)
Lj16:
s_lshl_b32 s22, s44, 11
s_add_u32 s22, s22, 98304
s_lshl_b32 s23, s45, 7
s_add_u32 s23, s23, s22
v_lshrrev_b32 v17, 2, v1
v_min_u32 v17, 13, v17
v_and_b32 v18, 3, v1
v_lshlrev_b32_e64 v18, 2, v18
v_lshl_add_u32 v17, v17, 7, v18
s_lshl2_add_u32 s94, s46, s23
s_add_u32 s94, s94, s63
v_mov_b32_e64 v18, s49
v_bfe_u32 v26, v1, 4, 1
v_lshrrev_b32 v27, 5, v1
v_lshlrev_b32 v28, 4, v6
v_lshl_add_u32 v28, v27, 8, v28
s_movk_i32 s55, 14336
v_mad_u32_u24 v128, v26, s55, v28
s_mul_i32 s36, s46, 28672
s_add_u32 s36, s36, s60
s_add_u32 s39, s36, 12595200
s_add_u32 s38, s36, 12591104
s_add_u32 s37, s36, 12587008
s_add_u32 s36, s36, 12582912
v_and_b32 v129, 31, v1
v_lshlrev_b32 v129, 3, v129
v_lshl_add_u32 v129, v27, 12, v129
v_cmp_eq_u32 vcc, 1, v27
v_bfrev_b32 v30, 1
s_nop 0
v_cndmask_b32 v130, v129, v30, vcc
s_lshl_b32 s42, s46, 8
s_add_u32 s42, s42, s60
s_add_u32 s42, s42, 12697600
s_mov_b32 s55, 57344
v_mad_u32_u24 v131, v26, s55, v28
v_lshlrev_b32_e64 v132, 4, v27
v_add_u32 v132, 160256, v132
s_mul_i32 s96, s46, 114688
s_mul_i32 s59, s45, 3584
s_add_u32 s96, s96, s59
s_add_u32 s96, s96, s61
s_add_u32 s96, s96, 20971520
s_cmp_lg_u32 s52, 0
s_waitcnt vmcnt(0)
s_mov_b64 exec, 1
buffer_store_dword v18, off, s[24:27], s94
s_mov_b64 exec, -1
s_barrier
s_cbranch_scc1 L18
buffer_load_dword v16, v17, s[24:27], s22 offen sc1
s_nop 7
buffer_load_dword v30, v17, s[24:27], s22 offen sc1
s_nop 7
buffer_load_dword v31, v17, s[24:27], s22 offen sc1
Lp20:
s_waitcnt vmcnt(2)
v_cmp_ne_u32 vcc, s49, v16
s_cbranch_vccz L17
buffer_load_dword v16, v17, s[24:27], s22 offen sc1
s_waitcnt vmcnt(2)
v_cmp_ne_u32 vcc, s49, v30
s_cbranch_vccz L17
buffer_load_dword v30, v17, s[24:27], s22 offen sc1
s_waitcnt vmcnt(2)
v_cmp_ne_u32 vcc, s49, v31
s_cbranch_vccz L17
buffer_load_dword v31, v17, s[24:27], s22 offen sc1
s_sub_u32 s62, s62, 1
s_cbranch_scc0 Lp20
s_mov_b32 s62, 0
Ld21:
s_branch L17
L18:
s_cmp_lg_u32 s52, 1
s_cbranch_scc1 L19
buffer_wbl2 sc1
s_waitcnt vmcnt(0)
v_lshlrev_b32 v30, 2, v1
s_mov_b64 exec, 15
buffer_store_dword v18, v30, s[24:27], s23 offen sc1
s_mov_b64 exec, -1
Lp22:
buffer_load_dword v16, v17, s[24:27], s22 offen sc1
s_waitcnt vmcnt(0)
v_cmp_ne_u32 vcc, s49, v16
s_cbranch_vccz Ld23
s_sub_u32 s62, s62, 1
s_cbranch_scc0 Lp22
s_mov_b32 s62, 0
Ld23:
buffer_inv sc1
s_waitcnt vmcnt(0)
s_branch L17
L19:
L17:
s_barrier
buffer_load_dwordx4 v[144:147], v128, s[24:27], s36 offen offset:0 sc1
buffer_load_dwordx4 v[148:151], v128, s[24:27], s36 offen offset:512 sc1
buffer_load_dwordx4 v[152:155], v128, s[24:27], s36 offen offset:1024 sc1
buffer_load_dwordx4 v[156:159], v128, s[24:27], s36 offen offset:1536 sc1
buffer_load_dwordx4 v[160:163], v128, s[24:27], s36 offen offset:2048 sc1
ds_read_b128 a[224:227], v2 offset:28672
ds_read_b128 a[228:231], v2 offset:57344
ds_read_b128 a[232:235], v2 offset:29696
ds_read_b128 a[236:239], v2 offset:58368
ds_read_b128 a[240:243], v2 offset:30720
ds_read_b128 a[244:247], v2 offset:59392
buffer_load_dwordx2 v[136:137], v129, s[24:27], s42 offen offset:0 sc1
buffer_load_dwordx2 v[138:139], v129, s[24:27], s42 offen offset:1024 sc1
buffer_load_dwordx2 v[140:141], v129, s[24:27], s42 offen offset:2048 sc1
buffer_load_dwordx2 v[142:143], v130, s[24:27], s42 offen offset:3072 sc1
s_waitcnt vmcnt(8) lgkmcnt(4)
v_mfma_f32_32x32x16_bf16 v[32:47], a[224:227], v[144:147], 0
ds_read_b128 a[248:251], v2 offset:31744
buffer_load_dwordx4 v[164:167], v128, s[24:27], s36 offen offset:2560 sc1
v_mfma_f32_32x32x16_bf16 v[48:63], a[228:231], v[144:147], 0
ds_read_b128 a[252:255], v2 offset:60416
buffer_load_dwordx4 v[168:171], v128, s[24:27], s36 offen offset:3072 sc1
s_waitcnt vmcnt(9) lgkmcnt(4)
v_mfma_f32_32x32x16_bf16 v[32:47], a[232:235], v[148:151], v[32:47]
ds_read_b128 a[224:227], v2 offset:32768
buffer_load_dwordx4 v[172:175], v128, s[24:27], s36 offen offset:3584 sc1
v_mfma_f32_32x32x16_bf16 v[48:63], a[236:239], v[148:151], v[48:63]
ds_read_b128 a[228:231], v2 offset:61440
buffer_load_dwordx4 v[176:179], v128, s[24:27], s37 offen offset:0 sc1
s_waitcnt vmcnt(10) lgkmcnt(4)
v_mfma_f32_32x32x16_bf16 v[32:47], a[240:243], v[152:155], v[32:47]
ds_read_b128 a[232:235], v2 offset:33792
buffer_load_dwordx4 v[180:183], v128, s[24:27], s37 offen offset:512 sc1
s_add_u32 m0, s4, 0
s_add_u32 s11, s10, 57344
buffer_load_dwordx4 v2, s[24:27], s11 offen offset:0 sc1 lds
v_mfma_f32_32x32x16_bf16 v[48:63], a[244:247], v[152:155], v[48:63]
ds_read_b128 a[236:239], v2 offset:62464
buffer_load_dwordx4 v[184:187], v128, s[24:27], s37 offen offset:1024 sc1
s_waitcnt vmcnt(7)
v_add_f32 v136, v136, v138
v_add_f32_e64 v137, v137, v139
v_add_f32 v140, v140, v142
s_waitcnt lgkmcnt(4)
v_mfma_f32_32x32x16_bf16 v[32:47], a[248:251], v[156:159], v[32:47]
ds_read_b128 a[240:243], v2 offset:34816
buffer_load_dwordx4 v[188:191], v128, s[24:27], s37 offen offset:1536 sc1
buffer_load_dwordx4 v2, s[24:27], s11 offen offset:1024 sc1 lds
v_add_f32 v141, v141, v143
v_add_f32 v136, v136, v140
v_mfma_f32_32x32x16_bf16 v[48:63], a[252:255], v[156:159], v[48:63]
ds_read_b128 a[244:247], v2 offset:63488
buffer_load_dwordx4 v[192:195], v128, s[24:27], s37 offen offset:2048 sc1
v_add_f32 v137, v137, v141
v_mov_b32 v138, v136
v_mov_b32 v139, v137
s_waitcnt lgkmcnt(4)
v_mfma_f32_32x32x16_bf16 v[32:47], a[224:227], v[160:163], v[32:47]
ds_read_b128 a[248:251], v2 offset:35840
buffer_load_dwordx4 v[196:199], v128, s[24:27], s37 offen offset:2560 sc1
buffer_load_dwordx4 v2, s[24:27], s11 offen offset:2048 sc1 lds
v_permlane32_swap_b32_e64 v136, v138
v_mfma_f32_32x32x16_bf16 v[48:63], a[228:231], v[160:163], v[48:63]
ds_read_b128 a[252:255], v2 offset:64512
buffer_load_dwordx4 v[200:203], v128, s[24:27], s37 offen offset:3072 sc1
v_permlane32_swap_b32 v137, v139
v_add_f32 v136, v136, v138
v_add_f32 v137, v137, v139
s_waitcnt vmcnt(12) lgkmcnt(4)
v_mfma_f32_32x32x16_bf16 v[32:47], a[232:235], v[164:167], v[32:47]
ds_read_b128 a[224:227], v2 offset:36864
buffer_load_dwordx4 v[204:207], v128, s[24:27], s37 offen offset:3584 sc1
buffer_load_dwordx4 v2, s[24:27], s11 offen offset:3072 sc1 lds
v_mul_f32 v133, 0xbb124925, v136
v_mul_f32_e64 v138, v133, v133
v_mfma_f32_32x32x16_bf16 v[48:63], a[236:239], v[164:167], v[48:63]
ds_read_b128 a[228:231], v3 offset:0
buffer_load_dwordx4 v[208:211], v128, s[24:27], s38 offen offset:0 sc1
v_fma_f32 v138, v137, s100, -v138
v_max_f32 v138, 0, v138
v_add_f32 v138, 0x3727c5ac, v138
s_waitcnt vmcnt(14) lgkmcnt(4)
v_mfma_f32_32x32x16_bf16 v[32:47], a[240:243], v[168:171], v[32:47]
ds_read_b128 a[232:235], v2 offset:37888
buffer_load_dwordx4 v[212:215], v128, s[24:27], s38 offen offset:512 sc1
s_add_u32 m0, s4, 4096
s_add_u32 s11, s10, 61440
buffer_load_dwordx4 v2, s[24:27], s11 offen offset:0 sc1 lds
v_mfma_f32_32x32x16_bf16 v[48:63], a[244:247], v[168:171], v[48:63]
ds_read_b128 a[236:239], v3 offset:1024
buffer_load_dwordx4 v[216:219], v128, s[24:27], s38 offen offset:1024 sc1
v_rsq_f32_e64 v134, v138
s_nop 0
v_mul_f32 v135, 0xbfb8aa3b, v134
ds_read_b128 v[96:99], v132 offset:0
s_waitcnt vmcnt(16) lgkmcnt(5)
v_mfma_f32_32x32x16_bf16 v[32:47], a[248:251], v[172:175], v[32:47]
ds_read_b128 a[240:243], v2 offset:38912
buffer_load_dwordx4 v[220:223], v128, s[24:27], s38 offen offset:1536 sc1
buffer_load_dwordx4 v2, s[24:27], s11 offen offset:1024 sc1 lds
ds_read_b128 v[100:103], v132 offset:32
ds_read_b128 v[104:107], v132 offset:64
v_mfma_f32_32x32x16_bf16 v[48:63], a[252:255], v[172:175], v[48:63]
ds_read_b128 a[244:247], v3 offset:2048
buffer_load_dwordx4 v[224:227], v128, s[24:27], s38 offen offset:2048 sc1
ds_read_b128 v[108:111], v132 offset:96
s_waitcnt vmcnt(18) lgkmcnt(8)
v_mfma_f32_32x32x16_bf16 v[32:47], a[224:227], v[176:179], v[32:47]
ds_read_b128 a[248:251], v2 offset:39936
buffer_load_dwordx4 v[228:231], v128, s[24:27], s38 offen offset:2560 sc1
buffer_load_dwordx4 v2, s[24:27], s11 offen offset:2048 sc1 lds
v_mfma_f32_32x32x16_bf16 v[48:63], a[228:231], v[176:179], v[48:63]
ds_read_b128 a[252:255], v3 offset:3072
buffer_load_dwordx4 v[232:235], v128, s[24:27], s38 offen offset:3072 sc1
s_waitcnt vmcnt(20) lgkmcnt(8)
v_mfma_f32_32x32x16_bf16 v[32:47], a[232:235], v[180:183], v[32:47]
ds_read_b128 a[224:227], v2 offset:40960
buffer_load_dwordx4 v[236:239], v128, s[24:27], s38 offen offset:3584 sc1
s_add_u32 m0, s4, 86016
s_add_u32 s11, s10, 86016
buffer_load_dwordx4 v2, s[24:27], s11 offen offset:0 sc1 lds
v_mfma_f32_32x32x16_bf16 v[48:63], a[236:239], v[180:183], v[48:63]
ds_read_b128 a[228:231], v3 offset:4096
s_waitcnt vmcnt(20) lgkmcnt(5)
v_mfma_f32_32x32x16_bf16 v[32:47], a[240:243], v[184:187], v[32:47]
ds_read_b128 a[232:235], v2 offset:41984
buffer_load_dwordx4 v[240:243], v128, s[24:27], s39 offen offset:0 sc1
buffer_load_dwordx4 v2, s[24:27], s11 offen offset:1024 sc1 lds
v_mfma_f32_32x32x16_bf16 v[48:63], a[244:247], v[184:187], v[48:63]
ds_read_b128 a[236:239], v3 offset:5120
s_waitcnt vmcnt(21) lgkmcnt(4)
v_mfma_f32_32x32x16_bf16 v[32:47], a[248:251], v[188:191], v[32:47]
ds_read_b128 a[240:243], v2 offset:43008
buffer_load_dwordx4 v[244:247], v128, s[24:27], s39 offen offset:512 sc1
buffer_load_dwordx4 v2, s[24:27], s11 offen offset:2048 sc1 lds
v_mfma_f32_32x32x16_bf16 v[48:63], a[252:255], v[188:191], v[48:63]
ds_read_b128 a[244:247], v3 offset:6144
s_waitcnt vmcnt(21) lgkmcnt(4)
v_mfma_f32_32x32x16_bf16 v[32:47], a[224:227], v[192:195], v[32:47]
ds_read_b128 a[248:251], v2 offset:44032
buffer_load_dwordx4 v[248:251], v128, s[24:27], s39 offen offset:1024 sc1
buffer_load_dwordx4 v2, s[24:27], s11 offen offset:3072 sc1 lds
v_mfma_f32_32x32x16_bf16 v[48:63], a[228:231], v[192:195], v[48:63]
ds_read_b128 a[252:255], v3 offset:7168
s_waitcnt vmcnt(22) lgkmcnt(4)
v_mfma_f32_32x32x16_bf16 v[32:47], a[232:235], v[196:199], v[32:47]
ds_read_b128 a[224:227], v2 offset:45056
buffer_load_dwordx4 v[252:255], v128, s[24:27], s39 offen offset:1536 sc1
s_add_u32 m0, s4, 90112
s_add_u32 s11, s10, 90112
buffer_load_dwordx4 v2, s[24:27], s11 offen offset:0 sc1 lds
v_mfma_f32_32x32x16_bf16 v[48:63], a[236:239], v[196:199], v[48:63]
ds_read_b128 a[228:231], v3 offset:8192
s_waitcnt vmcnt(22) lgkmcnt(4)
v_mfma_f32_32x32x16_bf16 v[32:47], a[240:243], v[200:203], v[32:47]
ds_read_b128 a[232:235], v2 offset:46080
buffer_load_dwordx4 v2, s[24:27], s11 offen offset:1024 sc1 lds
v_mfma_f32_32x32x16_bf16 v[48:63], a[244:247], v[200:203], v[48:63]
ds_read_b128 a[236:239], v3 offset:9216
s_waitcnt vmcnt(22) lgkmcnt(4)
v_mfma_f32_32x32x16_bf16 v[32:47], a[248:251], v[204:207], v[32:47]
ds_read_b128 a[240:243], v2 offset:47104
buffer_load_dwordx4 v2, s[24:27], s11 offen offset:2048 sc1 lds
v_mfma_f32_32x32x16_bf16 v[48:63], a[252:255], v[204:207], v[48:63]
ds_read_b128 a[244:247], v3 offset:10240
s_waitcnt vmcnt(21) lgkmcnt(4)
v_mfma_f32_32x32x16_bf16 v[32:47], a[224:227], v[208:211], v[32:47]
ds_read_b128 a[248:251], v2 offset:48128
s_add_u32 m0, s4, 114688
s_add_u32 s11, s10, 114688
buffer_load_dwordx4 v2, s[24:27], s11 offen offset:0 sc1 lds
v_mfma_f32_32x32x16_bf16 v[48:63], a[228:231], v[208:211], v[48:63]
ds_read_b128 a[252:255], v3 offset:11264
s_waitcnt vmcnt(21) lgkmcnt(4)
v_mfma_f32_32x32x16_bf16 v[32:47], a[232:235], v[212:215], v[32:47]
ds_read_b128 a[224:227], v2 offset:49152
buffer_load_dwordx4 v2, s[24:27], s11 offen offset:1024 sc1 lds
v_mfma_f32_32x32x16_bf16 v[48:63], a[236:239], v[212:215], v[48:63]
ds_read_b128 a[228:231], v3 offset:12288
s_waitcnt vmcnt(20) lgkmcnt(4)
v_mfma_f32_32x32x16_bf16 v[32:47], a[240:243], v[216:219], v[32:47]
ds_read_b128 a[232:235], v2 offset:50176
buffer_load_dwordx4 v2, s[24:27], s11 offen offset:2048 sc1 lds
v_mfma_f32_32x32x16_bf16 v[48:63], a[244:247], v[216:219], v[48:63]
ds_read_b128 a[236:239], v3 offset:13312
s_waitcnt vmcnt(20) lgkmcnt(4)
v_mfma_f32_32x32x16_bf16 v[32:47], a[248:251], v[220:223], v[32:47]
ds_read_b128 a[240:243], v2 offset:51200
buffer_load_dwordx4 v2, s[24:27], s11 offen offset:3072 sc1 lds
v_mfma_f32_32x32x16_bf16 v[48:63], a[252:255], v[220:223], v[48:63]
ds_read_b128 a[244:247], v3 offset:14336
s_waitcnt vmcnt(19) lgkmcnt(4)
v_mfma_f32_32x32x16_bf16 v[32:47], a[224:227], v[224:227], v[32:47]
ds_read_b128 a[248:251], v2 offset:52224
s_add_u32 m0, s4, 118784
s_add_u32 s11, s10, 118784
buffer_load_dwordx4 v2, s[24:27], s11 offen offset:0 sc1 lds
v_mfma_f32_32x32x16_bf16 v[48:63], a[228:231], v[224:227], v[48:63]
ds_read_b128 a[252:255], v3 offset:15360
s_waitcnt vmcnt(19) lgkmcnt(4)
v_mfma_f32_32x32x16_bf16 v[32:47], a[232:235], v[228:231], v[32:47]
ds_read_b128 a[224:227], v2 offset:53248
buffer_load_dwordx4 v2, s[24:27], s11 offen offset:1024 sc1 lds
v_mfma_f32_32x32x16_bf16 v[48:63], a[236:239], v[228:231], v[48:63]
ds_read_b128 a[228:231], v3 offset:16384
s_waitcnt vmcnt(18) lgkmcnt(4)
v_mfma_f32_32x32x16_bf16 v[32:47], a[240:243], v[232:235], v[32:47]
ds_read_b128 a[232:235], v2 offset:54272
buffer_load_dwordx4 v2, s[24:27], s11 offen offset:2048 sc1 lds
v_mfma_f32_32x32x16_bf16 v[48:63], a[244:247], v[232:235], v[48:63]
ds_read_b128 a[236:239], v3 offset:17408
s_waitcnt vmcnt(18) lgkmcnt(4)
v_mfma_f32_32x32x16_bf16 v[32:47], a[248:251], v[236:239], v[32:47]
ds_read_b128 a[240:243], v2 offset:55296
s_add_u32 s12, s91, 0
buffer_load_dwordx4 a[0:3], v2, s[24:27], s12 offen offset:0 sc1
v_mfma_f32_32x32x16_bf16 v[48:63], a[252:255], v[236:239], v[48:63]
ds_read_b128 a[244:247], v3 offset:18432
s_waitcnt vmcnt(17) lgkmcnt(4)
v_mfma_f32_32x32x16_bf16 v[32:47], a[224:227], v[240:243], v[32:47]
ds_read_b128 a[248:251], v2 offset:56320
buffer_load_dwordx4 a[4:7], v2, s[24:27], s12 offen offset:1024 sc1
v_mfma_f32_32x32x16_bf16 v[48:63], a[228:231], v[240:243], v[48:63]
ds_read_b128 a[252:255], v3 offset:19456
s_barrier
s_waitcnt vmcnt(16) lgkmcnt(4)
v_mfma_f32_32x32x16_bf16 v[32:47], a[232:235], v[244:247], v[32:47]
ds_read_b128 a[224:227], v2 offset:0
buffer_load_dwordx4 a[8:11], v2, s[24:27], s12 offen offset:2048 sc1
v_mfma_f32_32x32x16_bf16 v[48:63], a[236:239], v[244:247], v[48:63]
ds_read_b128 a[228:231], v2 offset:1024
s_waitcnt vmcnt(15) lgkmcnt(4)
v_mfma_f32_32x32x16_bf16 v[32:47], a[240:243], v[248:251], v[32:47]
ds_read_b128 a[232:235], v2 offset:2048
buffer_load_dwordx4 a[12:15], v2, s[24:27], s12 offen offset:3072 sc1
v_mfma_f32_32x32x16_bf16 v[48:63], a[244:247], v[248:251], v[48:63]
ds_read_b128 a[236:239], v2 offset:3072
s_waitcnt vmcnt(14) lgkmcnt(4)
v_mfma_f32_32x32x16_bf16 v[32:47], a[248:251], v[252:255], v[32:47]
ds_read_b128 a[240:243], v2 offset:4096
s_add_u32 s12, s91, 4096
buffer_load_dwordx4 a[16:19], v2, s[24:27], s12 offen offset:0 sc1
v_mfma_f32_32x32x16_bf16 v[48:63], a[252:255], v[252:255], v[48:63]
ds_read_b128 a[244:247], v2 offset:5120
s_barrier
s_waitcnt lgkmcnt(3)
v_mfma_f32_32x32x16_bf16 v[64:79], a[224:227], v[144:147], 0
ds_read_b128 a[248:251], v2 offset:6144
s_getpc_b64 s[92:93]
Lc24:
s_sub_u32 s92, s92, Lc24-Lpc
s_subb_u32 s93, s93, 0
s_and_b32 s13, s44, 1
s_lshl_b32 s13, s13, 4
s_add_u32 s13, s13, s45
s_mul_i32 s13, s13, CODE_NL
v_min_u32 v30, CODE_NL-1, v1
v_add_u32 v30, s13, v30
v_lshlrev_b32 v30, 7, v30
v_min_u32 v30, Lcode_end-Lpc-4, v30
global_load_dword v16, v30, s[92:93]
v_mfma_f32_32x32x16_bf16 v[64:79], a[228:231], v[148:151], v[64:79]
ds_read_b128 a[252:255], v2 offset:7168
v_fma_f32 v32, v96, v133, v32
v_fma_f32 v33, v97, v133, v33
v_fma_f32 v34, v98, v133, v34
v_fma_f32 v35, v99, v133, v35
v_mfma_f32_32x32x16_bf16 v[64:79], a[232:235], v[152:155], v[64:79]
ds_read_b128 a[224:227], v2 offset:8192
s_add_u32 m0, s4, 28672
s_add_u32 s11, s10, 143360
buffer_load_dwordx4 v2, s[24:27], s11 offen offset:0 sc1 lds
v_fma_f32 v36, v100, v133, v36
v_fma_f32 v37, v101, v133, v37
s_waitcnt lgkmcnt(3)
v_mfma_f32_32x32x16_bf16 v[64:79], a[236:239], v[156:159], v[64:79]
ds_read_b128 a[228:231], v2 offset:9216
v_fma_f32 v38, v102, v133, v38
v_fma_f32 v39, v103, v133, v39
v_fma_f32 v40, v104, v133, v40
v_fma_f32 v41, v105, v133, v41
v_mfma_f32_32x32x16_bf16 v[64:79], a[240:243], v[160:163], v[64:79]
ds_read_b128 a[232:235], v2 offset:10240
buffer_load_dwordx4 v2, s[24:27], s11 offen offset:1024 sc1 lds
v_fma_f32 v42, v106, v133, v42
v_fma_f32 v43, v107, v133, v43
v_fma_f32 v44, v108, v133, v44
v_fma_f32 v45, v109, v133, v45
v_mfma_f32_32x32x16_bf16 v[64:79], a[244:247], v[164:167], v[64:79]
ds_read_b128 a[236:239], v2 offset:11264
v_fma_f32 v46, v110, v133, v46
v_fma_f32 v47, v111, v133, v47
ds_read_b128 v[96:99], v132 offset:128
ds_read_b128 v[100:103], v132 offset:160
ds_read_b128 v[104:107], v132 offset:192
s_waitcnt lgkmcnt(6)
v_mfma_f32_32x32x16_bf16 v[64:79], a[248:251], v[168:171], v[64:79]
ds_read_b128 a[240:243], v2 offset:12288
buffer_load_dwordx4 v2, s[24:27], s11 offen offset:2048 sc1 lds
ds_read_b128 v[108:111], v132 offset:224
v_mul_f32 v112, v135, v32
v_mul_f32_e64 v113, v135, v33
v_mfma_f32_32x32x16_bf16 v[64:79], a[252:255], v[172:175], v[64:79]
ds_read_b128 a[244:247], v2 offset:13312
v_mul_f32 v114, v135, v34
v_mul_f32 v115, v135, v35
v_mul_f32 v116, v135, v36
v_mul_f32 v117, v135, v37
v_mul_f32_e64 v118, v135, v38
v_mfma_f32_32x32x16_bf16 v[64:79], a[224:227], v[176:179], v[64:79]
ds_read_b128 a[248:251], v2 offset:14336
buffer_load_dwordx4 v2, s[24:27], s11 offen offset:3072 sc1 lds
v_mul_f32_e64 v119, v135, v39
v_exp_f32 v112, v112
s_waitcnt lgkmcnt(7)
v_mfma_f32_32x32x16_bf16 v[64:79], a[228:231], v[180:183], v[64:79]
ds_read_b128 a[252:255], v2 offset:15360
v_exp_f32 v113, v113
v_exp_f32 v114, v114
v_mfma_f32_32x32x16_bf16 v[64:79], a[232:235], v[184:187], v[64:79]
ds_read_b128 a[224:227], v2 offset:16384
s_add_u32 m0, s4, 32768
s_add_u32 s11, s10, 147456
buffer_load_dwordx4 v2, s[24:27], s11 offen offset:0 sc1 lds
v_exp_f32_e64 v115, v115
v_mfma_f32_32x32x16_bf16 v[64:79], a[236:239], v[188:191], v[64:79]
ds_read_b128 a[228:231], v2 offset:17408
v_exp_f32_e64 v116, v116
v_exp_f32 v117, v117
s_waitcnt lgkmcnt(3)
v_mfma_f32_32x32x16_bf16 v[64:79], a[240:243], v[192:195], v[64:79]
ds_read_b128 a[232:235], v2 offset:18432
buffer_load_dwordx4 v2, s[24:27], s11 offen offset:1024 sc1 lds
v_exp_f32_e64 v118, v118
v_mfma_f32_32x32x16_bf16 v[64:79], a[244:247], v[196:199], v[64:79]
ds_read_b128 a[236:239], v2 offset:19456
v_exp_f32 v119, v119
v_mul_f32 v32, v32, v40
v_mul_f32 v33, v33, v41
v_mul_f32 v34, v34, v42
v_mfma_f32_32x32x16_bf16 v[64:79], a[248:251], v[200:203], v[64:79]
ds_read_b128 a[240:243], v2 offset:20480
buffer_load_dwordx4 v2, s[24:27], s11 offen offset:2048 sc1 lds
v_mul_f32 v35, v35, v43
v_mul_f32 v36, v36, v44
v_mul_f32_e64 v37, v37, v45
v_mul_f32 v38, v38, v46
s_waitcnt lgkmcnt(3)
v_mfma_f32_32x32x16_bf16 v[64:79], a[252:255], v[204:207], v[64:79]
ds_read_b128 a[244:247], v2 offset:21504
v_mul_f32 v39, v39, v47
v_add_f32 v112, 1.0, v112
v_add_f32 v113, 1.0, v113
v_add_f32 v114, 1.0, v114
v_mfma_f32_32x32x16_bf16 v[64:79], a[224:227], v[208:211], v[64:79]
ds_read_b128 a[248:251], v2 offset:22528
s_add_u32 m0, s4, 57344
s_add_u32 s11, s10, 172032
buffer_load_dwordx4 v2, s[24:27], s11 offen offset:0 sc1 lds
v_add_f32 v115, 1.0, v115
v_add_f32 v116, 1.0, v116
v_mfma_f32_32x32x16_bf16 v[64:79], a[228:231], v[212:215], v[64:79]
ds_read_b128 a[252:255], v2 offset:23552
v_add_f32 v117, 1.0, v117
v_add_f32 v118, 1.0, v118
v_add_f32_e64 v119, 1.0, v119
v_rcp_f32 v112, v112
s_waitcnt lgkmcnt(3)
v_mfma_f32_32x32x16_bf16 v[64:79], a[232:235], v[216:219], v[64:79]
ds_read_b128 a[224:227], v2 offset:24576
buffer_load_dwordx4 v2, s[24:27], s11 offen offset:1024 sc1 lds
v_rcp_f32_e64 v113, v113
v_mfma_f32_32x32x16_bf16 v[64:79], a[236:239], v[220:223], v[64:79]
ds_read_b128 a[228:231], v2 offset:25600
v_rcp_f32 v114, v114
v_rcp_f32 v115, v115
v_mfma_f32_32x32x16_bf16 v[64:79], a[240:243], v[224:227], v[64:79]
ds_read_b128 a[232:235], v2 offset:26624
buffer_load_dwordx4 v2, s[24:27], s11 offen offset:2048 sc1 lds
v_rcp_f32_e64 v116, v116
v_rcp_f32 v117, v117
s_waitcnt lgkmcnt(3)
v_mfma_f32_32x32x16_bf16 v[64:79], a[244:247], v[228:231], v[64:79]
ds_read_b128 a[236:239], v2 offset:27648
v_rcp_f32 v118, v118
v_rcp_f32 v119, v119
buffer_load_dwordx4 v2, s[24:27], s11 offen offset:3072 sc1 lds
s_waitcnt vmcnt(24)
s_barrier
v_mfma_f32_32x32x16_bf16 v[64:79], a[248:251], v[232:235], v[64:79]
ds_read_b128 a[240:243], v3 offset:20480
s_add_u32 m0, s4, 61440
s_add_u32 s11, s10, 176128
buffer_load_dwordx4 v2, s[24:27], s11 offen offset:0 sc1 lds
v_mul_f32 v32, v32, v112
v_mul_f32 v33, v33, v113
v_mfma_f32_32x32x16_bf16 v[64:79], a[252:255], v[236:239], v[64:79]
ds_read_b128 a[244:247], v3 offset:21504
v_mul_f32 v34, v34, v114
v_mul_f32 v35, v35, v115
v_mul_f32 v36, v36, v116
v_mul_f32 v37, v37, v117
v_mul_f32 v38, v38, v118
s_waitcnt lgkmcnt(3)
v_mfma_f32_32x32x16_bf16 v[64:79], a[224:227], v[240:243], v[64:79]
ds_read_b128 a[248:251], v3 offset:22528
buffer_load_dwordx4 v2, s[24:27], s11 offen offset:1024 sc1 lds
v_mul_f32_e64 v39, v39, v119
v_cvt_pk_bf16_f32 v120, v32, v33
v_cvt_pk_bf16_f32 v121, v34, v35
v_mfma_f32_32x32x16_bf16 v[64:79], a[228:231], v[244:247], v[64:79]
ds_read_b128 a[252:255], v3 offset:23552
v_cvt_pk_bf16_f32 v122, v36, v37
v_cvt_pk_bf16_f32 v123, v38, v39
buffer_store_dwordx4 v[120:123], v131, s[24:27], s96 offen offset:0 sc1
v_fma_f32 v48, v96, v133, v48
v_mfma_f32_32x32x16_bf16 v[64:79], a[232:235], v[248:251], v[64:79]
ds_read_b128 a[224:227], v3 offset:24576
buffer_load_dwordx4 v2, s[24:27], s11 offen offset:2048 sc1 lds
v_fma_f32 v49, v97, v133, v49
v_fma_f32 v50, v98, v133, v50
v_fma_f32 v51, v99, v133, v51
v_fma_f32 v52, v100, v133, v52
s_waitcnt lgkmcnt(3)
v_mfma_f32_32x32x16_bf16 v[64:79], a[236:239], v[252:255], v[64:79]
ds_read_b128 a[228:231], v3 offset:25600
v_fma_f32 v53, v101, v133, v53
v_fma_f32 v54, v102, v133, v54
v_fma_f32 v55, v103, v133, v55
v_fma_f32 v56, v104, v133, v56
v_mfma_f32_32x32x16_bf16 v[80:95], a[240:243], v[144:147], 0
ds_read_b128 a[232:235], v3 offset:26624
buffer_load_dwordx4 a[20:23], v2, s[24:27], s12 offen offset:1024 sc1
v_mfma_f32_32x32x16_bf16 v[80:95], a[244:247], v[148:151], v[80:95]
ds_read_b128 a[236:239], v3 offset:27648
v_fma_f32 v57, v105, v133, v57
v_fma_f32 v58, v106, v133, v58
v_fma_f32 v59, v107, v133, v59
v_fma_f32 v60, v108, v133, v60
v_fma_f32 v61, v109, v133, v61
s_waitcnt lgkmcnt(3)
v_mfma_f32_32x32x16_bf16 v[80:95], a[248:251], v[152:155], v[80:95]
ds_read_b128 a[240:243], v3 offset:28672
buffer_load_dwordx4 a[24:27], v2, s[24:27], s12 offen offset:2048 sc1
v_fma_f32 v62, v110, v133, v62
v_fma_f32 v63, v111, v133, v63
ds_read_b128 v[96:99], v132 offset:256
v_mfma_f32_32x32x16_bf16 v[80:95], a[252:255], v[156:159], v[80:95]
ds_read_b128 a[244:247], v3 offset:29696
ds_read_b128 v[100:103], v132 offset:288
ds_read_b128 v[104:107], v132 offset:320
ds_read_b128 v[108:111], v132 offset:352
v_mul_f32 v112, v135, v48
v_mul_f32 v113, v135, v49
v_mfma_f32_32x32x16_bf16 v[80:95], a[224:227], v[160:163], v[80:95]
ds_read_b128 a[248:251], v3 offset:30720
buffer_load_dwordx4 a[28:31], v2, s[24:27], s12 offen offset:3072 sc1
v_mul_f32 v114, v135, v50
v_mul_f32 v115, v135, v51
v_mul_f32_e64 v116, v135, v52
v_mul_f32 v117, v135, v53
s_waitcnt lgkmcnt(7)
v_mfma_f32_32x32x16_bf16 v[80:95], a[228:231], v[164:167], v[80:95]
ds_read_b128 a[252:255], v3 offset:31744
v_mul_f32 v118, v135, v54
v_mul_f32 v119, v135, v55
v_exp_f32_e64 v112, v112
v_mfma_f32_32x32x16_bf16 v[80:95], a[232:235], v[168:171], v[80:95]
ds_read_b128 a[224:227], v3 offset:32768
s_add_u32 s12, s91, 8192
buffer_load_dwordx4 a[32:35], v2, s[24:27], s12 offen offset:0 sc1
v_exp_f32_e64 v113, v113
v_mfma_f32_32x32x16_bf16 v[80:95], a[236:239], v[172:175], v[80:95]
ds_read_b128 a[228:231], v3 offset:33792
v_exp_f32_e64 v114, v114
v_exp_f32 v115, v115
s_waitcnt lgkmcnt(3)
v_mfma_f32_32x32x16_bf16 v[80:95], a[240:243], v[176:179], v[80:95]
ds_read_b128 a[232:235], v3 offset:34816
buffer_load_dwordx4 a[36:39], v2, s[24:27], s12 offen offset:1024 sc1
v_exp_f32_e64 v116, v116
v_mfma_f32_32x32x16_bf16 v[80:95], a[244:247], v[180:183], v[80:95]
ds_read_b128 a[236:239], v3 offset:35840
v_exp_f32 v117, v117
v_exp_f32 v118, v118
v_mfma_f32_32x32x16_bf16 v[80:95], a[248:251], v[184:187], v[80:95]
ds_read_b128 a[240:243], v3 offset:36864
buffer_load_dwordx4 a[40:43], v2, s[24:27], s12 offen offset:2048 sc1
v_exp_f32 v119, v119
v_mul_f32 v48, v48, v56
v_mul_f32 v49, v49, v57
s_waitcnt lgkmcnt(3)
v_mfma_f32_32x32x16_bf16 v[80:95], a[252:255], v[188:191], v[80:95]
ds_read_b128 a[244:247], v3 offset:37888
v_mul_f32 v50, v50, v58
v_mul_f32 v51, v51, v59
v_mul_f32 v52, v52, v60
v_mul_f32 v53, v53, v61
v_mfma_f32_32x32x16_bf16 v[80:95], a[224:227], v[192:195], v[80:95]
ds_read_b128 a[248:251], v3 offset:38912
buffer_load_dwordx4 a[44:47], v2, s[24:27], s12 offen offset:3072 sc1
v_mul_f32 v54, v54, v62
v_mul_f32 v55, v55, v63
v_add_f32 v112, 1.0, v112
v_add_f32 v113, 1.0, v113
v_mfma_f32_32x32x16_bf16 v[80:95], a[228:231], v[196:199], v[80:95]
ds_read_b128 a[252:255], v3 offset:39936
v_add_f32 v114, 1.0, v114
v_add_f32 v115, 1.0, v115
v_add_f32 v116, 1.0, v116
v_add_f32 v117, 1.0, v117
v_add_f32 v118, 1.0, v118
s_waitcnt lgkmcnt(3)
v_mfma_f32_32x32x16_bf16 v[80:95], a[232:235], v[200:203], v[80:95]
ds_read_b128 a[224:227], v3 offset:40960
s_add_u32 s12, s91, 12288
buffer_load_dwordx4 a[48:51], v2, s[24:27], s12 offen offset:0 sc1
v_add_f32_e64 v119, 1.0, v119
v_mfma_f32_32x32x16_bf16 v[80:95], a[236:239], v[204:207], v[80:95]
ds_read_b128 a[228:231], v3 offset:41984
v_rcp_f32 v112, v112
v_rcp_f32 v113, v113
v_mfma_f32_32x32x16_bf16 v[80:95], a[240:243], v[208:211], v[80:95]
ds_read_b128 a[232:235], v3 offset:43008
buffer_load_dwordx4 a[52:55], v2, s[24:27], s12 offen offset:1024 sc1
v_rcp_f32_e64 v114, v114
v_rcp_f32 v115, v115
s_waitcnt lgkmcnt(3)
v_mfma_f32_32x32x16_bf16 v[80:95], a[244:247], v[212:215], v[80:95]
ds_read_b128 a[236:239], v3 offset:44032
v_rcp_f32 v116, v116
v_rcp_f32 v117, v117
v_mfma_f32_32x32x16_bf16 v[80:95], a[248:251], v[216:219], v[80:95]
ds_read_b128 a[240:243], v3 offset:45056
buffer_load_dwordx4 a[56:59], v2, s[24:27], s12 offen offset:2048 sc1
v_rcp_f32 v118, v118
v_rcp_f32 v119, v119
v_mfma_f32_32x32x16_bf16 v[80:95], a[252:255], v[220:223], v[80:95]
ds_read_b128 a[244:247], v3 offset:46080
v_mul_f32 v48, v48, v112
v_mul_f32 v49, v49, v113
v_mul_f32 v50, v50, v114
v_mul_f32 v51, v51, v115
v_mul_f32 v52, v52, v116
s_waitcnt lgkmcnt(3)
v_mfma_f32_32x32x16_bf16 v[80:95], a[224:227], v[224:227], v[80:95]
ds_read_b128 a[248:251], v3 offset:47104
buffer_load_dwordx4 a[60:63], v2, s[24:27], s12 offen offset:3072 sc1
v_mul_f32 v53, v53, v117
v_mul_f32 v54, v54, v118
v_mul_f32_e64 v55, v55, v119
v_mfma_f32_32x32x16_bf16 v[80:95], a[228:231], v[228:231], v[80:95]
ds_read_b128 a[252:255], v3 offset:48128
v_cvt_pk_bf16_f32 v124, v48, v49
v_cvt_pk_bf16_f32 v125, v50, v51
v_cvt_pk_bf16_f32 v126, v52, v53
v_cvt_pk_bf16_f32 v127, v54, v55
buffer_store_dwordx4 v[124:127], v131, s[24:27], s96 offen offset:512 sc1
s_waitcnt vmcnt(33)
s_barrier
v_mfma_f32_32x32x16_bf16 v[80:95], a[232:235], v[232:235], v[80:95]
ds_read_b128 a[224:227], v3 offset:49152
s_add_u32 s12, s91, 16384
buffer_load_dwordx4 a[64:67], v2, s[24:27], s12 offen offset:0 sc1
v_fma_f32 v64, v96, v133, v64
v_fma_f32 v65, v97, v133, v65
s_waitcnt lgkmcnt(3)
v_mfma_f32_32x32x16_bf16 v[80:95], a[236:239], v[236:239], v[80:95]
ds_read_b128 a[228:231], v3 offset:50176
v_fma_f32 v66, v98, v133, v66
v_fma_f32 v67, v99, v133, v67
v_fma_f32 v68, v100, v133, v68
v_fma_f32 v69, v101, v133, v69
v_mfma_f32_32x32x16_bf16 v[80:95], a[240:243], v[240:243], v[80:95]
ds_read_b128 a[232:235], v3 offset:51200
buffer_load_dwordx4 a[68:71], v2, s[24:27], s12 offen offset:1024 sc1
v_fma_f32 v70, v102, v133, v70
v_fma_f32 v71, v103, v133, v71
v_fma_f32 v72, v104, v133, v72
v_fma_f32 v73, v105, v133, v73
v_mfma_f32_32x32x16_bf16 v[80:95], a[244:247], v[244:247], v[80:95]
ds_read_b128 a[236:239], v3 offset:52224
v_fma_f32 v74, v106, v133, v74
v_fma_f32 v75, v107, v133, v75
v_fma_f32 v76, v108, v133, v76
v_fma_f32 v77, v109, v133, v77
v_fma_f32 v78, v110, v133, v78
s_waitcnt lgkmcnt(3)
v_mfma_f32_32x32x16_bf16 v[80:95], a[248:251], v[248:251], v[80:95]
ds_read_b128 a[240:243], v3 offset:53248
buffer_load_dwordx4 a[72:75], v2, s[24:27], s12 offen offset:2048 sc1
v_fma_f32 v79, v111, v133, v79
ds_read_b128 v[96:99], v132 offset:384
ds_read_b128 v[100:103], v132 offset:416
v_mfma_f32_32x32x16_bf16 v[80:95], a[252:255], v[252:255], v[80:95]
ds_read_b128 a[244:247], v3 offset:54272
ds_read_b128 v[104:107], v132 offset:448
ds_read_b128 v[108:111], v132 offset:480
v_mul_f32 v112, v135, v64
v_mul_f32 v113, v135, v65
v_mul_f32_e64 v114, v135, v66
v_mfma_f32_32x32x16_bf16 v[32:47], a[224:227], v[144:147], 0
ds_read_b128 a[248:251], v3 offset:55296
buffer_load_dwordx4 a[76:79], v2, s[24:27], s12 offen offset:3072 sc1
s_waitcnt lgkmcnt(7)
v_mfma_f32_32x32x16_bf16 v[32:47], a[228:231], v[148:151], v[32:47]
ds_read_b128 a[252:255], v3 offset:56320
v_mul_f32 v115, v135, v67
v_mul_f32 v116, v135, v68
v_mul_f32 v117, v135, v69
v_mul_f32_e64 v118, v135, v70
v_mfma_f32_32x32x16_bf16 v[32:47], a[232:235], v[152:155], v[32:47]
ds_read_b128 a[224:227], v3 offset:57344
s_add_u32 s12, s91, 20480
buffer_load_dwordx4 a[80:83], v2, s[24:27], s12 offen offset:0 sc1
v_mul_f32 v119, v135, v71
v_exp_f32 v112, v112
v_mfma_f32_32x32x16_bf16 v[32:47], a[236:239], v[156:159], v[32:47]
ds_read_b128 a[228:231], v3 offset:58368
v_exp_f32_e64 v113, v113
v_exp_f32 v114, v114
s_waitcnt lgkmcnt(3)
v_mfma_f32_32x32x16_bf16 v[32:47], a[240:243], v[160:163], v[32:47]
ds_read_b128 a[232:235], v3 offset:59392
buffer_load_dwordx4 a[84:87], v2, s[24:27], s12 offen offset:1024 sc1
v_exp_f32_e64 v115, v115
v_mfma_f32_32x32x16_bf16 v[32:47], a[244:247], v[164:167], v[32:47]
ds_read_b128 a[236:239], v3 offset:60416
v_exp_f32 v116, v116
v_exp_f32 v117, v117
v_mfma_f32_32x32x16_bf16 v[32:47], a[248:251], v[168:171], v[32:47]
ds_read_b128 a[240:243], v3 offset:61440
buffer_load_dwordx4 a[88:91], v2, s[24:27], s12 offen offset:2048 sc1
v_exp_f32_e64 v118, v118
v_exp_f32 v119, v119
s_waitcnt lgkmcnt(3)
v_mfma_f32_32x32x16_bf16 v[32:47], a[252:255], v[172:175], v[32:47]
ds_read_b128 a[244:247], v3 offset:62464
v_mul_f32 v64, v64, v72
v_mul_f32 v65, v65, v73
v_mul_f32 v66, v66, v74
v_mul_f32 v67, v67, v75
v_mfma_f32_32x32x16_bf16 v[32:47], a[224:227], v[176:179], v[32:47]
ds_read_b128 a[248:251], v3 offset:63488
buffer_load_dwordx4 a[92:95], v2, s[24:27], s12 offen offset:3072 sc1
v_mul_f32 v68, v68, v76
v_mul_f32 v69, v69, v77
v_mul_f32 v70, v70, v78
v_mul_f32 v71, v71, v79
v_mfma_f32_32x32x16_bf16 v[32:47], a[228:231], v[180:183], v[32:47]
ds_read_b128 a[252:255], v3 offset:64512
v_add_f32 v112, 1.0, v112
v_add_f32 v113, 1.0, v113
v_add_f32 v114, 1.0, v114
v_add_f32 v115, 1.0, v115
v_add_f32 v116, 1.0, v116
s_waitcnt lgkmcnt(3)
v_mfma_f32_32x32x16_bf16 v[32:47], a[232:235], v[184:187], v[32:47]
ds_read_b128 a[224:227], v4 offset:0
s_add_u32 s12, s91, 24576
buffer_load_dwordx4 a[96:99], v2, s[24:27], s12 offen offset:0 sc1
v_add_f32 v117, 1.0, v117
v_add_f32 v118, 1.0, v118
v_mfma_f32_32x32x16_bf16 v[32:47], a[236:239], v[188:191], v[32:47]
ds_read_b128 a[228:231], v4 offset:1024
v_add_f32 v119, 1.0, v119
v_rcp_f32 v112, v112
v_rcp_f32_e64 v113, v113
v_mfma_f32_32x32x16_bf16 v[32:47], a[240:243], v[192:195], v[32:47]
ds_read_b128 a[232:235], v4 offset:2048
buffer_load_dwordx4 a[100:103], v2, s[24:27], s12 offen offset:1024 sc1
v_rcp_f32_e64 v114, v114
v_rcp_f32 v115, v115
s_waitcnt lgkmcnt(3)
v_mfma_f32_32x32x16_bf16 v[32:47], a[244:247], v[196:199], v[32:47]
ds_read_b128 a[236:239], v4 offset:3072
v_rcp_f32 v116, v116
v_rcp_f32 v117, v117
v_mfma_f32_32x32x16_bf16 v[32:47], a[248:251], v[200:203], v[32:47]
ds_read_b128 a[240:243], v4 offset:4096
buffer_load_dwordx4 a[104:107], v2, s[24:27], s12 offen offset:2048 sc1
v_rcp_f32 v118, v118
v_rcp_f32 v119, v119
v_mfma_f32_32x32x16_bf16 v[32:47], a[252:255], v[204:207], v[32:47]
ds_read_b128 a[244:247], v4 offset:5120
v_mul_f32 v64, v64, v112
v_mul_f32 v65, v65, v113
v_mul_f32 v66, v66, v114
v_mul_f32 v67, v67, v115
v_mul_f32 v68, v68, v116
s_waitcnt lgkmcnt(3)
v_mfma_f32_32x32x16_bf16 v[32:47], a[224:227], v[208:211], v[32:47]
ds_read_b128 a[248:251], v4 offset:6144
buffer_load_dwordx4 a[108:111], v2, s[24:27], s12 offen offset:3072 sc1
v_mul_f32 v69, v69, v117
v_mul_f32 v70, v70, v118
v_mul_f32_e64 v71, v71, v119
v_mfma_f32_32x32x16_bf16 v[32:47], a[228:231], v[212:215], v[32:47]
ds_read_b128 a[252:255], v4 offset:7168
v_cvt_pk_bf16_f32 v120, v64, v65
v_cvt_pk_bf16_f32 v121, v66, v67
v_cvt_pk_bf16_f32 v122, v68, v69
v_cvt_pk_bf16_f32 v123, v70, v71
buffer_store_dwordx4 v[120:123], v131, s[24:27], s96 offen offset:1024 sc1
v_mfma_f32_32x32x16_bf16 v[32:47], a[232:235], v[216:219], v[32:47]
ds_read_b128 a[224:227], v4 offset:8192
s_add_u32 s12, s91, 28672
buffer_load_dwordx4 a[112:115], v2, s[24:27], s12 offen offset:0 sc1
v_fma_f32 v80, v96, v133, v80
v_fma_f32 v81, v97, v133, v81
s_waitcnt lgkmcnt(3)
v_mfma_f32_32x32x16_bf16 v[32:47], a[236:239], v[220:223], v[32:47]
ds_read_b128 a[228:231], v4 offset:9216
v_fma_f32 v82, v98, v133, v82
v_fma_f32 v83, v99, v133, v83
v_fma_f32 v84, v100, v133, v84
v_fma_f32 v85, v101, v133, v85
v_mfma_f32_32x32x16_bf16 v[32:47], a[240:243], v[224:227], v[32:47]
ds_read_b128 a[232:235], v4 offset:10240
buffer_load_dwordx4 a[116:119], v2, s[24:27], s12 offen offset:1024 sc1
v_fma_f32 v86, v102, v133, v86
v_fma_f32 v87, v103, v133, v87
v_fma_f32 v88, v104, v133, v88
v_fma_f32 v89, v105, v133, v89
v_mfma_f32_32x32x16_bf16 v[32:47], a[244:247], v[228:231], v[32:47]
ds_read_b128 a[236:239], v4 offset:11264
v_fma_f32 v90, v106, v133, v90
v_fma_f32 v91, v107, v133, v91
v_fma_f32 v92, v108, v133, v92
v_fma_f32 v93, v109, v133, v93
v_fma_f32 v94, v110, v133, v94
s_waitcnt vmcnt(35)
s_barrier
s_waitcnt lgkmcnt(3)
v_mfma_f32_32x32x16_bf16 v[32:47], a[248:251], v[232:235], v[32:47]
ds_read_b128 a[240:243], v2 offset:28672
buffer_load_dwordx4 a[120:123], v2, s[24:27], s12 offen offset:2048 sc1
v_fma_f32 v95, v111, v133, v95
ds_read_b128 v[96:99], v132 offset:512
ds_read_b128 v[100:103], v132 offset:544
v_mfma_f32_32x32x16_bf16 v[32:47], a[252:255], v[236:239], v[32:47]
ds_read_b128 a[244:247], v2 offset:29696
ds_read_b128 v[104:107], v132 offset:576
ds_read_b128 v[108:111], v132 offset:608
v_mul_f32 v112, v135, v80
v_mul_f32 v113, v135, v81
v_mul_f32_e64 v114, v135, v82
v_mfma_f32_32x32x16_bf16 v[32:47], a[224:227], v[240:243], v[32:47]
ds_read_b128 a[248:251], v2 offset:30720
buffer_load_dwordx4 a[124:127], v2, s[24:27], s12 offen offset:3072 sc1
v_mul_f32 v115, v135, v83
v_mul_f32 v116, v135, v84
v_mul_f32_e64 v117, v135, v85
v_mul_f32 v118, v135, v86
s_waitcnt lgkmcnt(7)
v_mfma_f32_32x32x16_bf16 v[32:47], a[228:231], v[244:247], v[32:47]
ds_read_b128 a[252:255], v2 offset:31744
v_mul_f32 v119, v135, v87
v_exp_f32 v112, v112
v_mfma_f32_32x32x16_bf16 v[32:47], a[232:235], v[248:251], v[32:47]
ds_read_b128 a[224:227], v2 offset:32768
s_add_u32 s12, s91, 32768
buffer_load_dwordx4 a[128:131], v2, s[24:27], s12 offen offset:0 sc1
v_exp_f32_e64 v113, v113
v_mfma_f32_32x32x16_bf16 v[32:47], a[236:239], v[252:255], v[32:47]
ds_read_b128 a[228:231], v2 offset:33792
v_exp_f32_e64 v114, v114
v_exp_f32 v115, v115
s_waitcnt lgkmcnt(3)
v_mfma_f32_32x32x16_bf16 v[48:63], a[240:243], v[144:147], 0
ds_read_b128 a[232:235], v2 offset:34816
buffer_load_dwordx4 a[132:135], v2, s[24:27], s12 offen offset:1024 sc1
v_mfma_f32_32x32x16_bf16 v[48:63], a[244:247], v[148:151], v[48:63]
ds_read_b128 a[236:239], v2 offset:35840
v_exp_f32 v116, v116
v_exp_f32 v117, v117
v_mfma_f32_32x32x16_bf16 v[48:63], a[248:251], v[152:155], v[48:63]
ds_read_b128 a[240:243], v2 offset:36864
buffer_load_dwordx4 a[136:139], v2, s[24:27], s12 offen offset:2048 sc1
v_exp_f32_e64 v118, v118
v_exp_f32 v119, v119
s_waitcnt lgkmcnt(3)
v_mfma_f32_32x32x16_bf16 v[48:63], a[252:255], v[156:159], v[48:63]
ds_read_b128 a[244:247], v2 offset:37888
v_mul_f32 v80, v80, v88
v_mul_f32 v81, v81, v89
v_mul_f32 v82, v82, v90
v_mul_f32 v83, v83, v91
v_mfma_f32_32x32x16_bf16 v[48:63], a[224:227], v[160:163], v[48:63]
ds_read_b128 a[248:251], v2 offset:38912
buffer_load_dwordx4 a[140:143], v2, s[24:27], s12 offen offset:3072 sc1
v_mul_f32 v84, v84, v92
v_mul_f32 v85, v85, v93
v_mul_f32 v86, v86, v94
v_mul_f32 v87, v87, v95
v_mfma_f32_32x32x16_bf16 v[48:63], a[228:231], v[164:167], v[48:63]
ds_read_b128 a[252:255], v2 offset:39936
v_add_f32 v112, 1.0, v112
v_add_f32 v113, 1.0, v113
v_add_f32 v114, 1.0, v114
v_add_f32 v115, 1.0, v115
v_add_f32 v116, 1.0, v116
s_waitcnt lgkmcnt(3)
v_mfma_f32_32x32x16_bf16 v[48:63], a[232:235], v[168:171], v[48:63]
ds_read_b128 a[224:227], v2 offset:40960
s_add_u32 s12, s91, 36864
buffer_load_dwordx4 a[144:147], v2, s[24:27], s12 offen offset:0 sc1
v_add_f32 v117, 1.0, v117
v_add_f32 v118, 1.0, v118
v_mfma_f32_32x32x16_bf16 v[48:63], a[236:239], v[172:175], v[48:63]
ds_read_b128 a[228:231], v2 offset:41984
v_add_f32 v119, 1.0, v119
v_rcp_f32 v112, v112
v_rcp_f32_e64 v113, v113
v_mfma_f32_32x32x16_bf16 v[48:63], a[240:243], v[176:179], v[48:63]
ds_read_b128 a[232:235], v2 offset:43008
buffer_load_dwordx4 a[148:151], v2, s[24:27], s12 offen offset:1024 sc1
v_rcp_f32_e64 v114, v114
v_rcp_f32 v115, v115
s_waitcnt lgkmcnt(3)
v_mfma_f32_32x32x16_bf16 v[48:63], a[244:247], v[180:183], v[48:63]
ds_read_b128 a[236:239], v2 offset:44032
v_rcp_f32 v116, v116
v_rcp_f32 v117, v117
v_mfma_f32_32x32x16_bf16 v[48:63], a[248:251], v[184:187], v[48:63]
ds_read_b128 a[240:243], v2 offset:45056
buffer_load_dwordx4 a[152:155], v2, s[24:27], s12 offen offset:2048 sc1
v_rcp_f32 v118, v118
v_rcp_f32 v119, v119
v_mfma_f32_32x32x16_bf16 v[48:63], a[252:255], v[188:191], v[48:63]
ds_read_b128 a[244:247], v2 offset:46080
v_mul_f32 v80, v80, v112
v_mul_f32 v81, v81, v113
v_mul_f32 v82, v82, v114
v_mul_f32 v83, v83, v115
v_mul_f32 v84, v84, v116
s_waitcnt lgkmcnt(3)
v_mfma_f32_32x32x16_bf16 v[48:63], a[224:227], v[192:195], v[48:63]
ds_read_b128 a[248:251], v2 offset:47104
buffer_load_dwordx4 a[156:159], v2, s[24:27], s12 offen offset:3072 sc1
v_mul_f32 v85, v85, v117
v_mul_f32 v86, v86, v118
v_mul_f32_e64 v87, v87, v119
v_mfma_f32_32x32x16_bf16 v[48:63], a[228:231], v[196:199], v[48:63]
ds_read_b128 a[252:255], v2 offset:48128
v_cvt_pk_bf16_f32 v124, v80, v81
v_cvt_pk_bf16_f32 v125, v82, v83
v_cvt_pk_bf16_f32 v126, v84, v85
v_cvt_pk_bf16_f32 v127, v86, v87
buffer_store_dwordx4 v[124:127], v131, s[24:27], s96 offen offset:1536 sc1
v_mfma_f32_32x32x16_bf16 v[48:63], a[232:235], v[200:203], v[48:63]
ds_read_b128 a[224:227], v2 offset:49152
s_add_u32 s12, s91, 40960
buffer_load_dwordx4 a[160:163], v2, s[24:27], s12 offen offset:0 sc1
v_fma_f32 v32, v96, v133, v32
v_fma_f32 v33, v97, v133, v33
s_waitcnt lgkmcnt(3)
v_mfma_f32_32x32x16_bf16 v[48:63], a[236:239], v[204:207], v[48:63]
ds_read_b128 a[228:231], v2 offset:50176
v_fma_f32 v34, v98, v133, v34
v_fma_f32 v35, v99, v133, v35
v_fma_f32 v36, v100, v133, v36
v_fma_f32 v37, v101, v133, v37
v_mfma_f32_32x32x16_bf16 v[48:63], a[240:243], v[208:211], v[48:63]
ds_read_b128 a[232:235], v2 offset:51200
buffer_load_dwordx4 a[164:167], v2, s[24:27], s12 offen offset:1024 sc1
v_fma_f32 v38, v102, v133, v38
v_fma_f32 v39, v103, v133, v39
v_fma_f32 v40, v104, v133, v40
v_fma_f32 v41, v105, v133, v41
v_mfma_f32_32x32x16_bf16 v[48:63], a[244:247], v[212:215], v[48:63]
ds_read_b128 a[236:239], v2 offset:52224
v_fma_f32 v42, v106, v133, v42
v_fma_f32 v43, v107, v133, v43
v_fma_f32 v44, v108, v133, v44
v_fma_f32 v45, v109, v133, v45
v_fma_f32 v46, v110, v133, v46
s_waitcnt lgkmcnt(3)
v_mfma_f32_32x32x16_bf16 v[48:63], a[248:251], v[216:219], v[48:63]
ds_read_b128 a[240:243], v2 offset:53248
buffer_load_dwordx4 a[168:171], v2, s[24:27], s12 offen offset:2048 sc1
v_fma_f32 v47, v111, v133, v47
ds_read_b128 v[96:99], v132 offset:640
ds_read_b128 v[100:103], v132 offset:672
v_mfma_f32_32x32x16_bf16 v[48:63], a[252:255], v[220:223], v[48:63]
ds_read_b128 a[244:247], v2 offset:54272
ds_read_b128 v[104:107], v132 offset:704
ds_read_b128 v[108:111], v132 offset:736
v_mul_f32 v112, v135, v32
v_mul_f32 v113, v135, v33
v_mul_f32_e64 v114, v135, v34
v_mfma_f32_32x32x16_bf16 v[48:63], a[224:227], v[224:227], v[48:63]
ds_read_b128 a[248:251], v2 offset:55296
buffer_load_dwordx4 a[172:175], v2, s[24:27], s12 offen offset:3072 sc1
v_mul_f32 v115, v135, v35
v_mul_f32 v116, v135, v36
v_mul_f32_e64 v117, v135, v37
v_mul_f32 v118, v135, v38
s_waitcnt lgkmcnt(7)
v_mfma_f32_32x32x16_bf16 v[48:63], a[228:231], v[228:231], v[48:63]
ds_read_b128 a[252:255], v2 offset:56320
v_mul_f32 v119, v135, v39
v_exp_f32 v112, v112
s_waitcnt vmcnt(42)
s_barrier
v_mfma_f32_32x32x16_bf16 v[48:63], a[232:235], v[232:235], v[48:63]
ds_read_b128 a[224:227], v2 offset:57344
s_add_u32 s12, s91, 45056
buffer_load_dwordx4 a[176:179], v2, s[24:27], s12 offen offset:0 sc1
v_exp_f32_e64 v113, v113
v_mfma_f32_32x32x16_bf16 v[48:63], a[236:239], v[236:239], v[48:63]
ds_read_b128 a[228:231], v2 offset:58368
v_exp_f32_e64 v114, v114
v_exp_f32 v115, v115
s_waitcnt lgkmcnt(3)
v_mfma_f32_32x32x16_bf16 v[48:63], a[240:243], v[240:243], v[48:63]
ds_read_b128 a[232:235], v2 offset:59392
buffer_load_dwordx4 a[180:183], v2, s[24:27], s12 offen offset:1024 sc1
v_exp_f32_e64 v116, v116
v_mfma_f32_32x32x16_bf16 v[48:63], a[244:247], v[244:247], v[48:63]
ds_read_b128 a[236:239], v2 offset:60416
v_exp_f32 v117, v117
v_exp_f32 v118, v118
v_mfma_f32_32x32x16_bf16 v[48:63], a[248:251], v[248:251], v[48:63]
ds_read_b128 a[240:243], v2 offset:61440
buffer_load_dwordx4 a[184:187], v2, s[24:27], s12 offen offset:2048 sc1
v_exp_f32 v119, v119
v_mul_f32 v32, v32, v40
v_mul_f32 v33, v33, v41
s_waitcnt lgkmcnt(3)
v_mfma_f32_32x32x16_bf16 v[48:63], a[252:255], v[252:255], v[48:63]
ds_read_b128 a[244:247], v2 offset:62464
v_mul_f32 v34, v34, v42
v_mul_f32 v35, v35, v43
v_mul_f32 v36, v36, v44
v_mul_f32 v37, v37, v45
v_mfma_f32_32x32x16_bf16 v[64:79], a[224:227], v[144:147], 0
ds_read_b128 a[248:251], v2 offset:63488
buffer_load_dwordx4 a[188:191], v2, s[24:27], s12 offen offset:3072 sc1
v_mfma_f32_32x32x16_bf16 v[64:79], a[228:231], v[148:151], v[64:79]
ds_read_b128 a[252:255], v2 offset:64512
v_mul_f32 v38, v38, v46
v_mul_f32 v39, v39, v47
v_add_f32 v112, 1.0, v112
v_add_f32 v113, 1.0, v113
v_add_f32 v114, 1.0, v114
s_waitcnt lgkmcnt(3)
v_mfma_f32_32x32x16_bf16 v[64:79], a[232:235], v[152:155], v[64:79]
ds_read_b128 a[224:227], v3 offset:0
s_add_u32 s12, s91, 49152
buffer_load_dwordx4 a[192:195], v2, s[24:27], s12 offen offset:0 sc1
v_add_f32 v115, 1.0, v115
v_add_f32 v116, 1.0, v116
v_mfma_f32_32x32x16_bf16 v[64:79], a[236:239], v[156:159], v[64:79]
ds_read_b128 a[228:231], v3 offset:1024
v_add_f32 v117, 1.0, v117
v_add_f32 v118, 1.0, v118
v_add_f32 v119, 1.0, v119
v_rcp_f32 v112, v112
v_mfma_f32_32x32x16_bf16 v[64:79], a[240:243], v[160:163], v[64:79]
ds_read_b128 a[232:235], v3 offset:2048
v_rcp_f32_e64 v113, v113
v_rcp_f32 v114, v114
s_waitcnt lgkmcnt(3)
v_mfma_f32_32x32x16_bf16 v[64:79], a[244:247], v[164:167], v[64:79]
ds_read_b128 a[236:239], v3 offset:3072
v_rcp_f32 v115, v115
v_rcp_f32 v116, v116
v_mfma_f32_32x32x16_bf16 v[64:79], a[248:251], v[168:171], v[64:79]
ds_read_b128 a[240:243], v3 offset:4096
v_rcp_f32 v117, v117
v_rcp_f32 v118, v118
v_mfma_f32_32x32x16_bf16 v[64:79], a[252:255], v[172:175], v[64:79]
ds_read_b128 a[244:247], v3 offset:5120
v_rcp_f32 v119, v119
v_mul_f32 v32, v32, v112
v_mul_f32_e64 v33, v33, v113
v_mul_f32 v34, v34, v114
s_waitcnt lgkmcnt(3)
v_mfma_f32_32x32x16_bf16 v[64:79], a[224:227], v[176:179], v[64:79]
ds_read_b128 a[248:251], v3 offset:6144
v_mul_f32 v35, v35, v115
v_mul_f32 v36, v36, v116
v_mul_f32 v37, v37, v117
v_mul_f32 v38, v38, v118
v_mfma_f32_32x32x16_bf16 v[64:79], a[228:231], v[180:183], v[64:79]
ds_read_b128 a[252:255], v3 offset:7168
v_mul_f32_e64 v39, v39, v119
v_cvt_pk_bf16_f32 v120, v32, v33
v_cvt_pk_bf16_f32 v121, v34, v35
v_cvt_pk_bf16_f32 v122, v36, v37
v_cvt_pk_bf16_f32 v123, v38, v39
v_mfma_f32_32x32x16_bf16 v[64:79], a[232:235], v[184:187], v[64:79]
ds_read_b128 a[224:227], v3 offset:8192
buffer_store_dwordx4 v[120:123], v131, s[24:27], s96 offen offset:2048 sc1
s_waitcnt lgkmcnt(3)
v_mfma_f32_32x32x16_bf16 v[64:79], a[236:239], v[188:191], v[64:79]
ds_read_b128 a[228:231], v3 offset:9216
v_mfma_f32_32x32x16_bf16 v[64:79], a[240:243], v[192:195], v[64:79]
ds_read_b128 a[232:235], v3 offset:10240
v_mfma_f32_32x32x16_bf16 v[64:79], a[244:247], v[196:199], v[64:79]
ds_read_b128 a[236:239], v3 offset:11264
s_waitcnt lgkmcnt(3)
v_mfma_f32_32x32x16_bf16 v[64:79], a[248:251], v[200:203], v[64:79]
ds_read_b128 a[240:243], v3 offset:12288
v_mfma_f32_32x32x16_bf16 v[64:79], a[252:255], v[204:207], v[64:79]
ds_read_b128 a[244:247], v3 offset:13312
v_mfma_f32_32x32x16_bf16 v[64:79], a[224:227], v[208:211], v[64:79]
ds_read_b128 a[248:251], v3 offset:14336
s_waitcnt lgkmcnt(3)
v_mfma_f32_32x32x16_bf16 v[64:79], a[228:231], v[212:215], v[64:79]
ds_read_b128 a[252:255], v3 offset:15360
v_mfma_f32_32x32x16_bf16 v[64:79], a[232:235], v[216:219], v[64:79]
ds_read_b128 a[224:227], v3 offset:16384
v_mfma_f32_32x32x16_bf16 v[64:79], a[236:239], v[220:223], v[64:79]
ds_read_b128 a[228:231], v3 offset:17408
s_waitcnt lgkmcnt(3)
v_mfma_f32_32x32x16_bf16 v[64:79], a[240:243], v[224:227], v[64:79]
ds_read_b128 a[232:235], v3 offset:18432
v_mfma_f32_32x32x16_bf16 v[64:79], a[244:247], v[228:231], v[64:79]
ds_read_b128 a[236:239], v3 offset:19456
v_mfma_f32_32x32x16_bf16 v[64:79], a[248:251], v[232:235], v[64:79]
s_waitcnt lgkmcnt(2)
v_mfma_f32_32x32x16_bf16 v[64:79], a[252:255], v[236:239], v[64:79]
v_mfma_f32_32x32x16_bf16 v[64:79], a[224:227], v[240:243], v[64:79]
v_mfma_f32_32x32x16_bf16 v[64:79], a[228:231], v[244:247], v[64:79]
s_waitcnt lgkmcnt(0)
v_mfma_f32_32x32x16_bf16 v[64:79], a[232:235], v[248:251], v[64:79]
v_mfma_f32_32x32x16_bf16 v[64:79], a[236:239], v[252:255], v[64:79]
v_pk_fma_f32 v[48:49], v[96:97], v[132:133], v[48:49] op_sel:[0,1,0] op_sel_hi:[1,1,1]
v_pk_fma_f32 v[50:51], v[98:99], v[132:133], v[50:51] op_sel:[0,1,0] op_sel_hi:[1,1,1]
v_pk_fma_f32 v[52:53], v[100:101], v[132:133], v[52:53] op_sel:[0,1,0] op_sel_hi:[1,1,1]
v_pk_fma_f32 v[54:55], v[102:103], v[132:133], v[54:55] op_sel:[0,1,0] op_sel_hi:[1,1,1]
v_pk_fma_f32 v[56:57], v[104:105], v[132:133], v[56:57] op_sel:[0,1,0] op_sel_hi:[1,1,1]
v_pk_fma_f32 v[58:59], v[106:107], v[132:133], v[58:59] op_sel:[0,1,0] op_sel_hi:[1,1,1]
v_pk_fma_f32 v[60:61], v[108:109], v[132:133], v[60:61] op_sel:[0,1,0] op_sel_hi:[1,1,1]
v_pk_fma_f32 v[62:63], v[110:111], v[132:133], v[62:63] op_sel:[0,1,0] op_sel_hi:[1,1,1]
ds_read_b128 v[96:99], v132 offset:768
ds_read_b128 v[100:103], v132 offset:800
ds_read_b128 v[104:107], v132 offset:832
ds_read_b128 v[108:111], v132 offset:864
v_pk_mul_f32 v[112:113], v[48:49], v[134:135] op_sel:[0,1] op_sel_hi:[1,1]
v_pk_mul_f32 v[114:115], v[50:51], v[134:135] op_sel:[0,1] op_sel_hi:[1,1]
v_pk_mul_f32 v[116:117], v[52:53], v[134:135] op_sel:[0,1] op_sel_hi:[1,1]
v_pk_mul_f32 v[118:119], v[54:55], v[134:135] op_sel:[0,1] op_sel_hi:[1,1]
v_exp_f32 v112, v112
v_exp_f32 v113, v113
v_exp_f32 v114, v114
v_exp_f32 v115, v115
v_exp_f32 v116, v116
v_exp_f32 v117, v117
v_exp_f32 v118, v118
v_exp_f32 v119, v119
v_pk_mul_f32 v[48:49], v[48:49], v[56:57]
v_pk_mul_f32 v[50:51], v[50:51], v[58:59]
v_pk_mul_f32 v[52:53], v[52:53], v[60:61]
v_pk_mul_f32 v[54:55], v[54:55], v[62:63]
v_pk_add_f32 v[112:113], v[112:113], 1.0 op_sel_hi:[1,0]
v_pk_add_f32 v[114:115], v[114:115], 1.0 op_sel_hi:[1,0]
v_pk_add_f32 v[116:117], v[116:117], 1.0 op_sel_hi:[1,0]
v_pk_add_f32 v[118:119], v[118:119], 1.0 op_sel_hi:[1,0]
v_rcp_f32 v112, v112
v_rcp_f32 v113, v113
v_rcp_f32 v114, v114
v_rcp_f32 v115, v115
v_rcp_f32 v116, v116
v_rcp_f32 v117, v117
v_rcp_f32_e64 v118, v118
v_rcp_f32 v119, v119
v_pk_mul_f32 v[48:49], v[48:49], v[112:113]
v_pk_mul_f32 v[50:51], v[50:51], v[114:115]
v_pk_mul_f32 v[52:53], v[52:53], v[116:117]
v_pk_mul_f32 v[54:55], v[54:55], v[118:119]
v_cvt_pk_bf16_f32 v124, v48, v49
v_cvt_pk_bf16_f32 v125, v50, v51
v_cvt_pk_bf16_f32 v126, v52, v53
v_cvt_pk_bf16_f32 v127, v54, v55
buffer_store_dwordx4 v[124:127], v131, s[24:27], s96 offen offset:2560
s_waitcnt lgkmcnt(0)
v_pk_fma_f32 v[64:65], v[96:97], v[132:133], v[64:65] op_sel:[0,1,0] op_sel_hi:[1,1,1]
v_pk_fma_f32 v[66:67], v[98:99], v[132:133], v[66:67] op_sel:[0,1,0] op_sel_hi:[1,1,1]
v_pk_fma_f32 v[68:69], v[100:101], v[132:133], v[68:69] op_sel:[0,1,0] op_sel_hi:[1,1,1]
v_pk_fma_f32 v[70:71], v[102:103], v[132:133], v[70:71] op_sel:[0,1,0] op_sel_hi:[1,1,1]
v_pk_fma_f32 v[72:73], v[104:105], v[132:133], v[72:73] op_sel:[0,1,0] op_sel_hi:[1,1,1]
v_pk_fma_f32 v[74:75], v[106:107], v[132:133], v[74:75] op_sel:[0,1,0] op_sel_hi:[1,1,1]
v_pk_fma_f32 v[76:77], v[108:109], v[132:133], v[76:77] op_sel:[0,1,0] op_sel_hi:[1,1,1]
v_pk_fma_f32 v[78:79], v[110:111], v[132:133], v[78:79] op_sel:[0,1,0] op_sel_hi:[1,1,1]
v_pk_mul_f32 v[112:113], v[64:65], v[134:135] op_sel:[0,1] op_sel_hi:[1,1]
v_pk_mul_f32 v[114:115], v[66:67], v[134:135] op_sel:[0,1] op_sel_hi:[1,1]
v_pk_mul_f32 v[116:117], v[68:69], v[134:135] op_sel:[0,1] op_sel_hi:[1,1]
v_pk_mul_f32 v[118:119], v[70:71], v[134:135] op_sel:[0,1] op_sel_hi:[1,1]
v_exp_f32 v112, v112
v_exp_f32 v113, v113
v_exp_f32 v114, v114
v_exp_f32 v115, v115
v_exp_f32 v116, v116
v_exp_f32 v117, v117
v_exp_f32 v118, v118
v_exp_f32 v119, v119
v_pk_mul_f32 v[64:65], v[64:65], v[72:73]
v_pk_mul_f32 v[66:67], v[66:67], v[74:75]
v_pk_mul_f32 v[68:69], v[68:69], v[76:77]
v_pk_mul_f32 v[70:71], v[70:71], v[78:79]
v_pk_add_f32 v[112:113], v[112:113], 1.0 op_sel_hi:[1,0]
v_pk_add_f32 v[114:115], v[114:115], 1.0 op_sel_hi:[1,0]
v_pk_add_f32 v[116:117], v[116:117], 1.0 op_sel_hi:[1,0]
v_pk_add_f32 v[118:119], v[118:119], 1.0 op_sel_hi:[1,0]
v_rcp_f32 v112, v112
v_rcp_f32 v113, v113
v_rcp_f32 v114, v114
v_rcp_f32 v115, v115
v_rcp_f32 v116, v116
v_rcp_f32 v117, v117
v_rcp_f32 v118, v118
v_rcp_f32 v119, v119
v_pk_mul_f32 v[64:65], v[64:65], v[112:113]
v_pk_mul_f32 v[66:67], v[66:67], v[114:115]
v_pk_mul_f32 v[68:69], v[68:69], v[116:117]
v_pk_mul_f32 v[70:71], v[70:71], v[118:119]
v_cvt_pk_bf16_f32 v120, v64, v65
v_cvt_pk_bf16_f32 v121, v66, v67
v_cvt_pk_bf16_f32 v122, v68, v69
v_cvt_pk_bf16_f32 v123, v70, v71
buffer_store_dwordx4 v[120:123], v131, s[24:27], s96 offen offset:3072
s_lshl_b32 s22, s44, 11
s_add_u32 s22, s22, 131072
s_lshl_b32 s23, s45, 7
s_add_u32 s23, s23, s22
v_lshrrev_b32 v17, 2, v1
v_min_u32 v17, 15, v17
v_and_b32 v18, 3, v1
v_lshlrev_b32_e64 v18, 2, v18
v_lshl_add_u32 v17, v17, 7, v18
s_lshl2_add_u32 s94, s46, s23
s_add_u32 s94, s94, s63
v_mov_b32 v18, s49
v_cmp_eq_u32 vcc, 3, v7
v_bfrev_b32 v28, 1
s_nop 0
v_cndmask_b32 v28, v25, v28, vcc
s_lshl2_add_u32 s54, s48, s46
s_lshl_b32 s54, s54, 7
s_add_u32 s54, s54, s60
s_add_u32 s54, s54, 12697600
buffer_load_dwordx2 v[120:121], v25, s[24:27], s54 offen sc1
buffer_load_dwordx2 v[122:123], v28, s[24:27], s54 offen offset:1024 sc1
s_mul_i32 s59, s46, 14336
s_add_u32 s59, s59, s61
s_add_u32 s59, s59, 20971520
s_add_u32 s36, s46, 1
s_and_b32 s36, s36, 3
s_mul_i32 s58, s36, 12288
s_add_u32 s58, s58, 110592
v_add_u32 v112, s58, v2
s_lshl2_add_u32 s36, s48, s36
s_mul_i32 s36, s36, 57344
s_add_u32 s36, s36, s59
s_add_u32 s37, s46, 2
s_and_b32 s37, s37, 3
s_mul_i32 s58, s37, 12288
s_add_u32 s58, s58, 114688
v_add_u32_e64 v113, s58, v2
s_lshl2_add_u32 s37, s48, s37
s_mul_i32 s37, s37, 57344
s_add_u32 s37, s37, s59
s_add_u32 s38, s46, 3
s_and_b32 s38, s38, 3
s_mul_i32 s58, s38, 12288
s_add_u32 s58, s58, 118784
v_add_u32 v114, s58, v2
s_lshl2_add_u32 s38, s48, s38
s_mul_i32 s38, s38, 57344
s_add_u32 s38, s38, s59
s_add_u32 s39, s46, 4
s_and_b32 s39, s39, 3
s_lshl2_add_u32 s39, s48, s39
s_mul_i32 s39, s39, 57344
s_add_u32 s39, s39, s59
s_lshl2_add_u32 s40, s48, s46
s_mul_i32 s40, s40, 14336
s_lshl_b32 s59, s47, 11
s_add_u32 s40, s40, s59
s_add_u32 s40, s40, s60
s_add_u32 s40, s40, 8388608
s_lshl2_add_u32 s41, s48, s46
s_lshl_b32 s41, s41, 7
s_lshl_b32 s59, s47, 10
s_add_u32 s41, s41, s59
s_add_u32 s41, s41, s60
s_add_u32 s41, s41, 8503296
s_mov_b32 s3, 0
s_cmp_lg_u32 s52, 0
s_waitcnt vmcnt(2)
s_mov_b64 exec, 1
buffer_store_dword v18, off, s[24:27], s94
s_mov_b64 exec, -1
s_barrier
s_cbranch_scc1 L26
buffer_load_dword v16, v17, s[24:27], s22 offen sc1
s_nop 7
buffer_load_dword v30, v17, s[24:27], s22 offen sc1
s_nop 7
buffer_load_dword v31, v17, s[24:27], s22 offen sc1
Lp28:
s_waitcnt vmcnt(2)
v_cmp_ne_u32 vcc, s49, v16
s_cbranch_vccz L25
buffer_load_dword v16, v17, s[24:27], s22 offen sc1
s_waitcnt vmcnt(2)
v_cmp_ne_u32 vcc, s49, v30
s_cbranch_vccz L25
buffer_load_dword v30, v17, s[24:27], s22 offen sc1
s_waitcnt vmcnt(2)
v_cmp_ne_u32 vcc, s49, v31
s_cbranch_vccz L25
buffer_load_dword v31, v17, s[24:27], s22 offen sc1
s_sub_u32 s62, s62, 1
s_cbranch_scc0 Lp28
s_mov_b32 s62, 0
Ld29:
s_branch L25
L26:
s_cmp_lg_u32 s52, 1
s_cbranch_scc1 L27
buffer_wbl2 sc1
s_waitcnt vmcnt(0)
v_lshlrev_b32_e64 v30, 2, v1
s_mov_b64 exec, 15
buffer_store_dword v18, v30, s[24:27], s23 offen sc1
s_mov_b64 exec, -1
Lp30:
buffer_load_dword v16, v17, s[24:27], s22 offen sc1
s_waitcnt vmcnt(0)
v_cmp_ne_u32 vcc, s49, v16
s_cbranch_vccz Ld31
s_sub_u32 s62, s62, 1
s_cbranch_scc0 Lp30
s_mov_b32 s62, 0
Ld31:
buffer_inv sc1
s_waitcnt vmcnt(0)
s_branch L25
L27:
L25:
s_barrier
s_cmp_lg_u32 s53, 0
s_cbranch_scc1 Li32
buffer_load_dwordx4 v[128:131], v2, s[24:27], s36 offen offset:0 sc1
buffer_load_dwordx4 v[132:135], v2, s[24:27], s36 offen offset:1024 sc1
buffer_load_dwordx4 v[136:139], v2, s[24:27], s36 offen offset:2048 sc1
buffer_load_dwordx4 v[140:143], v2, s[24:27], s36 offen offset:3072 sc1
s_add_u32 s36, s36, 4096
buffer_load_dwordx4 v[144:147], v2, s[24:27], s36 offen offset:0 sc1
buffer_load_dwordx4 v[148:151], v2, s[24:27], s36 offen offset:1024 sc1
buffer_load_dwordx4 v[152:155], v2, s[24:27], s36 offen offset:2048 sc1
buffer_load_dwordx4 v[156:159], v2, s[24:27], s36 offen offset:3072 sc1
s_waitcnt vmcnt(7)
v_mfma_f32_16x16x32_bf16 v[32:35], a[0:3], v[128:131], 0
s_add_u32 s36, s36, 4096
buffer_load_dwordx4 v[160:163], v2, s[24:27], s36 offen offset:0 sc1
buffer_load_dwordx4 a[196:199], v2, s[24:27], s12 offen offset:1024 sc1
v_mfma_f32_16x16x32_bf16 v[36:39], a[4:7], v[128:131], 0
v_mfma_f32_16x16x32_bf16 v[40:43], a[8:11], v[128:131], 0
buffer_load_dwordx4 v[164:167], v2, s[24:27], s36 offen offset:1024 sc1
v_mfma_f32_16x16x32_bf16 v[44:47], a[12:15], v[128:131], 0
s_waitcnt vmcnt(9)
v_mfma_f32_16x16x32_bf16 v[32:35], a[16:19], v[132:135], v[32:35]
buffer_load_dwordx4 v[168:171], v2, s[24:27], s36 offen offset:2048 sc1
v_mfma_f32_16x16x32_bf16 v[36:39], a[20:23], v[132:135], v[36:39]
v_add_f32_e64 v120, v120, v122
v_mfma_f32_16x16x32_bf16 v[40:43], a[24:27], v[132:135], v[40:43]
buffer_load_dwordx4 v[172:175], v2, s[24:27], s36 offen offset:3072 sc1
v_add_f32_e64 v121, v121, v123
v_mfma_f32_16x16x32_bf16 v[44:47], a[28:31], v[132:135], v[44:47]
buffer_load_dwordx4 a[200:203], v2, s[24:27], s12 offen offset:2048 sc1
v_mov_b32 v122, v120
s_waitcnt vmcnt(11)
v_mfma_f32_16x16x32_bf16 v[32:35], a[32:35], v[136:139], v[32:35]
s_add_u32 s36, s36, 4096
buffer_load_dwordx4 v[176:179], v2, s[24:27], s36 offen offset:0 sc1
v_mfma_f32_16x16x32_bf16 v[36:39], a[36:39], v[136:139], v[36:39]
v_mov_b32_e64 v123, v121
v_mfma_f32_16x16x32_bf16 v[40:43], a[40:43], v[136:139], v[40:43]
buffer_load_dwordx4 v[180:183], v2, s[24:27], s36 offen offset:1024 sc1
v_mfma_f32_16x16x32_bf16 v[44:47], a[44:47], v[136:139], v[44:47]
v_permlane16_swap_b32 v120, v122
s_waitcnt vmcnt(12)
v_mfma_f32_16x16x32_bf16 v[32:35], a[48:51], v[140:143], v[32:35]
buffer_load_dwordx4 v[184:187], v2, s[24:27], s37 offen offset:0 sc1
v_mfma_f32_16x16x32_bf16 v[36:39], a[52:55], v[140:143], v[36:39]
v_permlane16_swap_b32_e64 v121, v123
v_mfma_f32_16x16x32_bf16 v[40:43], a[56:59], v[140:143], v[40:43]
buffer_load_dwordx4 v[188:191], v2, s[24:27], s37 offen offset:1024 sc1
buffer_load_dwordx4 a[204:207], v2, s[24:27], s12 offen offset:3072 sc1
v_mfma_f32_16x16x32_bf16 v[44:47], a[60:63], v[140:143], v[44:47]
v_add_f32_e64 v120, v120, v122
v_add_f32 v121, v121, v123
s_waitcnt vmcnt(14)
v_mfma_f32_16x16x32_bf16 v[32:35], a[64:67], v[144:147], v[32:35]
buffer_load_dwordx4 v[192:195], v2, s[24:27], s37 offen offset:2048 sc1
v_mfma_f32_16x16x32_bf16 v[36:39], a[68:71], v[144:147], v[36:39]
v_mov_b32 v122, v120
v_mov_b32 v123, v121
v_mfma_f32_16x16x32_bf16 v[40:43], a[72:75], v[144:147], v[40:43]
v_permlane32_swap_b32_e64 v120, v122
v_mfma_f32_16x16x32_bf16 v[44:47], a[76:79], v[144:147], v[44:47]
v_permlane32_swap_b32 v121, v123
s_waitcnt vmcnt(14)
v_mfma_f32_16x16x32_bf16 v[32:35], a[80:83], v[148:151], v[32:35]
buffer_load_dwordx4 v[196:199], v2, s[24:27], s37 offen offset:3072 sc1
v_mfma_f32_16x16x32_bf16 v[36:39], a[84:87], v[148:151], v[36:39]
s_add_u32 s12, s91, 53248
buffer_load_dwordx4 a[208:211], v2, s[24:27], s12 offen offset:0 sc1
v_mfma_f32_16x16x32_bf16 v[40:43], a[88:91], v[148:151], v[40:43]
v_add_f32 v120, v120, v122
v_add_f32 v121, v121, v123
v_mfma_f32_16x16x32_bf16 v[44:47], a[92:95], v[148:151], v[44:47]
v_mul_f32 v122, 0xbb124925, v120
v_mul_f32 v123, v122, v122
s_waitcnt vmcnt(15)
v_mfma_f32_16x16x32_bf16 v[32:35], a[96:99], v[152:155], v[32:35]
s_add_u32 s37, s37, 4096
buffer_load_dwordx4 v[200:203], v2, s[24:27], s37 offen offset:0 sc1
v_mfma_f32_16x16x32_bf16 v[36:39], a[100:103], v[152:155], v[36:39]
v_fma_f32 v123, v121, s100, -v123
v_max_f32_e64 v123, 0, v123
v_mfma_f32_16x16x32_bf16 v[40:43], a[104:107], v[152:155], v[40:43]
v_add_f32 v123, 0x3727c5ac, v123
v_mfma_f32_16x16x32_bf16 v[44:47], a[108:111], v[152:155], v[44:47]
v_rsq_f32 v124, v123
s_waitcnt vmcnt(15)
v_mfma_f32_16x16x32_bf16 v[32:35], a[112:115], v[156:159], v[32:35]
buffer_load_dwordx4 v[204:207], v2, s[24:27], s37 offen offset:1024 sc1
buffer_load_dwordx4 a[212:215], v2, s[24:27], s12 offen offset:1024 sc1
v_mfma_f32_16x16x32_bf16 v[36:39], a[116:119], v[156:159], v[36:39]
v_mul_f32 v124, v124, v124
v_lshlrev_b32 v96, 16, v8
v_mfma_f32_16x16x32_bf16 v[40:43], a[120:123], v[156:159], v[40:43]
v_and_b32 v97, 0xffff0000, v8
v_lshlrev_b32_e64 v98, 16, v9
v_mfma_f32_16x16x32_bf16 v[44:47], a[124:127], v[156:159], v[44:47]
v_and_b32 v99, 0xffff0000, v9
v_lshlrev_b32 v100, 16, v10
s_waitcnt vmcnt(16)
v_mfma_f32_16x16x32_bf16 v[32:35], a[128:131], v[160:163], v[32:35]
buffer_load_dwordx4 v[208:211], v2, s[24:27], s37 offen offset:2048 sc1
v_mfma_f32_16x16x32_bf16 v[36:39], a[132:135], v[160:163], v[36:39]
v_and_b32 v101, 0xffff0000, v10
v_lshlrev_b32_e64 v102, 16, v11
v_mfma_f32_16x16x32_bf16 v[40:43], a[136:139], v[160:163], v[40:43]
v_and_b32 v103, 0xffff0000, v11
v_lshlrev_b32 v104, 16, v12
v_mfma_f32_16x16x32_bf16 v[44:47], a[140:143], v[160:163], v[44:47]
buffer_load_dwordx4 a[216:219], v2, s[24:27], s12 offen offset:2048 sc1
v_and_b32 v105, 0xffff0000, v12
s_waitcnt vmcnt(16)
v_mfma_f32_16x16x32_bf16 v[32:35], a[144:147], v[164:167], v[32:35]
buffer_load_dwordx4 v[212:215], v2, s[24:27], s37 offen offset:3072 sc1
v_mfma_f32_16x16x32_bf16 v[36:39], a[148:151], v[164:167], v[36:39]
v_lshlrev_b32_e64 v106, 16, v13
v_and_b32 v107, 0xffff0000, v13
v_mfma_f32_16x16x32_bf16 v[40:43], a[152:155], v[164:167], v[40:43]
v_lshlrev_b32_e64 v108, 16, v14
v_and_b32 v109, 0xffff0000, v14
v_mfma_f32_16x16x32_bf16 v[44:47], a[156:159], v[164:167], v[44:47]
v_lshlrev_b32 v110, 16, v15
v_and_b32 v111, 0xffff0000, v15
s_waitcnt vmcnt(16)
v_mfma_f32_16x16x32_bf16 v[32:35], a[160:163], v[168:171], v[32:35]
s_add_u32 s37, s37, 4096
buffer_load_dwordx4 v[216:219], v2, s[24:27], s37 offen offset:0 sc1
v_mfma_f32_16x16x32_bf16 v[36:39], a[164:167], v[168:171], v[36:39]
s_mul_i32 s58, s46, 12288
s_add_u32 s58, s58, 110592
v_mfma_f32_16x16x32_bf16 v[40:43], a[168:171], v[168:171], v[40:43]
buffer_load_dwordx4 a[220:223], v2, s[24:27], s12 offen offset:3072 sc1
v_add_u32 v116, s58, v2
v_mfma_f32_16x16x32_bf16 v[44:47], a[172:175], v[168:171], v[44:47]
s_waitcnt vmcnt(17)
v_mfma_f32_16x16x32_bf16 v[32:35], a[176:179], v[172:175], v[32:35]
buffer_load_dwordx4 v[220:223], v2, s[24:27], s37 offen offset:1024 sc1
v_mfma_f32_16x16x32_bf16 v[36:39], a[180:183], v[172:175], v[36:39]
v_mfma_f32_16x16x32_bf16 v[40:43], a[184:187], v[172:175], v[40:43]
v_mfma_f32_16x16x32_bf16 v[44:47], a[188:191], v[172:175], v[44:47]
s_waitcnt vmcnt(12)
v_mfma_f32_16x16x32_bf16 v[32:35], a[192:195], v[176:179], v[32:35]
buffer_load_dwordx4 v[224:227], v2, s[24:27], s37 offen offset:2048 sc1
v_mfma_f32_16x16x32_bf16 v[36:39], a[196:199], v[176:179], v[36:39]
s_add_u32 m0, s4, 0
s_add_u32 s11, s7, 0
buffer_load_dwordx4 v2, s[24:27], s11 offen offset:0 sc1 lds
v_mfma_f32_16x16x32_bf16 v[40:43], a[200:203], v[176:179], v[40:43]
v_mfma_f32_16x16x32_bf16 v[44:47], a[204:207], v[176:179], v[44:47]
s_waitcnt vmcnt(3)
v_mfma_f32_16x16x32_bf16 v[32:35], a[208:211], v[180:183], v[32:35]
buffer_load_dwordx4 v[228:231], v2, s[24:27], s37 offen offset:3072 sc1
v_mfma_f32_16x16x32_bf16 v[36:39], a[212:215], v[180:183], v[36:39]
v_mfma_f32_16x16x32_bf16 v[40:43], a[216:219], v[180:183], v[40:43]
v_mfma_f32_16x16x32_bf16 v[44:47], a[220:223], v[180:183], v[44:47]
v_mfma_f32_16x16x32_bf16 v[48:51], a[0:3], v[184:187], 0
s_add_u32 s37, s37, 4096
buffer_load_dwordx4 v[232:235], v2, s[24:27], s37 offen offset:0 sc1
buffer_load_dwordx4 v2, s[24:27], s11 offen offset:1024 sc1 lds
v_mfma_f32_16x16x32_bf16 v[52:55], a[4:7], v[184:187], 0
v_mfma_f32_16x16x32_bf16 v[56:59], a[8:11], v[184:187], 0
v_mfma_f32_16x16x32_bf16 v[60:63], a[12:15], v[184:187], 0
v_mfma_f32_16x16x32_bf16 v[48:51], a[16:19], v[188:191], v[48:51]
buffer_load_dwordx4 v[236:239], v2, s[24:27], s37 offen offset:1024 sc1
v_mfma_f32_16x16x32_bf16 v[52:55], a[20:23], v[188:191], v[52:55]
ds_write_b128 v112, v[32:35] offset:0
ds_write_b128 v112, v[36:39] offset:1024
v_mfma_f32_16x16x32_bf16 v[56:59], a[24:27], v[188:191], v[56:59]
ds_write_b128 v112, v[40:43] offset:2048
ds_write_b128 v112, v[44:47] offset:3072
v_mfma_f32_16x16x32_bf16 v[60:63], a[28:31], v[188:191], v[60:63]
buffer_load_dwordx4 v2, s[24:27], s11 offen offset:2048 sc1 lds
v_mfma_f32_16x16x32_bf16 v[48:51], a[32:35], v[192:195], v[48:51]
buffer_load_dwordx4 v[240:243], v2, s[24:27], s38 offen offset:0 sc1
v_mfma_f32_16x16x32_bf16 v[52:55], a[36:39], v[192:195], v[52:55]
v_mfma_f32_16x16x32_bf16 v[56:59], a[40:43], v[192:195], v[56:59]
v_mfma_f32_16x16x32_bf16 v[60:63], a[44:47], v[192:195], v[60:63]
v_mfma_f32_16x16x32_bf16 v[48:51], a[48:51], v[196:199], v[48:51]
buffer_load_dwordx4 v[244:247], v2, s[24:27], s38 offen offset:1024 sc1
v_mfma_f32_16x16x32_bf16 v[52:55], a[52:55], v[196:199], v[52:55]
v_mfma_f32_16x16x32_bf16 v[56:59], a[56:59], v[196:199], v[56:59]
buffer_load_dwordx4 v2, s[24:27], s11 offen offset:3072 sc1 lds
v_mfma_f32_16x16x32_bf16 v[60:63], a[60:63], v[196:199], v[60:63]
v_mfma_f32_16x16x32_bf16 v[48:51], a[64:67], v[200:203], v[48:51]
buffer_load_dwordx4 v[248:251], v2, s[24:27], s38 offen offset:2048 sc1
v_mfma_f32_16x16x32_bf16 v[52:55], a[68:71], v[200:203], v[52:55]
v_mfma_f32_16x16x32_bf16 v[56:59], a[72:75], v[200:203], v[56:59]
v_mfma_f32_16x16x32_bf16 v[60:63], a[76:79], v[200:203], v[60:63]
v_mfma_f32_16x16x32_bf16 v[48:51], a[80:83], v[204:207], v[48:51]
buffer_load_dwordx4 v[252:255], v2, s[24:27], s38 offen offset:3072 sc1
v_mfma_f32_16x16x32_bf16 v[52:55], a[84:87], v[204:207], v[52:55]
s_add_u32 m0, s4, 4096
s_add_u32 s11, s7, 4096
buffer_load_dwordx4 v2, s[24:27], s11 offen offset:0 sc1 lds
v_mfma_f32_16x16x32_bf16 v[56:59], a[88:91], v[204:207], v[56:59]
v_mfma_f32_16x16x32_bf16 v[60:63], a[92:95], v[204:207], v[60:63]
v_mfma_f32_16x16x32_bf16 v[48:51], a[96:99], v[208:211], v[48:51]
s_add_u32 s38, s38, 4096
buffer_load_dwordx4 v[128:131], v2, s[24:27], s38 offen offset:0 sc1
v_mfma_f32_16x16x32_bf16 v[52:55], a[100:103], v[208:211], v[52:55]
v_mfma_f32_16x16x32_bf16 v[56:59], a[104:107], v[208:211], v[56:59]
v_mfma_f32_16x16x32_bf16 v[60:63], a[108:111], v[208:211], v[60:63]
v_mfma_f32_16x16x32_bf16 v[48:51], a[112:115], v[212:215], v[48:51]
buffer_load_dwordx4 v[132:135], v2, s[24:27], s38 offen offset:1024 sc1
buffer_load_dwordx4 v2, s[24:27], s11 offen offset:1024 sc1 lds
v_mfma_f32_16x16x32_bf16 v[52:55], a[116:119], v[212:215], v[52:55]
v_mfma_f32_16x16x32_bf16 v[56:59], a[120:123], v[212:215], v[56:59]
v_mfma_f32_16x16x32_bf16 v[60:63], a[124:127], v[212:215], v[60:63]
v_mfma_f32_16x16x32_bf16 v[48:51], a[128:131], v[216:219], v[48:51]
buffer_load_dwordx4 v[136:139], v2, s[24:27], s38 offen offset:2048 sc1
v_mfma_f32_16x16x32_bf16 v[52:55], a[132:135], v[216:219], v[52:55]
v_mfma_f32_16x16x32_bf16 v[56:59], a[136:139], v[216:219], v[56:59]
v_mfma_f32_16x16x32_bf16 v[60:63], a[140:143], v[216:219], v[60:63]
buffer_load_dwordx4 v2, s[24:27], s11 offen offset:2048 sc1 lds
s_waitcnt vmcnt(18)
v_mfma_f32_16x16x32_bf16 v[48:51], a[144:147], v[220:223], v[48:51]
buffer_load_dwordx4 v[140:143], v2, s[24:27], s38 offen offset:3072 sc1
v_mfma_f32_16x16x32_bf16 v[52:55], a[148:151], v[220:223], v[52:55]
v_mfma_f32_16x16x32_bf16 v[56:59], a[152:155], v[220:223], v[56:59]
v_mfma_f32_16x16x32_bf16 v[60:63], a[156:159], v[220:223], v[60:63]
s_waitcnt vmcnt(18)
v_mfma_f32_16x16x32_bf16 v[48:51], a[160:163], v[224:227], v[48:51]
s_add_u32 s38, s38, 4096
buffer_load_dwordx4 v[144:147], v2, s[24:27], s38 offen offset:0 sc1
v_mfma_f32_16x16x32_bf16 v[52:55], a[164:167], v[224:227], v[52:55]
v_mfma_f32_16x16x32_bf16 v[56:59], a[168:171], v[224:227], v[56:59]
s_add_u32 m0, s5, 86016
s_add_u32 s11, s89, 0
buffer_load_dwordx4 v19, s[16:19], s11 offen  lds
v_mfma_f32_16x16x32_bf16 v[60:63], a[172:175], v[224:227], v[60:63]
s_waitcnt vmcnt(18)
v_mfma_f32_16x16x32_bf16 v[48:51], a[176:179], v[228:231], v[48:51]
buffer_load_dwordx4 v[148:151], v2, s[24:27], s38 offen offset:1024 sc1
v_mfma_f32_16x16x32_bf16 v[52:55], a[180:183], v[228:231], v[52:55]
v_mfma_f32_16x16x32_bf16 v[56:59], a[184:187], v[228:231], v[56:59]
v_mfma_f32_16x16x32_bf16 v[60:63], a[188:191], v[228:231], v[60:63]
s_waitcnt vmcnt(18)
v_mfma_f32_16x16x32_bf16 v[48:51], a[192:195], v[232:235], v[48:51]
buffer_load_dwordx4 v[152:155], v2, s[24:27], s38 offen offset:2048 sc1
v_mfma_f32_16x16x32_bf16 v[52:55], a[196:199], v[232:235], v[52:55]
s_add_u32 m0, s5, 87040
s_add_u32 s11, s89, 7168
buffer_load_dwordx4 v19, s[16:19], s11 offen  lds
v_mfma_f32_16x16x32_bf16 v[56:59], a[200:203], v[232:235], v[56:59]
v_mfma_f32_16x16x32_bf16 v[60:63], a[204:207], v[232:235], v[60:63]
s_waitcnt vmcnt(18)
v_mfma_f32_16x16x32_bf16 v[48:51], a[208:211], v[236:239], v[48:51]
buffer_load_dwordx4 v[156:159], v2, s[24:27], s38 offen offset:3072 sc1
v_mfma_f32_16x16x32_bf16 v[52:55], a[212:215], v[236:239], v[52:55]
v_mfma_f32_16x16x32_bf16 v[56:59], a[216:219], v[236:239], v[56:59]
v_mfma_f32_16x16x32_bf16 v[60:63], a[220:223], v[236:239], v[60:63]
s_waitcnt vmcnt(17)
v_mfma_f32_16x16x32_bf16 v[32:35], a[0:3], v[240:243], 0
s_add_u32 s38, s38, 4096
buffer_load_dwordx4 v[160:163], v2, s[24:27], s38 offen offset:0 sc1
s_add_u32 m0, s5, 88064
s_add_u32 s11, s89, 14336
buffer_load_dwordx4 v19, s[16:19], s11 offen  lds
v_mfma_f32_16x16x32_bf16 v[36:39], a[4:7], v[240:243], 0
v_mfma_f32_16x16x32_bf16 v[40:43], a[8:11], v[240:243], 0
v_mfma_f32_16x16x32_bf16 v[44:47], a[12:15], v[240:243], 0
s_waitcnt vmcnt(18)
v_mfma_f32_16x16x32_bf16 v[32:35], a[16:19], v[244:247], v[32:35]
buffer_load_dwordx4 v[164:167], v2, s[24:27], s38 offen offset:1024 sc1
v_mfma_f32_16x16x32_bf16 v[36:39], a[20:23], v[244:247], v[36:39]
ds_write_b128 v113, v[48:51] offset:0
ds_write_b128 v113, v[52:55] offset:1024
v_mfma_f32_16x16x32_bf16 v[40:43], a[24:27], v[244:247], v[40:43]
ds_write_b128 v113, v[56:59] offset:2048
ds_write_b128 v113, v[60:63] offset:3072
v_mfma_f32_16x16x32_bf16 v[44:47], a[28:31], v[244:247], v[44:47]
s_add_u32 m0, s5, 89088
s_add_u32 s11, s89, 21504
buffer_load_dwordx4 v19, s[16:19], s11 offen  lds
s_waitcnt vmcnt(18)
v_mfma_f32_16x16x32_bf16 v[32:35], a[32:35], v[248:251], v[32:35]
buffer_load_dwordx4 v[168:171], v2, s[24:27], s39 offen offset:0 sc1
v_mfma_f32_16x16x32_bf16 v[36:39], a[36:39], v[248:251], v[36:39]
v_mfma_f32_16x16x32_bf16 v[40:43], a[40:43], v[248:251], v[40:43]
v_mfma_f32_16x16x32_bf16 v[44:47], a[44:47], v[248:251], v[44:47]
s_waitcnt vmcnt(18)
v_mfma_f32_16x16x32_bf16 v[32:35], a[48:51], v[252:255], v[32:35]
buffer_load_dwordx4 v[172:175], v2, s[24:27], s39 offen offset:1024 sc1
v_mfma_f32_16x16x32_bf16 v[36:39], a[52:55], v[252:255], v[36:39]
v_mfma_f32_16x16x32_bf16 v[40:43], a[56:59], v[252:255], v[40:43]
s_add_u32 m0, s4, 28672
s_add_u32 s11, s7, 28672
buffer_load_dwordx4 v2, s[24:27], s11 offen offset:0 sc1 lds
v_mfma_f32_16x16x32_bf16 v[44:47], a[60:63], v[252:255], v[44:47]
s_waitcnt vmcnt(18)
v_mfma_f32_16x16x32_bf16 v[32:35], a[64:67], v[128:131], v[32:35]
buffer_load_dwordx4 v[176:179], v2, s[24:27], s39 offen offset:2048 sc1
v_mfma_f32_16x16x32_bf16 v[36:39], a[68:71], v[128:131], v[36:39]
v_mfma_f32_16x16x32_bf16 v[40:43], a[72:75], v[128:131], v[40:43]
v_mfma_f32_16x16x32_bf16 v[44:47], a[76:79], v[128:131], v[44:47]
s_waitcnt vmcnt(18)
v_mfma_f32_16x16x32_bf16 v[32:35], a[80:83], v[132:135], v[32:35]
buffer_load_dwordx4 v[180:183], v2, s[24:27], s39 offen offset:3072 sc1
v_mfma_f32_16x16x32_bf16 v[36:39], a[84:87], v[132:135], v[36:39]
buffer_load_dwordx4 v2, s[24:27], s11 offen offset:1024 sc1 lds
v_mfma_f32_16x16x32_bf16 v[40:43], a[88:91], v[132:135], v[40:43]
v_mfma_f32_16x16x32_bf16 v[44:47], a[92:95], v[132:135], v[44:47]
s_waitcnt vmcnt(18)
v_mfma_f32_16x16x32_bf16 v[32:35], a[96:99], v[136:139], v[32:35]
s_add_u32 s39, s39, 4096
buffer_load_dwordx4 v[184:187], v2, s[24:27], s39 offen offset:0 sc1
v_mfma_f32_16x16x32_bf16 v[36:39], a[100:103], v[136:139], v[36:39]
v_mfma_f32_16x16x32_bf16 v[40:43], a[104:107], v[136:139], v[40:43]
v_mfma_f32_16x16x32_bf16 v[44:47], a[108:111], v[136:139], v[44:47]
s_waitcnt vmcnt(17)
v_mfma_f32_16x16x32_bf16 v[32:35], a[112:115], v[140:143], v[32:35]
buffer_load_dwordx4 v[188:191], v2, s[24:27], s39 offen offset:1024 sc1
buffer_load_dwordx4 v2, s[24:27], s11 offen offset:2048 sc1 lds
v_mfma_f32_16x16x32_bf16 v[36:39], a[116:119], v[140:143], v[36:39]
v_mfma_f32_16x16x32_bf16 v[40:43], a[120:123], v[140:143], v[40:43]
v_mfma_f32_16x16x32_bf16 v[44:47], a[124:127], v[140:143], v[44:47]
s_waitcnt vmcnt(18)
v_mfma_f32_16x16x32_bf16 v[32:35], a[128:131], v[144:147], v[32:35]
buffer_load_dwordx4 v[192:195], v2, s[24:27], s39 offen offset:2048 sc1
v_mfma_f32_16x16x32_bf16 v[36:39], a[132:135], v[144:147], v[36:39]
v_mfma_f32_16x16x32_bf16 v[40:43], a[136:139], v[144:147], v[40:43]
v_mfma_f32_16x16x32_bf16 v[44:47], a[140:143], v[144:147], v[44:47]
buffer_load_dwordx4 v2, s[24:27], s11 offen offset:3072 sc1 lds
s_waitcnt vmcnt(18)
v_mfma_f32_16x16x32_bf16 v[32:35], a[144:147], v[148:151], v[32:35]
buffer_load_dwordx4 v[196:199], v2, s[24:27], s39 offen offset:3072 sc1
v_mfma_f32_16x16x32_bf16 v[36:39], a[148:151], v[148:151], v[36:39]
v_mfma_f32_16x16x32_bf16 v[40:43], a[152:155], v[148:151], v[40:43]
v_mfma_f32_16x16x32_bf16 v[44:47], a[156:159], v[148:151], v[44:47]
s_waitcnt vmcnt(18)
v_mfma_f32_16x16x32_bf16 v[32:35], a[160:163], v[152:155], v[32:35]
s_add_u32 s39, s39, 4096
buffer_load_dwordx4 v[200:203], v2, s[24:27], s39 offen offset:0 sc1
v_mfma_f32_16x16x32_bf16 v[36:39], a[164:167], v[152:155], v[36:39]
v_mfma_f32_16x16x32_bf16 v[40:43], a[168:171], v[152:155], v[40:43]
s_add_u32 m0, s4, 32768
s_add_u32 s11, s7, 32768
buffer_load_dwordx4 v2, s[24:27], s11 offen offset:0 sc1 lds
v_mfma_f32_16x16x32_bf16 v[44:47], a[172:175], v[152:155], v[44:47]
s_waitcnt vmcnt(18)
v_mfma_f32_16x16x32_bf16 v[32:35], a[176:179], v[156:159], v[32:35]
buffer_load_dwordx4 v[204:207], v2, s[24:27], s39 offen offset:1024 sc1
v_mfma_f32_16x16x32_bf16 v[36:39], a[180:183], v[156:159], v[36:39]
v_mfma_f32_16x16x32_bf16 v[40:43], a[184:187], v[156:159], v[40:43]
v_mfma_f32_16x16x32_bf16 v[44:47], a[188:191], v[156:159], v[44:47]
s_waitcnt vmcnt(18)
v_mfma_f32_16x16x32_bf16 v[32:35], a[192:195], v[160:163], v[32:35]
buffer_load_dwordx4 v[208:211], v2, s[24:27], s39 offen offset:2048 sc1
v_mfma_f32_16x16x32_bf16 v[36:39], a[196:199], v[160:163], v[36:39]
buffer_load_dwordx4 v2, s[24:27], s11 offen offset:1024 sc1 lds
v_mfma_f32_16x16x32_bf16 v[40:43], a[200:203], v[160:163], v[40:43]
v_mfma_f32_16x16x32_bf16 v[44:47], a[204:207], v[160:163], v[44:47]
s_waitcnt vmcnt(18)
v_mfma_f32_16x16x32_bf16 v[32:35], a[208:211], v[164:167], v[32:35]
buffer_load_dwordx4 v[212:215], v2, s[24:27], s39 offen offset:3072 sc1
v_mfma_f32_16x16x32_bf16 v[36:39], a[212:215], v[164:167], v[36:39]
v_mfma_f32_16x16x32_bf16 v[40:43], a[216:219], v[164:167], v[40:43]
v_mfma_f32_16x16x32_bf16 v[44:47], a[220:223], v[164:167], v[44:47]
s_waitcnt vmcnt(17)
v_mfma_f32_16x16x32_bf16 v[48:51], a[0:3], v[168:171], 0
s_add_u32 s39, s39, 4096
buffer_load_dwordx4 v[216:219], v2, s[24:27], s39 offen offset:0 sc1
buffer_load_dwordx4 v2, s[24:27], s11 offen offset:2048 sc1 lds
v_mfma_f32_16x16x32_bf16 v[52:55], a[4:7], v[168:171], 0
v_mfma_f32_16x16x32_bf16 v[56:59], a[8:11], v[168:171], 0
v_mfma_f32_16x16x32_bf16 v[60:63], a[12:15], v[168:171], 0
s_waitcnt vmcnt(18)
v_mfma_f32_16x16x32_bf16 v[48:51], a[16:19], v[172:175], v[48:51]
buffer_load_dwordx4 v[220:223], v2, s[24:27], s39 offen offset:1024 sc1
v_mfma_f32_16x16x32_bf16 v[52:55], a[20:23], v[172:175], v[52:55]
s_add_u32 m0, s4, 57344
s_add_u32 s11, s7, 57344
buffer_load_dwordx4 v2, s[24:27], s11 offen offset:0 sc1 lds
v_mfma_f32_16x16x32_bf16 v[56:59], a[24:27], v[172:175], v[56:59]
ds_write_b128 v114, v[32:35] offset:0
ds_write_b128 v114, v[36:39] offset:1024
v_mfma_f32_16x16x32_bf16 v[60:63], a[28:31], v[172:175], v[60:63]
ds_write_b128 v114, v[40:43] offset:2048
ds_write_b128 v114, v[44:47] offset:3072
s_waitcnt vmcnt(18)
v_mfma_f32_16x16x32_bf16 v[48:51], a[32:35], v[176:179], v[48:51]
v_mfma_f32_16x16x32_bf16 v[52:55], a[36:39], v[176:179], v[52:55]
v_mfma_f32_16x16x32_bf16 v[56:59], a[40:43], v[176:179], v[56:59]
buffer_load_dwordx4 v2, s[24:27], s11 offen offset:1024 sc1 lds
v_mfma_f32_16x16x32_bf16 v[60:63], a[44:47], v[176:179], v[60:63]
s_waitcnt vmcnt(18)
v_mfma_f32_16x16x32_bf16 v[48:51], a[48:51], v[180:183], v[48:51]
v_mfma_f32_16x16x32_bf16 v[52:55], a[52:55], v[180:183], v[52:55]
v_mfma_f32_16x16x32_bf16 v[56:59], a[56:59], v[180:183], v[56:59]
v_mfma_f32_16x16x32_bf16 v[60:63], a[60:63], v[180:183], v[60:63]
buffer_load_dwordx4 v2, s[24:27], s11 offen offset:2048 sc1 lds
s_waitcnt vmcnt(17)
v_mfma_f32_16x16x32_bf16 v[48:51], a[64:67], v[184:187], v[48:51]
v_mfma_f32_16x16x32_bf16 v[52:55], a[68:71], v[184:187], v[52:55]
v_mfma_f32_16x16x32_bf16 v[56:59], a[72:75], v[184:187], v[56:59]
v_mfma_f32_16x16x32_bf16 v[60:63], a[76:79], v[184:187], v[60:63]
s_waitcnt lgkmcnt(0)
s_barrier
s_waitcnt vmcnt(16)
v_mfma_f32_16x16x32_bf16 v[48:51], a[80:83], v[188:191], v[48:51]
buffer_load_dwordx4 v2, s[24:27], s11 offen offset:3072 sc1 lds
v_mfma_f32_16x16x32_bf16 v[52:55], a[84:87], v[188:191], v[52:55]
ds_read_b128 v[64:67], v116 offset:0
ds_read_b128 v[68:71], v116 offset:1024
v_mfma_f32_16x16x32_bf16 v[56:59], a[88:91], v[188:191], v[56:59]
ds_read_b128 v[72:75], v116 offset:2048
ds_read_b128 v[76:79], v116 offset:3072
v_mfma_f32_16x16x32_bf16 v[60:63], a[92:95], v[188:191], v[60:63]
ds_read_b128 v[80:83], v116 offset:4096
ds_read_b128 v[84:87], v116 offset:5120
s_waitcnt vmcnt(15)
v_mfma_f32_16x16x32_bf16 v[48:51], a[96:99], v[192:195], v[48:51]
ds_read_b128 v[88:91], v116 offset:6144
v_mfma_f32_16x16x32_bf16 v[52:55], a[100:103], v[192:195], v[52:55]
s_add_u32 m0, s4, 61440
s_add_u32 s11, s7, 61440
buffer_load_dwordx4 v2, s[24:27], s11 offen offset:0 sc1 lds
v_mfma_f32_16x16x32_bf16 v[56:59], a[104:107], v[192:195], v[56:59]
ds_read_b128 v[92:95], v116 offset:7168
s_waitcnt lgkmcnt(0)
v_mfma_f32_16x16x32_bf16 v[60:63], a[108:111], v[192:195], v[60:63]
v_add_f32_e64 v64, v64, v80
v_add_f32 v65, v65, v81
s_waitcnt vmcnt(14)
v_mfma_f32_16x16x32_bf16 v[48:51], a[112:115], v[196:199], v[48:51]
v_add_f32_e64 v66, v66, v82
v_mfma_f32_16x16x32_bf16 v[52:55], a[116:119], v[196:199], v[52:55]
v_add_f32 v67, v67, v83
v_add_f32 v68, v68, v84
v_mfma_f32_16x16x32_bf16 v[56:59], a[120:123], v[196:199], v[56:59]
buffer_load_dwordx4 v2, s[24:27], s11 offen offset:1024 sc1 lds
v_add_f32_e64 v69, v69, v85
v_mfma_f32_16x16x32_bf16 v[60:63], a[124:127], v[196:199], v[60:63]
v_add_f32_e64 v70, v70, v86
v_add_f32 v71, v71, v87
s_waitcnt vmcnt(14)
v_mfma_f32_16x16x32_bf16 v[48:51], a[128:131], v[200:203], v[48:51]
v_add_f32_e64 v72, v72, v88
v_mfma_f32_16x16x32_bf16 v[52:55], a[132:135], v[200:203], v[52:55]
v_add_f32 v73, v73, v89
v_add_f32 v74, v74, v90
v_mfma_f32_16x16x32_bf16 v[56:59], a[136:139], v[200:203], v[56:59]
v_add_f32 v75, v75, v91
v_add_f32 v76, v76, v92
v_mfma_f32_16x16x32_bf16 v[60:63], a[140:143], v[200:203], v[60:63]
buffer_load_dwordx4 v2, s[24:27], s11 offen offset:2048 sc1 lds
v_add_f32 v77, v77, v93
s_waitcnt vmcnt(13)
v_mfma_f32_16x16x32_bf16 v[48:51], a[144:147], v[204:207], v[48:51]
v_add_f32_e64 v78, v78, v94
v_mfma_f32_16x16x32_bf16 v[52:55], a[148:151], v[204:207], v[52:55]
v_add_f32_e64 v79, v79, v95
ds_read_b128 v[80:83], v116 offset:8192
v_mfma_f32_16x16x32_bf16 v[56:59], a[152:155], v[204:207], v[56:59]
ds_read_b128 v[84:87], v116 offset:9216
ds_read_b128 v[88:91], v116 offset:10240
v_mfma_f32_16x16x32_bf16 v[60:63], a[156:159], v[204:207], v[60:63]
ds_read_b128 v[92:95], v116 offset:11264
v_fma_f32 v96, v64, v124, v96
s_waitcnt vmcnt(12)
v_mfma_f32_16x16x32_bf16 v[48:51], a[160:163], v[208:211], v[48:51]
s_getpc_b64 s[92:93]
Lc33:
s_sub_u32 s92, s92, Lc33-Lpc
s_subb_u32 s93, s93, 0
s_and_b32 s13, s44, 1
s_lshl_b32 s13, s13, 4
s_add_u32 s13, s13, s45
s_mul_i32 s13, s13, CODE_NL
v_min_u32 v30, CODE_NL-1, v1
v_add_u32 v30, s13, v30
v_lshlrev_b32 v30, 7, v30
v_min_u32 v30, Lcode_end-Lpc-4, v30
global_load_dword v16, v30, s[92:93]
v_mfma_f32_16x16x32_bf16 v[52:55], a[164:167], v[208:211], v[52:55]
v_fma_f32 v97, v65, v124, v97
v_fma_f32 v98, v66, v124, v98
v_mfma_f32_16x16x32_bf16 v[56:59], a[168:171], v[208:211], v[56:59]
v_fma_f32 v99, v67, v124, v99
v_fma_f32 v100, v68, v124, v100
v_mfma_f32_16x16x32_bf16 v[60:63], a[172:175], v[208:211], v[60:63]
v_fma_f32 v101, v69, v124, v101
v_fma_f32 v102, v70, v124, v102
s_waitcnt vmcnt(11)
v_mfma_f32_16x16x32_bf16 v[48:51], a[176:179], v[212:215], v[48:51]
v_fma_f32 v103, v71, v124, v103
v_mfma_f32_16x16x32_bf16 v[52:55], a[180:183], v[212:215], v[52:55]
v_fma_f32 v104, v72, v124, v104
v_fma_f32 v105, v73, v124, v105
v_mfma_f32_16x16x32_bf16 v[56:59], a[184:187], v[212:215], v[56:59]
v_fma_f32 v106, v74, v124, v106
v_fma_f32 v107, v75, v124, v107
v_mfma_f32_16x16x32_bf16 v[60:63], a[188:191], v[212:215], v[60:63]
v_fma_f32 v108, v76, v124, v108
v_fma_f32 v109, v77, v124, v109
s_waitcnt vmcnt(10)
v_mfma_f32_16x16x32_bf16 v[48:51], a[192:195], v[216:219], v[48:51]
v_fma_f32 v110, v78, v124, v110
v_mfma_f32_16x16x32_bf16 v[52:55], a[196:199], v[216:219], v[52:55]
v_fma_f32 v111, v79, v124, v111
s_waitcnt lgkmcnt(0)
v_mfma_f32_16x16x32_bf16 v[56:59], a[200:203], v[216:219], v[56:59]
v_fma_f32 v96, v80, v124, v96
v_fma_f32 v97, v81, v124, v97
v_mfma_f32_16x16x32_bf16 v[60:63], a[204:207], v[216:219], v[60:63]
v_fma_f32 v98, v82, v124, v98
v_fma_f32 v99, v83, v124, v99
s_waitcnt vmcnt(8)
v_mfma_f32_16x16x32_bf16 v[48:51], a[208:211], v[220:223], v[48:51]
v_fma_f32 v100, v84, v124, v100
v_mfma_f32_16x16x32_bf16 v[52:55], a[212:215], v[220:223], v[52:55]
v_fma_f32 v101, v85, v124, v101
v_fma_f32 v102, v86, v124, v102
v_mfma_f32_16x16x32_bf16 v[56:59], a[216:219], v[220:223], v[56:59]
v_fma_f32 v103, v87, v124, v103
v_fma_f32 v104, v88, v124, v104
v_mfma_f32_16x16x32_bf16 v[60:63], a[220:223], v[220:223], v[60:63]
v_fma_f32 v105, v89, v124, v105
v_fma_f32 v106, v90, v124, v106
v_fma_f32 v107, v91, v124, v107
v_fma_f32 v108, v92, v124, v108
v_fma_f32 v109, v93, v124, v109
v_fma_f32 v110, v94, v124, v110
v_fma_f32 v111, v95, v124, v111
v_pk_fma_f32 v[48:49], v[48:49], v[124:125], v[96:97] op_sel_hi:[1,0,1]
v_pk_fma_f32 v[50:51], v[50:51], v[124:125], v[98:99] op_sel_hi:[1,0,1]
v_pk_fma_f32 v[52:53], v[52:53], v[124:125], v[100:101] op_sel_hi:[1,0,1]
v_pk_fma_f32 v[54:55], v[54:55], v[124:125], v[102:103] op_sel_hi:[1,0,1]
v_pk_fma_f32 v[56:57], v[56:57], v[124:125], v[104:105] op_sel_hi:[1,0,1]
v_pk_fma_f32 v[58:59], v[58:59], v[124:125], v[106:107] op_sel_hi:[1,0,1]
v_pk_fma_f32 v[60:61], v[60:61], v[124:125], v[108:109] op_sel_hi:[1,0,1]
v_pk_fma_f32 v[62:63], v[62:63], v[124:125], v[110:111] op_sel_hi:[1,0,1]
v_cvt_pk_bf16_f32 v244, v48, v49
v_cvt_pk_bf16_f32 v245, v50, v51
v_cvt_pk_bf16_f32 v246, v52, v53
v_cvt_pk_bf16_f32 v247, v54, v55
v_cvt_pk_bf16_f32 v248, v56, v57
v_cvt_pk_bf16_f32 v249, v58, v59
v_cvt_pk_bf16_f32 v250, v60, v61
v_cvt_pk_bf16_f32 v251, v62, v63
v_permlane32_swap_b32 v244, v246
v_permlane32_swap_b32 v245, v247
v_permlane32_swap_b32 v248, v250
v_permlane32_swap_b32 v249, v251
v_permlane16_swap_b32 v244, v246
v_permlane16_swap_b32 v245, v247
v_permlane16_swap_b32 v248, v250
v_permlane16_swap_b32 v249, v251
buffer_store_dwordx4 v[244:247], v2, s[24:27], s40 offen offset:0
buffer_store_dwordx4 v[248:251], v2, s[24:27], s40 offen offset:1024
v_dot2_f32_bf16 v252, v244, v20, 0
v_dot2_f32_bf16 v253, v244, v244, 0
v_dot2_f32_bf16 v252, v245, v20, v252
v_dot2_f32_bf16 v253, v245, v245, v253
v_dot2_f32_bf16 v252, v246, v20, v252
v_dot2_f32_bf16 v253, v246, v246, v253
v_dot2_f32_bf16 v252, v247, v20, v252
v_dot2_f32_bf16 v253, v247, v247, v253
v_dot2_f32_bf16 v252, v248, v20, v252
v_dot2_f32_bf16 v253, v248, v248, v253
v_dot2_f32_bf16 v252, v249, v20, v252
v_dot2_f32_bf16 v253, v249, v249, v253
v_dot2_f32_bf16 v252, v250, v20, v252
v_dot2_f32_bf16 v253, v250, v250, v253
v_dot2_f32_bf16 v252, v251, v20, v252
v_dot2_f32_bf16 v253, v251, v251, v253
s_nop 1
v_mov_b32 v122, v252
v_mov_b32 v123, v253
s_nop 0
v_permlane16_swap_b32 v252, v122
v_permlane16_swap_b32 v253, v123
v_add_f32 v252, v252, v122
v_add_f32 v253, v253, v123
v_mov_b32 v122, v252
v_mov_b32 v123, v253
s_nop 0
v_permlane32_swap_b32 v252, v122
v_permlane32_swap_b32 v253, v123
v_add_f32 v252, v252, v122
v_add_f32_e64 v253, v253, v123
v_lshlrev_b32 v29, 3, v6
s_mov_b64 exec, 0xffff
buffer_store_dwordx2 v[252:253], v29, s[24:27], s41 offen
s_mov_b64 exec, -1
v_cvt_pk_bf16_f32 v8, v48, v49
v_cvt_pk_bf16_f32 v9, v50, v51
v_cvt_pk_bf16_f32 v10, v52, v53
v_cvt_pk_bf16_f32 v11, v54, v55
v_cvt_pk_bf16_f32 v12, v56, v57
v_cvt_pk_bf16_f32 v13, v58, v59
v_cvt_pk_bf16_f32 v14, v60, v61
v_cvt_pk_bf16_f32 v15, v62, v63
Lj35:
s_lshl_b32 s22, s44, 11
s_add_u32 s22, s22, 163840
s_lshl_b32 s23, s45, 7
s_add_u32 s23, s23, s22
v_lshrrev_b32 v17, 2, v1
v_min_u32 v17, 13, v17
v_and_b32 v18, 3, v1
v_lshlrev_b32_e64 v18, 2, v18
v_lshl_add_u32 v17, v17, 7, v18
s_lshl2_add_u32 s94, s46, s23
s_add_u32 s94, s94, s63
v_mov_b32 v18, s49
s_mul_i32 s36, s46, 28672
s_add_u32 s36, s36, s60
s_add_u32 s43, s36, 8415232
s_add_u32 s42, s36, 8411136
s_add_u32 s41, s36, 8407040
s_add_u32 s40, s36, 8402944
s_add_u32 s39, s36, 8400896
s_add_u32 s38, s36, 8396800
s_add_u32 s37, s36, 8392704
s_add_u32 s36, s36, 8388608
v_cmp_eq_u32 vcc, 3, v7
v_bfrev_b32 v28, 1
s_nop 0
v_cndmask_b32 v28, v25, v28, vcc
s_lshl_b32 s56, s46, 8
s_add_u32 s56, s56, s60
s_add_u32 s56, s56, 8503296
s_add_u32 s55, s56, 128
s_lshl_b32 s58, s46, 10
s_add_u32 s58, s58, 2048
v_add_u32 v126, s58, v2
v_add_u32 v127, 0xa800, v126
s_cmp_lg_u32 s52, 0
s_waitcnt vmcnt(0)
s_mov_b64 exec, 1
buffer_store_dword v18, off, s[24:27], s94
s_mov_b64 exec, -1
s_barrier
s_cbranch_scc1 L37
buffer_load_dword v16, v17, s[24:27], s22 offen sc1
s_nop 7
buffer_load_dword v30, v17, s[24:27], s22 offen sc1
s_nop 7
buffer_load_dword v31, v17, s[24:27], s22 offen sc1
Lp39:
s_waitcnt vmcnt(2)
v_cmp_ne_u32 vcc, s49, v16
s_cbranch_vccz L36
buffer_load_dword v16, v17, s[24:27], s22 offen sc1
s_waitcnt vmcnt(2)
v_cmp_ne_u32_e64 vcc, s49, v30
s_cbranch_vccz L36
buffer_load_dword v30, v17, s[24:27], s22 offen sc1
s_waitcnt vmcnt(2)
v_cmp_ne_u32 vcc, s49, v31
s_cbranch_vccz L36
buffer_load_dword v31, v17, s[24:27], s22 offen sc1
s_sub_u32 s62, s62, 1
s_cbranch_scc0 Lp39
s_mov_b32 s62, 0
Ld40:
s_branch L36
L37:
s_cmp_lg_u32 s52, 1
s_cbranch_scc1 L38
buffer_wbl2 sc1
s_waitcnt vmcnt(0)
v_lshlrev_b32 v30, 2, v1
s_mov_b64 exec, 15
buffer_store_dword v18, v30, s[24:27], s23 offen sc1
s_mov_b64 exec, -1
Lp41:
buffer_load_dword v16, v17, s[24:27], s22 offen sc1
s_waitcnt vmcnt(0)
v_cmp_ne_u32 vcc, s49, v16
s_cbranch_vccz Ld42
s_sub_u32 s62, s62, 1
s_cbranch_scc0 Lp41
s_mov_b32 s62, 0
Ld42:
buffer_inv sc1
s_waitcnt vmcnt(0)
s_branch L36
L38:
s_lshl1_add_u32 s92, s46, s48
s_lshl_b32 s93, s53, 3
s_add_u32 s92, s92, s93
s_cmp_eq_u32 s44, 15
s_cselect_b32 s92, 0, s92
s_cmp_lg_u32 s92, 7
s_cbranch_scc1 L43
s_lshl_b32 s92, s44, 14
s_add_u32 s92, s92, 18890752
s_lshl_b32 s93, s47, 11
s_add_u32 s93, s93, s92
buffer_store_dwordx4 v[244:247], v2, s[24:27], s93 offen offset:0 sc1
buffer_store_dwordx4 v[248:251], v2, s[24:27], s93 offen offset:1024 sc1
s_lshl_b32 s93, s47, 7
s_add_u32 s94, s93, s92
s_add_u32 s94, s94, 14336
s_mov_b64 exec, 0xffff
buffer_store_dwordx2 v[252:253], v29, s[24:27], s94 offen sc1
s_mov_b64 exec, -1
s_lshl_b32 s92, s44, 10
s_add_u32 s92, s92, s93
s_add_u32 s3, s92, 295936
L43:
L36:
s_barrier
buffer_load_dwordx4 v[128:131], v2, s[24:27], s36 offen offset:0 sc1
buffer_load_dwordx4 v[184:187], v2, s[24:27], s40 offen offset:0 sc1
buffer_load_dwordx4 v[132:135], v2, s[24:27], s36 offen offset:1024 sc1
buffer_load_dwordx4 v[188:191], v2, s[24:27], s40 offen offset:1024 sc1
buffer_load_dwordx2 v[114:115], v25, s[24:27], s56 offen sc1
buffer_load_dwordx2 v[116:117], v28, s[24:27], s56 offen offset:1024 sc1
buffer_load_dwordx2 v[118:119], v25, s[24:27], s55 offen sc1
buffer_load_dwordx2 v[120:121], v28, s[24:27], s55 offen offset:1024 sc1
buffer_load_dwordx4 v[136:139], v2, s[24:27], s36 offen offset:2048 sc1
buffer_load_dwordx4 v[192:195], v2, s[24:27], s40 offen offset:2048 sc1
buffer_load_dwordx4 v[140:143], v2, s[24:27], s36 offen offset:3072 sc1
buffer_load_dwordx4 v[196:199], v2, s[24:27], s40 offen offset:3072 sc1
ds_read_b128 a[224:227], v2 offset:0
ds_read_b128 a[228:231], v2 offset:1024
ds_read_b128 a[232:235], v2 offset:2048
ds_read_b128 a[236:239], v2 offset:3072
ds_read_b128 a[240:243], v2 offset:4096
ds_read_b128 a[244:247], v2 offset:5120
s_waitcnt vmcnt(10)
s_cmp_eq_u32 s3, 0
s_cbranch_scc1 L44
v_mov_b32 v18, s50
s_mov_b64 exec, 1
buffer_store_dword v18, off, s[24:27], s3 sc1
s_mov_b64 exec, -1
L44:
s_waitcnt lgkmcnt(3)
v_mfma_f32_16x16x32_bf16 v[32:35], a[224:227], v[128:131], 0
v_mfma_f32_16x16x32_bf16 v[56:59], a[224:227], v[184:187], 0
ds_read_b128 a[248:251], v2 offset:6144
s_waitcnt vmcnt(4)
v_mfma_f32_16x16x32_bf16 v[36:39], a[228:231], v[128:131], 0
buffer_load_dwordx4 v[144:147], v2, s[24:27], s37 offen offset:0 sc1
buffer_load_dwordx4 v[200:203], v2, s[24:27], s41 offen offset:0 sc1
v_mfma_f32_16x16x32_bf16 v[60:63], a[228:231], v[184:187], 0
ds_read_b128 a[252:255], v2 offset:7168
v_add_f32_e64 v96, v114, v116
v_mfma_f32_16x16x32_bf16 v[40:43], a[232:235], v[128:131], 0
ds_read_b128 v[240:243], v126 offset:0
v_add_f32_e64 v97, v115, v117
v_mfma_f32_16x16x32_bf16 v[64:67], a[232:235], v[184:187], 0
ds_read_b128 a[224:227], v2 offset:8192
v_add_f32 v98, v118, v120
s_waitcnt lgkmcnt(4)
v_mfma_f32_16x16x32_bf16 v[44:47], a[236:239], v[128:131], 0
v_add_f32_e64 v99, v119, v121
v_mfma_f32_16x16x32_bf16 v[68:71], a[236:239], v[184:187], 0
ds_read_b128 a[228:231], v2 offset:9216
v_mov_b32_e64 v102, v96
v_mfma_f32_16x16x32_bf16 v[48:51], v[128:131], a[240:243], 0
v_mov_b32 v103, v97
v_mov_b32 v104, v98
v_mfma_f32_16x16x32_bf16 v[72:75], v[184:187], a[240:243], 0
ds_read_b128 a[232:235], v2 offset:10240
v_mov_b32_e64 v105, v99
v_mfma_f32_16x16x32_bf16 v[52:55], v[128:131], a[244:247], 0
v_permlane16_swap_b32 v96, v102
v_mfma_f32_16x16x32_bf16 v[76:79], v[184:187], a[244:247], 0
ds_read_b128 a[236:239], v2 offset:11264
s_waitcnt lgkmcnt(3)
v_mfma_f32_16x16x32_bf16 v[32:35], a[248:251], v[132:135], v[32:35]
v_mfma_f32_16x16x32_bf16 v[56:59], a[248:251], v[188:191], v[56:59]
ds_read_b128 a[240:243], v2 offset:12288
v_mfma_f32_16x16x32_bf16 v[36:39], a[252:255], v[132:135], v[36:39]
buffer_load_dwordx4 v[148:151], v2, s[24:27], s37 offen offset:1024 sc1
buffer_load_dwordx4 v[204:207], v2, s[24:27], s41 offen offset:1024 sc1
v_mfma_f32_16x16x32_bf16 v[60:63], a[252:255], v[188:191], v[60:63]
ds_read_b128 a[244:247], v2 offset:13312
v_mfma_f32_16x16x32_bf16 v[40:43], a[224:227], v[132:135], v[40:43]
ds_read_b128 v[184:187], v126 offset:6144
v_mfma_f32_16x16x32_bf16 v[64:67], a[224:227], v[188:191], v[64:67]
ds_read_b128 a[248:251], v2 offset:14336
s_waitcnt lgkmcnt(4)
v_mfma_f32_16x16x32_bf16 v[44:47], a[228:231], v[132:135], v[44:47]
v_mfma_f32_16x16x32_bf16 v[68:71], a[228:231], v[188:191], v[68:71]
ds_read_b128 a[252:255], v2 offset:15360
v_mfma_f32_16x16x32_bf16 v[48:51], v[132:135], a[232:235], v[48:51]
v_permlane16_swap_b32 v97, v103
v_mfma_f32_16x16x32_bf16 v[72:75], v[188:191], a[232:235], v[72:75]
ds_read_b128 a[224:227], v2 offset:16384
v_mfma_f32_16x16x32_bf16 v[52:55], v[132:135], a[236:239], v[52:55]
v_permlane16_swap_b32_e64 v98, v104
v_mfma_f32_16x16x32_bf16 v[76:79], v[188:191], a[236:239], v[76:79]
ds_read_b128 a[228:231], v2 offset:17408
s_waitcnt vmcnt(6)
s_waitcnt lgkmcnt(3)
v_mfma_f32_16x16x32_bf16 v[32:35], a[240:243], v[136:139], v[32:35]
v_mfma_f32_16x16x32_bf16 v[56:59], a[240:243], v[192:195], v[56:59]
ds_read_b128 a[232:235], v2 offset:18432
v_mfma_f32_16x16x32_bf16 v[36:39], a[244:247], v[136:139], v[36:39]
buffer_load_dwordx4 v[152:155], v2, s[24:27], s37 offen offset:2048 sc1
buffer_load_dwordx4 v[208:211], v2, s[24:27], s41 offen offset:2048 sc1
v_mfma_f32_16x16x32_bf16 v[60:63], a[244:247], v[192:195], v[60:63]
ds_read_b128 a[236:239], v2 offset:19456
v_mfma_f32_16x16x32_bf16 v[40:43], a[248:251], v[136:139], v[40:43]
ds_read_b128 v[188:191], v126 offset:12288
v_mfma_f32_16x16x32_bf16 v[64:67], a[248:251], v[192:195], v[64:67]
ds_read_b128 a[240:243], v2 offset:20480
s_waitcnt lgkmcnt(4)
v_mfma_f32_16x16x32_bf16 v[44:47], a[252:255], v[136:139], v[44:47]
v_mfma_f32_16x16x32_bf16 v[68:71], a[252:255], v[192:195], v[68:71]
ds_read_b128 a[244:247], v2 offset:21504
v_mfma_f32_16x16x32_bf16 v[48:51], v[136:139], a[224:227], v[48:51]
v_permlane16_swap_b32 v99, v105
v_mfma_f32_16x16x32_bf16 v[72:75], v[192:195], a[224:227], v[72:75]
ds_read_b128 a[248:251], v2 offset:22528
v_add_f32_e64 v96, v96, v102
v_mfma_f32_16x16x32_bf16 v[52:55], v[136:139], a[228:231], v[52:55]
v_add_f32 v97, v97, v103
v_add_f32 v98, v98, v104
v_mfma_f32_16x16x32_bf16 v[76:79], v[192:195], a[228:231], v[76:79]
ds_read_b128 a[252:255], v2 offset:23552
v_add_f32_e64 v99, v99, v105
s_waitcnt vmcnt(6)
s_waitcnt lgkmcnt(3)
v_mfma_f32_16x16x32_bf16 v[32:35], a[232:235], v[140:143], v[32:35]
v_mfma_f32_16x16x32_bf16 v[56:59], a[232:235], v[196:199], v[56:59]
ds_read_b128 a[224:227], v2 offset:24576
v_mov_b32_e64 v102, v96
v_mfma_f32_16x16x32_bf16 v[36:39], a[236:239], v[140:143], v[36:39]
buffer_load_dwordx4 v[156:159], v2, s[24:27], s37 offen offset:3072 sc1
buffer_load_dwordx4 v[212:215], v2, s[24:27], s41 offen offset:3072 sc1
v_mfma_f32_16x16x32_bf16 v[60:63], a[236:239], v[196:199], v[60:63]
ds_read_b128 a[228:231], v2 offset:25600
v_mov_b32_e64 v103, v97
v_mfma_f32_16x16x32_bf16 v[40:43], a[240:243], v[140:143], v[40:43]
ds_read_b128 v[192:195], v126 offset:18432
v_mov_b32_e64 v104, v98
v_mfma_f32_16x16x32_bf16 v[64:67], a[240:243], v[196:199], v[64:67]
ds_read_b128 a[232:235], v2 offset:26624
v_mov_b32 v105, v99
s_waitcnt lgkmcnt(4)
v_mfma_f32_16x16x32_bf16 v[44:47], a[244:247], v[140:143], v[44:47]
v_mfma_f32_16x16x32_bf16 v[68:71], a[244:247], v[196:199], v[68:71]
ds_read_b128 a[236:239], v2 offset:27648
v_mfma_f32_16x16x32_bf16 v[48:51], v[140:143], a[248:251], v[48:51]
v_permlane32_swap_b32_e64 v96, v102
v_mfma_f32_16x16x32_bf16 v[72:75], v[196:199], a[248:251], v[72:75]
ds_read_b128 a[240:243], v2 offset:28672
v_mfma_f32_16x16x32_bf16 v[52:55], v[140:143], a[252:255], v[52:55]
v_permlane32_swap_b32_e64 v97, v103
v_mfma_f32_16x16x32_bf16 v[76:79], v[196:199], a[252:255], v[76:79]
ds_read_b128 a[244:247], v2 offset:29696
s_waitcnt vmcnt(6)
s_waitcnt lgkmcnt(3)
v_mfma_f32_16x16x32_bf16 v[32:35], a[224:227], v[144:147], v[32:35]
v_mfma_f32_16x16x32_bf16 v[56:59], a[224:227], v[200:203], v[56:59]
ds_read_b128 a[248:251], v2 offset:30720
v_mfma_f32_16x16x32_bf16 v[36:39], a[228:231], v[144:147], v[36:39]
buffer_load_dwordx4 v[160:163], v2, s[24:27], s38 offen offset:0 sc1
buffer_load_dwordx4 v[216:219], v2, s[24:27], s42 offen offset:0 sc1
v_mfma_f32_16x16x32_bf16 v[60:63], a[228:231], v[200:203], v[60:63]
ds_read_b128 a[252:255], v2 offset:31744
v_mfma_f32_16x16x32_bf16 v[40:43], a[232:235], v[144:147], v[40:43]
ds_read_b128 v[196:199], v126 offset:24576
v_mfma_f32_16x16x32_bf16 v[64:67], a[232:235], v[200:203], v[64:67]
ds_read_b128 a[224:227], v2 offset:32768
s_waitcnt lgkmcnt(4)
v_mfma_f32_16x16x32_bf16 v[44:47], a[236:239], v[144:147], v[44:47]
v_mfma_f32_16x16x32_bf16 v[68:71], a[236:239], v[200:203], v[68:71]
ds_read_b128 a[228:231], v2 offset:33792
v_mfma_f32_16x16x32_bf16 v[48:51], v[144:147], a[240:243], v[48:51]
v_permlane32_swap_b32 v98, v104
v_mfma_f32_16x16x32_bf16 v[72:75], v[200:203], a[240:243], v[72:75]
ds_read_b128 a[232:235], v2 offset:34816
v_mfma_f32_16x16x32_bf16 v[52:55], v[144:147], a[244:247], v[52:55]
v_permlane32_swap_b32_e64 v99, v105
v_mfma_f32_16x16x32_bf16 v[76:79], v[200:203], a[244:247], v[76:79]
ds_read_b128 a[236:239], v2 offset:35840
v_add_f32 v96, v96, v102
s_waitcnt vmcnt(6)
v_min_u32 v17, 6, v1
v_lshlrev_b32 v17, 7, v17
s_lshl_b32 s54, s44, 10
s_add_u32 s54, s54, 294912
buffer_load_dword v16, v17, s[24:27], s54 offen sc1
s_waitcnt lgkmcnt(3)
v_mfma_f32_16x16x32_bf16 v[32:35], a[248:251], v[148:151], v[32:35]
v_mfma_f32_16x16x32_bf16 v[56:59], a[248:251], v[204:207], v[56:59]
ds_read_b128 a[240:243], v2 offset:36864
v_add_f32_e64 v97, v97, v103
v_mfma_f32_16x16x32_bf16 v[36:39], a[252:255], v[148:151], v[36:39]
buffer_load_dwordx4 v[164:167], v2, s[24:27], s38 offen offset:1024 sc1
buffer_load_dwordx4 v[220:223], v2, s[24:27], s42 offen offset:1024 sc1
v_mfma_f32_16x16x32_bf16 v[60:63], a[252:255], v[204:207], v[60:63]
ds_read_b128 a[244:247], v2 offset:37888
v_add_f32_e64 v98, v98, v104
v_mfma_f32_16x16x32_bf16 v[40:43], a[224:227], v[148:151], v[40:43]
ds_read_b128 v[200:203], v126 offset:30720
v_add_f32_e64 v99, v99, v105
v_mfma_f32_16x16x32_bf16 v[64:67], a[224:227], v[204:207], v[64:67]
ds_read_b128 a[248:251], v2 offset:38912
v_mul_f32 v108, 0xbb124925, v96
s_waitcnt lgkmcnt(4)
v_mfma_f32_16x16x32_bf16 v[44:47], a[228:231], v[148:151], v[44:47]
v_mul_f32 v102, v108, v108
v_mfma_f32_16x16x32_bf16 v[68:71], a[228:231], v[204:207], v[68:71]
ds_read_b128 a[252:255], v2 offset:39936
v_fma_f32 v102, v97, s100, -v102
v_mfma_f32_16x16x32_bf16 v[48:51], v[148:151], a[232:235], v[48:51]
v_max_f32_e64 v102, 0, v102
v_add_f32 v102, 0x3727c5ac, v102
v_mfma_f32_16x16x32_bf16 v[72:75], v[204:207], a[232:235], v[72:75]
ds_read_b128 a[224:227], v2 offset:40960
v_mfma_f32_16x16x32_bf16 v[52:55], v[148:151], a[236:239], v[52:55]
v_rsq_f32_e64 v109, v102
v_mfma_f32_16x16x32_bf16 v[76:79], v[204:207], a[236:239], v[76:79]
ds_read_b128 a[228:231], v2 offset:41984
v_mul_f32 v110, 0xbb124925, v98
s_waitcnt vmcnt(7)
s_waitcnt lgkmcnt(3)
v_mfma_f32_16x16x32_bf16 v[32:35], a[240:243], v[152:155], v[32:35]
v_mfma_f32_16x16x32_bf16 v[56:59], a[240:243], v[208:211], v[56:59]
ds_read_b128 a[232:235], v2 offset:43008
v_mul_f32_e64 v103, v110, v110
v_mfma_f32_16x16x32_bf16 v[36:39], a[244:247], v[152:155], v[36:39]
buffer_load_dwordx4 v[168:171], v2, s[24:27], s38 offen offset:2048 sc1
buffer_load_dwordx4 v[224:227], v2, s[24:27], s42 offen offset:2048 sc1
v_mfma_f32_16x16x32_bf16 v[60:63], a[244:247], v[208:211], v[60:63]
ds_read_b128 a[236:239], v2 offset:44032
v_fma_f32 v103, v99, s100, -v103
v_mfma_f32_16x16x32_bf16 v[40:43], a[248:251], v[152:155], v[40:43]
ds_read_b128 v[204:207], v126 offset:36864
v_max_f32 v103, 0, v103
v_mfma_f32_16x16x32_bf16 v[64:67], a[248:251], v[208:211], v[64:67]
ds_read_b128 a[240:243], v2 offset:45056
v_add_f32 v103, 0x3727c5ac, v103
s_waitcnt lgkmcnt(4)
v_mfma_f32_16x16x32_bf16 v[44:47], a[252:255], v[152:155], v[44:47]
v_mfma_f32_16x16x32_bf16 v[68:71], a[252:255], v[208:211], v[68:71]
ds_read_b128 a[244:247], v2 offset:46080
v_mfma_f32_16x16x32_bf16 v[48:51], v[152:155], a[224:227], v[48:51]
v_rsq_f32 v111, v103
v_mfma_f32_16x16x32_bf16 v[72:75], v[208:211], a[224:227], v[72:75]
ds_read_b128 a[248:251], v2 offset:47104
s_lshl_b32 s58, s46, 7
v_mfma_f32_16x16x32_bf16 v[52:55], v[152:155], a[228:231], v[52:55]
s_add_u32 s58, s58, 161280
v_lshl_add_u32 v125, v6, 2, s58
v_mfma_f32_16x16x32_bf16 v[76:79], v[208:211], a[228:231], v[76:79]
ds_read_b128 a[252:255], v2 offset:48128
ds_write2_b32 v125, v108, v109 offset0:0 offset1:160
s_waitcnt vmcnt(7)
s_waitcnt lgkmcnt(4)
v_mfma_f32_16x16x32_bf16 v[32:35], a[232:235], v[156:159], v[32:35]
v_mfma_f32_16x16x32_bf16 v[56:59], a[232:235], v[212:215], v[56:59]
ds_read_b128 a[224:227], v2 offset:49152
ds_write2_b32 v125, v110, v111 offset0:16 offset1:176
v_mfma_f32_16x16x32_bf16 v[36:39], a[236:239], v[156:159], v[36:39]
buffer_load_dwordx4 v[172:175], v2, s[24:27], s38 offen offset:3072 sc1
buffer_load_dwordx4 v[228:231], v2, s[24:27], s42 offen offset:3072 sc1
v_mfma_f32_16x16x32_bf16 v[60:63], a[236:239], v[212:215], v[60:63]
ds_read_b128 a[228:231], v2 offset:50176
v_lshl_add_u32 v124, v7, 4, s58
v_mfma_f32_16x16x32_bf16 v[40:43], a[240:243], v[156:159], v[40:43]
ds_read_b128 v[208:211], v127 offset:0
v_mfma_f32_16x16x32_bf16 v[64:67], a[240:243], v[212:215], v[64:67]
ds_read_b128 a[232:235], v2 offset:51200
s_waitcnt lgkmcnt(6)
v_mfma_f32_16x16x32_bf16 v[44:47], a[244:247], v[156:159], v[44:47]
v_mfma_f32_16x16x32_bf16 v[68:71], a[244:247], v[212:215], v[68:71]
ds_read_b128 a[236:239], v2 offset:52224
v_mfma_f32_16x16x32_bf16 v[48:51], v[156:159], a[248:251], v[48:51]
v_mfma_f32_16x16x32_bf16 v[72:75], v[212:215], a[248:251], v[72:75]
ds_read_b128 a[240:243], v2 offset:53248
v_mfma_f32_16x16x32_bf16 v[52:55], v[156:159], a[252:255], v[52:55]
v_mfma_f32_16x16x32_bf16 v[76:79], v[212:215], a[252:255], v[76:79]
ds_read_b128 a[244:247], v2 offset:54272
s_waitcnt vmcnt(7)
s_waitcnt vmcnt(6)
v_cmp_ne_u32 vcc, s49, v16
s_cbranch_vccz L45
s_cmp_eq_u32 s44, 0
s_cbranch_scc1 L45
Lp46:
buffer_load_dword v16, v17, s[24:27], s54 offen sc1
s_waitcnt vmcnt(0)
v_cmp_ne_u32 vcc, s49, v16
s_cbranch_vccz Ld47
s_sub_u32 s62, s62, 1
s_cbranch_scc0 Lp46
s_mov_b32 s62, 0
Ld47:
L45:
s_lshl_b32 s55, s46, 2
s_min_u32 s55, s55, 10
s_lshl_b32 s55, s55, 10
s_add_u32 m0, s55, 135168
s_lshl_b32 s56, s44, 14
s_add_u32 s56, s56, 18874368
s_cmp_eq_u32 s44, 0
s_cselect_b32 s56, 0x40000000, s56
s_add_u32 s55, s55, s56
s_add_u32 s56, s56, 14336
buffer_load_dwordx4 v2, s[24:27], s55 offen offset:0 sc1 lds
buffer_load_dwordx4 v2, s[24:27], s55 offen offset:1024 sc1 lds
buffer_load_dwordx4 v2, s[24:27], s55 offen offset:2048 sc1 lds
buffer_load_dwordx4 v2, s[24:27], s55 offen offset:3072 sc1 lds
v_lshlrev_b32_e64 v30, 8, v7
v_lshl_add_u32 v30, v6, 3, v30
v_cmp_eq_u32 vcc, 3, v7
v_bfrev_b32 v31, 1
s_nop 0
v_cndmask_b32 v31, v30, v31, vcc
buffer_load_dwordx2 v[100:101], v30, s[24:27], s56 offen sc1
buffer_load_dwordx2 v[102:103], v31, s[24:27], s56 offen offset:128 sc1
s_waitcnt lgkmcnt(3)
v_mfma_f32_16x16x32_bf16 v[32:35], a[224:227], v[160:163], v[32:35]
v_mfma_f32_16x16x32_bf16 v[56:59], a[224:227], v[216:219], v[56:59]
ds_read_b128 a[248:251], v2 offset:55296
v_mfma_f32_16x16x32_bf16 v[36:39], a[228:231], v[160:163], v[36:39]
buffer_load_dwordx4 v[176:179], v2, s[24:27], s39 offen offset:0 sc1
buffer_load_dwordx4 v[232:235], v2, s[24:27], s43 offen offset:0 sc1
v_mfma_f32_16x16x32_bf16 v[60:63], a[228:231], v[216:219], v[60:63]
ds_read_b128 a[252:255], v2 offset:56320
v_mfma_f32_16x16x32_bf16 v[40:43], a[232:235], v[160:163], v[40:43]
ds_read_b128 v[212:215], v127 offset:6144
v_mfma_f32_16x16x32_bf16 v[64:67], a[232:235], v[216:219], v[64:67]
ds_read_b128 a[224:227], v2 offset:57344
s_waitcnt lgkmcnt(4)
v_mfma_f32_16x16x32_bf16 v[44:47], a[236:239], v[160:163], v[44:47]
v_mfma_f32_16x16x32_bf16 v[68:71], a[236:239], v[216:219], v[68:71]
ds_read_b128 a[228:231], v2 offset:58368
v_mfma_f32_16x16x32_bf16 v[48:51], v[160:163], a[240:243], v[48:51]
v_mfma_f32_16x16x32_bf16 v[72:75], v[216:219], a[240:243], v[72:75]
ds_read_b128 a[232:235], v2 offset:59392
v_mfma_f32_16x16x32_bf16 v[52:55], v[160:163], a[244:247], v[52:55]
v_mfma_f32_16x16x32_bf16 v[76:79], v[216:219], a[244:247], v[76:79]
ds_read_b128 a[236:239], v2 offset:60416
s_waitcnt vmcnt(12)
s_waitcnt lgkmcnt(3)
v_mfma_f32_16x16x32_bf16 v[32:35], a[248:251], v[164:167], v[32:35]
v_mfma_f32_16x16x32_bf16 v[56:59], a[248:251], v[220:223], v[56:59]
ds_read_b128 a[240:243], v2 offset:61440
v_mfma_f32_16x16x32_bf16 v[36:39], a[252:255], v[164:167], v[36:39]
buffer_load_dwordx4 v[180:183], v2, s[24:27], s39 offen offset:1024 sc1
buffer_load_dwordx4 v[236:239], v2, s[24:27], s43 offen offset:1024 sc1
v_mfma_f32_16x16x32_bf16 v[60:63], a[252:255], v[220:223], v[60:63]
ds_read_b128 a[244:247], v2 offset:62464
v_mfma_f32_16x16x32_bf16 v[40:43], a[224:227], v[164:167], v[40:43]
ds_read_b128 v[216:219], v127 offset:12288
v_mfma_f32_16x16x32_bf16 v[64:67], a[224:227], v[220:223], v[64:67]
ds_read_b128 a[248:251], v2 offset:63488
s_waitcnt lgkmcnt(4)
v_mfma_f32_16x16x32_bf16 v[44:47], a[228:231], v[164:167], v[44:47]
v_mfma_f32_16x16x32_bf16 v[68:71], a[228:231], v[220:223], v[68:71]
ds_read_b128 a[252:255], v2 offset:64512
v_mfma_f32_16x16x32_bf16 v[48:51], v[164:167], a[232:235], v[48:51]
v_mfma_f32_16x16x32_bf16 v[72:75], v[220:223], a[232:235], v[72:75]
ds_read_b128 a[224:227], v3 offset:0
v_mfma_f32_16x16x32_bf16 v[52:55], v[164:167], a[236:239], v[52:55]
v_mfma_f32_16x16x32_bf16 v[76:79], v[220:223], a[236:239], v[76:79]
ds_read_b128 a[228:231], v3 offset:1024
s_waitcnt vmcnt(12)
s_barrier
s_waitcnt lgkmcnt(3)
v_mfma_f32_16x16x32_bf16 v[32:35], a[240:243], v[168:171], v[32:35]
v_mfma_f32_16x16x32_bf16 v[56:59], a[240:243], v[224:227], v[56:59]
ds_read_b128 a[232:235], v3 offset:2048
s_getpc_b64 s[92:93]
Lc48:
s_sub_u32 s92, s92, Lc48-Lpc
s_subb_u32 s93, s93, 0
s_and_b32 s13, s44, 1
s_lshl_b32 s13, s13, 4
s_add_u32 s13, s13, s45
s_mul_i32 s13, s13, CODE_NL
v_min_u32 v30, CODE_NL-1, v1
v_add_u32 v30, s13, v30
v_lshlrev_b32_e64 v30, 7, v30
v_min_u32 v30, Lcode_end-Lpc-4, v30
global_load_dword v16, v30, s[92:93]
v_mfma_f32_16x16x32_bf16 v[36:39], a[244:247], v[168:171], v[36:39]
v_mfma_f32_16x16x32_bf16 v[60:63], a[244:247], v[224:227], v[60:63]
ds_read_b128 a[236:239], v3 offset:3072
v_mfma_f32_16x16x32_bf16 v[40:43], a[248:251], v[168:171], v[40:43]
ds_read_b128 v[220:223], v127 offset:18432
v_mfma_f32_16x16x32_bf16 v[64:67], a[248:251], v[224:227], v[64:67]
ds_read_b128 a[240:243], v3 offset:4096
s_waitcnt lgkmcnt(4)
v_mfma_f32_16x16x32_bf16 v[44:47], a[252:255], v[168:171], v[44:47]
s_add_u32 m0, s5, 102400
s_add_u32 s11, s89, 100352
buffer_load_dwordx4 v19, s[16:19], s11 offen  lds
v_mfma_f32_16x16x32_bf16 v[68:71], a[252:255], v[224:227], v[68:71]
ds_read_b128 a[244:247], v3 offset:5120
v_mfma_f32_16x16x32_bf16 v[48:51], v[168:171], a[224:227], v[48:51]
v_mfma_f32_16x16x32_bf16 v[72:75], v[224:227], a[224:227], v[72:75]
ds_read_b128 a[248:251], v3 offset:6144
v_mfma_f32_16x16x32_bf16 v[52:55], v[168:171], a[228:231], v[52:55]
v_mfma_f32_16x16x32_bf16 v[76:79], v[224:227], a[228:231], v[76:79]
ds_read_b128 a[252:255], v3 offset:7168
s_add_u32 m0, s5, 103424
s_add_u32 s11, s89, 107520
buffer_load_dwordx4 v19, s[16:19], s11 offen  lds
s_waitcnt vmcnt(13)
s_waitcnt lgkmcnt(3)
v_mfma_f32_16x16x32_bf16 v[32:35], a[232:235], v[172:175], v[32:35]
v_mfma_f32_16x16x32_bf16 v[56:59], a[232:235], v[228:231], v[56:59]
ds_read_b128 a[224:227], v3 offset:8192
v_mfma_f32_16x16x32_bf16 v[36:39], a[236:239], v[172:175], v[36:39]
v_mfma_f32_16x16x32_bf16 v[60:63], a[236:239], v[228:231], v[60:63]
ds_read_b128 a[228:231], v3 offset:9216
v_mfma_f32_16x16x32_bf16 v[40:43], a[240:243], v[172:175], v[40:43]
ds_read_b128 v[224:227], v127 offset:24576
s_add_u32 m0, s5, 104448
s_add_u32 s11, s89, 114688
buffer_load_dwordx4 v19, s[16:19], s11 offen  lds
v_mfma_f32_16x16x32_bf16 v[64:67], a[240:243], v[228:231], v[64:67]
ds_read_b128 a[232:235], v3 offset:10240
s_waitcnt lgkmcnt(4)
v_mfma_f32_16x16x32_bf16 v[44:47], a[244:247], v[172:175], v[44:47]
v_mfma_f32_16x16x32_bf16 v[68:71], a[244:247], v[228:231], v[68:71]
ds_read_b128 a[236:239], v3 offset:11264
v_mfma_f32_16x16x32_bf16 v[48:51], v[172:175], a[248:251], v[48:51]
v_mfma_f32_16x16x32_bf16 v[72:75], v[228:231], a[248:251], v[72:75]
ds_read_b128 a[240:243], v3 offset:12288
s_add_u32 m0, s5, 105472
s_add_u32 s11, s89, 121856
buffer_load_dwordx4 v19, s[16:19], s11 offen  lds
v_mfma_f32_16x16x32_bf16 v[52:55], v[172:175], a[252:255], v[52:55]
v_mfma_f32_16x16x32_bf16 v[76:79], v[228:231], a[252:255], v[76:79]
ds_read_b128 a[244:247], v3 offset:13312
s_waitcnt vmcnt(7)
s_barrier
s_waitcnt lgkmcnt(3)
v_mfma_f32_16x16x32_bf16 v[32:35], a[224:227], v[176:179], v[32:35]
ds_read_b128 v[128:131], v4 offset:4096
v_mfma_f32_16x16x32_bf16 v[56:59], a[224:227], v[232:235], v[56:59]
ds_read_b128 a[248:251], v3 offset:14336
v_mfma_f32_16x16x32_bf16 v[36:39], a[228:231], v[176:179], v[36:39]
ds_read_b128 v[132:135], v4 offset:5120
s_add_u32 m0, s5, 118784
s_add_u32 s11, s89, 200704
buffer_load_dwordx4 v19, s[16:19], s11 offen  lds
v_mfma_f32_16x16x32_bf16 v[60:63], a[228:231], v[232:235], v[60:63]
ds_read_b128 a[252:255], v3 offset:15360
v_mfma_f32_16x16x32_bf16 v[40:43], a[232:235], v[176:179], v[40:43]
ds_read_b128 v[228:231], v127 offset:30720
v_mfma_f32_16x16x32_bf16 v[64:67], a[232:235], v[232:235], v[64:67]
ds_read_b128 a[224:227], v3 offset:16384
s_waitcnt lgkmcnt(6)
v_mfma_f32_16x16x32_bf16 v[44:47], a[236:239], v[176:179], v[44:47]
ds_read_b128 v[136:139], v4 offset:6144
v_mfma_f32_16x16x32_bf16 v[68:71], a[236:239], v[232:235], v[68:71]
ds_read_b128 a[228:231], v3 offset:17408
s_add_u32 m0, s5, 119808
s_add_u32 s11, s89, 207872
buffer_load_dwordx4 v19, s[16:19], s11 offen  lds
v_mfma_f32_16x16x32_bf16 v[48:51], v[176:179], a[240:243], v[48:51]
ds_read_b128 v[140:143], v4 offset:7168
v_mfma_f32_16x16x32_bf16 v[72:75], v[232:235], a[240:243], v[72:75]
ds_read_b128 a[232:235], v3 offset:18432
v_mfma_f32_16x16x32_bf16 v[52:55], v[176:179], a[244:247], v[52:55]
ds_read_b128 v[144:147], v4 offset:8192
v_mfma_f32_16x16x32_bf16 v[76:79], v[232:235], a[244:247], v[76:79]
ds_read_b128 a[236:239], v3 offset:19456
s_waitcnt vmcnt(7)
s_waitcnt lgkmcnt(6)
v_mfma_f32_16x16x32_bf16 v[32:35], a[248:251], v[180:183], v[32:35]
ds_read_b128 v[148:151], v4 offset:9216
ds_read_b128 v[152:155], v4 offset:10240
s_add_u32 m0, s5, 120832
s_add_u32 s11, s89, 215040
buffer_load_dwordx4 v19, s[16:19], s11 offen  lds
v_mfma_f32_16x16x32_bf16 v[56:59], a[248:251], v[236:239], v[56:59]
ds_read_b128 v[156:159], v4 offset:11264
ds_read_b128 v[160:163], v4 offset:12288
v_mfma_f32_16x16x32_bf16 v[36:39], a[252:255], v[180:183], v[36:39]
ds_read_b128 v[164:167], v4 offset:13312
ds_read_b128 v[168:171], v4 offset:14336
v_mfma_f32_16x16x32_bf16 v[60:63], a[252:255], v[236:239], v[60:63]
ds_read_b128 v[172:175], v4 offset:15360
ds_read_b128 v[248:251], v4 offset:16384
v_mfma_f32_16x16x32_bf16 v[40:43], a[224:227], v[180:183], v[40:43]
ds_read_b128 v[232:235], v127 offset:36864
ds_read_b128 v[252:255], v4 offset:17408
v_mfma_f32_16x16x32_bf16 v[64:67], a[224:227], v[236:239], v[64:67]
s_add_u32 m0, s5, 121856
s_add_u32 s11, s89, 222208
buffer_load_dwordx4 v19, s[16:19], s11 offen  lds
s_waitcnt lgkmcnt(10)
v_mfma_f32_16x16x32_bf16 v[44:47], a[228:231], v[180:183], v[44:47]
v_mfma_f32_16x16x32_bf16 v[68:71], a[228:231], v[236:239], v[68:71]
v_mfma_f32_16x16x32_bf16 v[48:51], v[180:183], a[232:235], v[48:51]
v_mfma_f32_16x16x32_bf16 v[72:75], v[236:239], a[232:235], v[72:75]
v_mfma_f32_16x16x32_bf16 v[52:55], v[180:183], a[236:239], v[52:55]
s_add_u32 m0, s4, 0
s_add_u32 s11, s10, 172032
buffer_load_dwordx4 v2, s[24:27], s11 offen offset:0 sc1 lds
v_mfma_f32_16x16x32_bf16 v[76:79], v[236:239], a[236:239], v[76:79]
buffer_load_dwordx4 v2, s[24:27], s11 offen offset:1024 sc1 lds
buffer_load_dwordx4 v2, s[24:27], s11 offen offset:2048 sc1 lds
buffer_load_dwordx4 v2, s[24:27], s11 offen offset:3072 sc1 lds
v_lshlrev_b32_e64 v26, 4, v7
v_add_u32 v26, 159744, v26
v_lshlrev_b32 v27, 2, v6
v_add_u32 v27, 159744, v27
s_waitcnt lgkmcnt(0)
v_mfma_f32_16x16x32_bf16 v[80:83], v[240:243], v[128:131], 0
ds_read_b128 v[84:87], v26 offset:0
ds_read_b128 v[88:91], v26 offset:64
v_mfma_f32_16x16x32_bf16 v[80:83], v[184:187], v[132:135], v[80:83]
ds_read_b128 v[92:95], v26 offset:128
ds_read_b128 v[96:99], v26 offset:192
v_mfma_f32_16x16x32_bf16 v[80:83], v[188:191], v[136:139], v[80:83]
ds_read_b32 v122, v27 offset:256
ds_read_b32 v123, v27 offset:320
v_mfma_f32_16x16x32_bf16 v[80:83], v[192:195], v[140:143], v[80:83]
s_lshl_b32 s54, s46, 6
v_add_u32 v26, s54, v26
v_mfma_f32_16x16x32_bf16 v[80:83], v[196:199], v[144:147], v[80:83]
ds_read_b128 v[176:179], v26 offset:128
ds_read_b128 v[114:117], v124 offset:64
v_mfma_f32_16x16x32_bf16 v[80:83], v[200:203], v[148:151], v[80:83]
ds_read_b128 v[118:121], v124 offset:704
v_add_f32_e64 v100, v100, v102
v_mfma_f32_16x16x32_bf16 v[80:83], v[204:207], v[152:155], v[80:83]
v_add_f32 v101, v101, v103
v_mov_b32 v102, v100
v_mfma_f32_16x16x32_bf16 v[80:83], v[208:211], v[156:159], v[80:83]
v_mov_b32_e64 v103, v101
v_mfma_f32_16x16x32_bf16 v[80:83], v[212:215], v[160:163], v[80:83]
v_permlane16_swap_b32_e64 v100, v102
v_mfma_f32_16x16x32_bf16 v[80:83], v[216:219], v[164:167], v[80:83]
v_permlane16_swap_b32_e64 v101, v103
v_mfma_f32_16x16x32_bf16 v[80:83], v[220:223], v[168:171], v[80:83]
v_add_f32 v100, v100, v102
v_add_f32 v101, v101, v103
v_mfma_f32_16x16x32_bf16 v[80:83], v[224:227], v[172:175], v[80:83]
v_mov_b32 v102, v100
v_mov_b32 v103, v101
v_mfma_f32_16x16x32_bf16 v[80:83], v[228:231], v[248:251], v[80:83]
v_permlane32_swap_b32_e64 v100, v102
v_mfma_f32_16x16x32_bf16 v[80:83], v[232:235], v[252:255], v[80:83]
v_permlane32_swap_b32 v101, v103
v_add_f32 v100, v100, v102
v_add_f32_e64 v101, v101, v103
v_mul_f32 v112, 0xbb124925, v100
v_mul_f32_e64 v102, v112, v112
v_fma_f32 v102, v101, s100, -v102
v_max_f32_e64 v102, 0, v102
v_add_f32 v102, 0x3727c5ac, v102
v_rsq_f32_e64 v113, v102
ds_read_b128 v[100:103], v124
ds_read_b128 v[104:107], v124 offset:640
s_lshl_b32 s54, s46, 11
s_add_u32 s54, s54, 151552
s_cmp_eq_u32 s46, 3
s_cselect_b32 s54, 161792, s54
v_add_u32_e64 v126, s54, v2
v_lshl_add_u32 v127, v1, 3, s54
v_lshlrev_b32 v26, 5, v6
v_lshl_add_u32 v26, v7, 3, v26
s_lshl_b32 s54, s46, 3
s_lshl_b32 s55, s46, 9
s_cmp_ge_u32 s46, 2
s_cselect_b64 vcc, -1, 0
s_cselect_b32 s54, s55, s54
s_add_u32 s54, s54, 157696
v_cndmask_b32 v125, v2, v26, vcc
v_add_u32 v125, s54, v125
s_waitcnt lgkmcnt(0)
s_barrier
s_add_u32 m0, s5, 135168
s_add_u32 s11, s89, 301056
buffer_load_dwordx4 v19, s[16:19], s11 offen  lds
v_pk_fma_f32 v[80:81], v[176:177], v[112:113], v[80:81] op_sel_hi:[1,0,1]
v_pk_fma_f32 v[82:83], v[178:179], v[112:113], v[82:83] op_sel_hi:[1,0,1]
v_pk_mul_f32 v[80:81], v[80:81], v[112:113] op_sel:[0,1] op_sel_hi:[1,1]
v_pk_mul_f32 v[82:83], v[82:83], v[112:113] op_sel:[0,1] op_sel_hi:[1,1]
v_cvt_pk_bf16_f32 v80, v80, v81
v_cvt_pk_bf16_f32 v81, v82, v83
ds_write_b64 v125, v[80:81]
v_pk_fma_f32 v[64:65], v[92:93], v[110:111], v[64:65] op_sel_hi:[1,0,1]
v_pk_fma_f32 v[66:67], v[94:95], v[110:111], v[66:67] op_sel_hi:[1,0,1]
v_pk_mul_f32 v[64:65], v[64:65], v[110:111] op_sel:[0,1] op_sel_hi:[1,1]
v_pk_mul_f32 v[66:67], v[66:67], v[110:111] op_sel:[0,1] op_sel_hi:[1,1]
v_cvt_pk_bf16_f32 v64, v64, v65
v_cvt_pk_bf16_f32 v65, v66, v67
v_pk_fma_f32 v[68:69], v[96:97], v[110:111], v[68:69] op_sel_hi:[1,0,1]
v_pk_fma_f32 v[70:71], v[98:99], v[110:111], v[70:71] op_sel_hi:[1,0,1]
v_pk_mul_f32 v[68:69], v[68:69], v[110:111] op_sel:[0,1] op_sel_hi:[1,1]
v_pk_mul_f32 v[70:71], v[70:71], v[110:111] op_sel:[0,1] op_sel_hi:[1,1]
v_cvt_pk_bf16_f32 v66, v68, v69
v_cvt_pk_bf16_f32 v67, v70, v71
s_add_u32 m0, s5, 136192
s_add_u32 s11, s89, 308224
buffer_load_dwordx4 v19, s[16:19], s11 offen  lds
ds_write_b128 v126, v[64:67]
v_pk_fma_f32 v[72:73], v[114:115], v[122:123], v[72:73] op_sel:[0,0,0] op_sel_hi:[1,0,1]
v_pk_fma_f32 v[74:75], v[116:117], v[122:123], v[74:75] op_sel:[0,0,0] op_sel_hi:[1,0,1]
v_pk_mul_f32 v[72:73], v[72:73], v[118:119]
v_pk_mul_f32 v[74:75], v[74:75], v[120:121]
v_cvt_pk_bf16_f32 v248, v72, v73
v_cvt_pk_bf16_f32 v249, v74, v75
ds_write_b64 v127, v[248:249] offset:1024
v_pk_fma_f32 v[76:77], v[114:115], v[122:123], v[76:77] op_sel:[0,1,0] op_sel_hi:[1,1,1]
v_pk_fma_f32 v[78:79], v[116:117], v[122:123], v[78:79] op_sel:[0,1,0] op_sel_hi:[1,1,1]
v_pk_mul_f32 v[76:77], v[76:77], v[118:119]
v_pk_mul_f32 v[78:79], v[78:79], v[120:121]
v_cvt_pk_bf16_f32 v254, v76, v77
v_cvt_pk_bf16_f32 v255, v78, v79
ds_write_b64 v127, v[254:255] offset:1536
v_pk_fma_f32 v[40:41], v[92:93], v[108:109], v[40:41] op_sel_hi:[1,0,1]
v_pk_fma_f32 v[42:43], v[94:95], v[108:109], v[42:43] op_sel_hi:[1,0,1]
v_pk_mul_f32 v[40:41], v[40:41], v[108:109] op_sel:[0,1] op_sel_hi:[1,1]
v_pk_mul_f32 v[42:43], v[42:43], v[108:109] op_sel:[0,1] op_sel_hi:[1,1]
v_cvt_pk_bf16_f32 v40, v40, v41
v_cvt_pk_bf16_f32 v41, v42, v43
s_add_u32 m0, s5, 137216
s_add_u32 s11, s89, 315392
buffer_load_dwordx4 v19, s[16:19], s11 offen  lds
v_pk_fma_f32 v[44:45], v[96:97], v[108:109], v[44:45] op_sel_hi:[1,0,1]
v_pk_fma_f32 v[46:47], v[98:99], v[108:109], v[46:47] op_sel_hi:[1,0,1]
v_pk_mul_f32 v[44:45], v[44:45], v[108:109] op_sel:[0,1] op_sel_hi:[1,1]
v_pk_mul_f32 v[46:47], v[46:47], v[108:109] op_sel:[0,1] op_sel_hi:[1,1]
v_cvt_pk_bf16_f32 v42, v44, v45
v_cvt_pk_bf16_f32 v43, v46, v47
v_pk_fma_f32 v[32:33], v[84:85], v[108:109], v[32:33] op_sel_hi:[1,0,1]
v_pk_fma_f32 v[34:35], v[86:87], v[108:109], v[34:35] op_sel_hi:[1,0,1]
v_cvt_pk_bf16_f32 v32, v32, v33
v_cvt_pk_bf16_f32 v33, v34, v35
v_pk_fma_f32 v[36:37], v[88:89], v[108:109], v[36:37] op_sel_hi:[1,0,1]
v_pk_fma_f32 v[38:39], v[90:91], v[108:109], v[38:39] op_sel_hi:[1,0,1]
v_cvt_pk_bf16_f32 v34, v36, v37
v_cvt_pk_bf16_f32 v35, v38, v39
v_cndmask_b32_e64 v34, v34, 0, s[20:21]
v_cndmask_b32_e64 v35, v35, 0, s[20:21]
v_pk_fma_f32 v[56:57], v[84:85], v[110:111], v[56:57] op_sel_hi:[1,0,1]
v_pk_fma_f32 v[58:59], v[86:87], v[110:111], v[58:59] op_sel_hi:[1,0,1]
v_cvt_pk_bf16_f32 v56, v56, v57
v_cvt_pk_bf16_f32 v57, v58, v59
s_add_u32 m0, s5, 138240
s_add_u32 s11, s89, 322560
buffer_load_dwordx4 v19, s[16:19], s11 offen  lds
v_pk_fma_f32 v[60:61], v[88:89], v[110:111], v[60:61] op_sel_hi:[1,0,1]
v_pk_fma_f32 v[62:63], v[90:91], v[110:111], v[62:63] op_sel_hi:[1,0,1]
v_cvt_pk_bf16_f32 v58, v60, v61
v_cvt_pk_bf16_f32 v59, v62, v63
v_cndmask_b32_e64 v58, v58, 0, s[20:21]
v_cndmask_b32_e64 v59, v59, 0, s[20:21]
s_sub_u32 s54, s46, 1
s_and_b32 s54, s54, 3
s_lshl_b32 s54, s54, 11
s_add_u32 s54, s54, 151552
v_add_u32 v28, s54, v2
v_lshl_add_u32 v29, v1, 3, s54
s_waitcnt lgkmcnt(0)
s_barrier
ds_read_b128 v[240:243], v28
ds_read_b64 v[244:245], v29 offset:1024
ds_read_b64 v[250:251], v29 offset:1536
v_pk_fma_f32 v[48:49], v[100:101], v[122:123], v[48:49] op_sel:[0,0,0] op_sel_hi:[1,0,1]
v_pk_fma_f32 v[50:51], v[102:103], v[122:123], v[50:51] op_sel:[0,0,0] op_sel_hi:[1,0,1]
v_pk_mul_f32 v[48:49], v[48:49], v[104:105]
v_pk_mul_f32 v[50:51], v[50:51], v[106:107]
v_cvt_pk_bf16_f32 v246, v48, v49
v_cvt_pk_bf16_f32 v247, v50, v51
s_add_u32 m0, s4, 4096
s_add_u32 s11, s10, 176128
buffer_load_dwordx4 v2, s[24:27], s11 offen offset:0 sc1 lds
v_pk_fma_f32 v[52:53], v[100:101], v[122:123], v[52:53] op_sel:[0,1,0] op_sel_hi:[1,1,1]
v_pk_fma_f32 v[54:55], v[102:103], v[122:123], v[54:55] op_sel:[0,1,0] op_sel_hi:[1,1,1]
v_pk_mul_f32 v[52:53], v[52:53], v[104:105]
v_pk_mul_f32 v[54:55], v[54:55], v[106:107]
v_cvt_pk_bf16_f32 v252, v52, v53
v_cvt_pk_bf16_f32 v253, v54, v55
v_mul_f32 v104, 0x3e8b97f6, v109
v_mul_f32 v106, 0x3e8b97f6, v111
s_lshl_b32 s54, s46, 15
s_lshl_b32 s55, s101, 10
s_add_u32 s54, s54, s55
s_add_u32 s54, s54, s60
s_add_u32 s95, s54, 12582912
s_add_u32 s96, s95, 16384
s_cmp_lg_u32 s46, 0
s_cbranch_scc1 L49
v_lshlrev_b32_e64 v29, 3, v1
v_add_u32 v29, 158720, v29
ds_read_b64_tr_b16 v[244:245], v29 offset:0
ds_read_b64_tr_b16 v[250:251], v29 offset:512
L49:
buffer_load_dwordx4 v2, s[24:27], s11 offen offset:1024 sc1 lds
v_mfma_f32_16x16x32_bf16 v[132:135], v[64:67], v[56:59], 0
v_mfma_f32_16x16x32_bf16 v[128:131], v[40:43], v[56:59], 0
v_mfma_f32_16x16x32_bf16 v[212:215], v[40:43], v[32:35], 0
s_waitcnt lgkmcnt(2)
v_mfma_f32_16x16x32_bf16 v[208:211], v[240:243], v[32:35], 0
s_nop 5
v_cndmask_b32 v212, v5, v212, s[64:65]
v_cndmask_b32 v132, v5, v132, s[64:65]
v_cndmask_b32 v133, v5, v133, s[66:67]
v_cndmask_b32 v134, v5, v134, s[68:69]
v_cndmask_b32 v135, v5, v135, s[70:71]
v_cndmask_b32 v213, v5, v213, s[66:67]
v_cndmask_b32 v214, v5, v214, s[68:69]
v_cndmask_b32 v215, v5, v215, s[70:71]
v_cndmask_b32 v208, v5, v208, s[80:81]
buffer_load_dwordx4 v2, s[24:27], s11 offen offset:2048 sc1 lds
v_cndmask_b32 v128, v5, v128, s[72:73]
v_cndmask_b32 v129, v5, v129, s[74:75]
v_cndmask_b32 v130, v5, v130, s[76:77]
v_cndmask_b32 v131, v5, v131, s[78:79]
v_cndmask_b32 v209, v5, v209, s[82:83]
v_cndmask_b32 v210, v5, v210, s[84:85]
v_cndmask_b32 v211, v5, v211, s[86:87]
v_max3_f32 v154, v212, v213, v214
v_max3_f32 v152, v132, v133, v134
v_max3_f32 v153, v135, v128, v129
v_max3_f32 v152, v152, v130, v131
v_max_f32_e64 v152, v152, v153
v_max3_f32 v155, v215, v208, v209
v_max3_f32 v154, v154, v210, v211
v_max_f32 v154, v154, v155
v_mov_b32 v155, v154
v_mov_b32 v153, v152
s_nop 1
v_permlane16_swap_b32_e64 v152, v153
s_add_u32 m0, s4, 28672
s_add_u32 s11, s10, 143360
buffer_load_dwordx4 v2, s[24:27], s11 offen offset:0 sc1 lds
v_max_f32 v152, v152, v153
v_mov_b32 v153, v152
v_permlane16_swap_b32 v154, v155
v_max_f32 v154, v154, v155
v_mov_b32 v155, v154
s_nop 1
v_permlane32_swap_b32 v154, v155
v_permlane32_swap_b32 v152, v153
v_max_f32 v152, v152, v153
v_mul_f32 v152, v152, v106
v_pk_fma_f32 v[128:129], v[128:129], v[106:107], v[152:153] op_sel_hi:[1,0,0] neg_lo:[0,0,1] neg_hi:[0,0,1]
v_max_f32 v154, v154, v155
v_mul_f32 v154, v154, v104
v_pk_fma_f32 v[208:209], v[208:209], v[104:105], v[154:155] op_sel_hi:[1,0,0] neg_lo:[0,0,1] neg_hi:[0,0,1]
v_pk_fma_f32 v[210:211], v[210:211], v[104:105], v[154:155] op_sel_hi:[1,0,0] neg_lo:[0,0,1] neg_hi:[0,0,1]
v_pk_fma_f32 v[130:131], v[130:131], v[106:107], v[152:153] op_sel_hi:[1,0,0] neg_lo:[0,0,1] neg_hi:[0,0,1]
v_pk_fma_f32 v[132:133], v[132:133], v[106:107], v[152:153] op_sel_hi:[1,0,0] neg_lo:[0,0,1] neg_hi:[0,0,1]
v_pk_fma_f32 v[134:135], v[134:135], v[106:107], v[152:153] op_sel_hi:[1,0,0] neg_lo:[0,0,1] neg_hi:[0,0,1]
v_exp_f32_e64 v128, v128
v_pk_fma_f32 v[212:213], v[212:213], v[104:105], v[154:155] op_sel_hi:[1,0,0] neg_lo:[0,0,1] neg_hi:[0,0,1]
v_pk_fma_f32 v[214:215], v[214:215], v[104:105], v[154:155] op_sel_hi:[1,0,0] neg_lo:[0,0,1] neg_hi:[0,0,1]
v_exp_f32 v208, v208
v_exp_f32 v209, v209
v_exp_f32 v129, v129
v_exp_f32 v130, v130
v_exp_f32 v131, v131
v_exp_f32 v132, v132
v_exp_f32 v210, v210
v_exp_f32 v211, v211
v_exp_f32 v212, v212
v_exp_f32 v213, v213
v_exp_f32 v133, v133
v_exp_f32 v134, v134
v_exp_f32_e64 v135, v135
v_cvt_pk_bf16_f32 v136, v128, v129
v_exp_f32 v214, v214
v_exp_f32 v215, v215
v_cvt_pk_bf16_f32 v216, v208, v209
v_cvt_pk_bf16_f32 v217, v210, v211
v_cvt_pk_bf16_f32 v137, v130, v131
v_cvt_pk_bf16_f32 v138, v132, v133
v_cvt_pk_bf16_f32 v139, v134, v135
s_nop 1
v_mfma_f32_16x16x32_bf16 v[148:151], v[20:23], v[136:139], 0
v_cvt_pk_bf16_f32 v218, v212, v213
v_cvt_pk_bf16_f32 v219, v214, v215
s_waitcnt lgkmcnt(0)
s_nop 0
v_mfma_f32_16x16x32_bf16 v[228:231], v[20:23], v[216:219], 0
v_mfma_f32_16x16x32_bf16 v[140:143], v[246:249], v[136:139], 0
v_mfma_f32_16x16x32_bf16 v[144:147], v[252:255], v[136:139], 0
s_nop 0
v_rcp_f32 v152, v148
s_nop 0
v_cndmask_b32_e64 v153, v152, 0, s[20:21]
v_mfma_f32_16x16x32_bf16 v[220:223], v[244:247], v[216:219], 0
v_mfma_f32_16x16x32_bf16 v[224:227], v[250:253], v[216:219], 0
v_rcp_f32 v154, v228
s_nop 0
v_cndmask_b32_e64 v155, v154, 0, s[20:21]
v_pk_mul_f32 v[140:141], v[140:141], v[152:153] op_sel_hi:[1,0]
v_pk_mul_f32 v[142:143], v[142:143], v[152:153] op_sel_hi:[1,0]
v_pk_mul_f32 v[144:145], v[144:145], v[152:153] op_sel:[0,1] op_sel_hi:[1,1]
v_pk_mul_f32 v[146:147], v[146:147], v[152:153] op_sel:[0,1] op_sel_hi:[1,1]
v_pk_mul_f32 v[220:221], v[220:221], v[154:155] op_sel_hi:[1,0]
v_pk_mul_f32 v[222:223], v[222:223], v[154:155] op_sel_hi:[1,0]
v_pk_mul_f32 v[224:225], v[224:225], v[154:155] op_sel:[0,1] op_sel_hi:[1,1]
v_pk_mul_f32 v[226:227], v[226:227], v[154:155] op_sel:[0,1] op_sel_hi:[1,1]
v_cvt_pk_bf16_f32 v140, v140, v141
v_cvt_pk_bf16_f32 v141, v142, v143
v_cvt_pk_bf16_f32 v142, v144, v145
v_cvt_pk_bf16_f32 v143, v146, v147
v_cvt_pk_bf16_f32 v220, v220, v221
v_cvt_pk_bf16_f32 v221, v222, v223
v_cvt_pk_bf16_f32 v222, v224, v225
v_cvt_pk_bf16_f32 v223, v226, v227
buffer_store_dwordx4 v[140:143], v2, s[24:27], s96 offen
buffer_store_dwordx4 v[220:223], v2, s[24:27], s95 offen
v_lshlrev_b32_e64 v32, 16, v8
v_and_b32 v33, 0xffff0000, v8
v_lshlrev_b32_e64 v34, 16, v9
v_and_b32 v35, 0xffff0000, v9
v_lshlrev_b32_e64 v36, 16, v10
v_and_b32 v37, 0xffff0000, v10
v_lshlrev_b32_e64 v38, 16, v11
v_and_b32 v39, 0xffff0000, v11
v_lshlrev_b32_e64 v40, 16, v12
v_and_b32 v41, 0xffff0000, v12
v_lshlrev_b32_e64 v42, 16, v13
v_and_b32 v43, 0xffff0000, v13
v_lshlrev_b32_e64 v44, 16, v14
v_and_b32 v45, 0xffff0000, v14
v_lshlrev_b32_e64 v46, 16, v15
v_and_b32 v47, 0xffff0000, v15
buffer_load_dwordx4 v2, s[24:27], s11 offen offset:1024 sc1 lds
buffer_load_dwordx4 v2, s[24:27], s11 offen offset:2048 sc1 lds
buffer_load_dwordx4 v2, s[24:27], s11 offen offset:3072 sc1 lds
s_lshl_b32 s22, s44, 11
s_add_u32 s22, s22, 196608
s_lshl_b32 s23, s45, 7
s_add_u32 s23, s23, s22
v_lshrrev_b32 v17, 2, v1
v_min_u32 v17, 15, v17
v_and_b32 v18, 3, v1
v_lshlrev_b32_e64 v18, 2, v18
v_lshl_add_u32 v17, v17, 7, v18
s_lshl2_add_u32 s94, s46, s23
s_add_u32 s94, s94, s63
v_mov_b32 v18, s49
s_lshl2_add_u32 s36, s48, s46
s_lshl_b32 s36, s36, 14
s_add_u32 s36, s36, s60
s_add_u32 s39, s36, 12595200
s_add_u32 s38, s36, 12591104
s_add_u32 s37, s36, 12587008
s_add_u32 s36, s36, 12582912
v_lshrrev_b32_e64 v26, 2, v6
v_lshl_add_u32 v26, v7, 2, v26
v_bfe_u32 v27, v26, 1, 2
v_lshlrev_b32_e64 v27, 5, v27
v_lshl_add_u32 v26, v26, 7, v27
v_and_b32_e64 v27, 3, v1
v_lshl_add_u32 v26, v27, 3, v26
v_add_u32 v48, 86016, v26
v_xor_b32_e64 v49, 32, v48
v_xor_b32 v50, 64, v48
v_xor_b32 v51, 96, v48
s_lshl2_add_u32 s40, s48, s46
s_mul_i32 s40, s40, 14336
s_lshl_b32 s59, s47, 11
s_add_u32 s40, s40, s59
s_add_u32 s40, s40, s60
s_add_u32 s40, s40, 8388608
s_lshl2_add_u32 s41, s48, s46
s_lshl_b32 s41, s41, 7
s_lshl_b32 s59, s47, 10
s_add_u32 s41, s41, s59
s_add_u32 s41, s41, s60
s_add_u32 s41, s41, 8503296
s_add_u32 m0, s4, 32768
s_add_u32 s11, s10, 147456
buffer_load_dwordx4 v2, s[24:27], s11 offen offset:0 sc1 lds
buffer_load_dwordx4 v2, s[24:27], s11 offen offset:1024 sc1 lds
buffer_load_dwordx4 v2, s[24:27], s11 offen offset:2048 sc1 lds
s_cmp_lg_u32 s52, 0
s_waitcnt vmcnt(6)
s_mov_b64 exec, 1
buffer_store_dword v18, off, s[24:27], s94
s_mov_b64 exec, -1
s_barrier
s_cbranch_scc1 L51
buffer_load_dword v16, v17, s[24:27], s22 offen sc1
ds_read_b64_tr_b16 v[52:53], v48 offset:0
ds_read_b64_tr_b16 v[54:55], v48 offset:2048
ds_read_b64_tr_b16 v[56:57], v49 offset:0
ds_read_b64_tr_b16 v[58:59], v49 offset:2048
ds_read_b64_tr_b16 v[60:61], v50 offset:0
ds_read_b64_tr_b16 v[62:63], v50 offset:2048
ds_read_b64_tr_b16 v[64:65], v51 offset:0
ds_read_b64_tr_b16 v[66:67], v51 offset:2048
ds_read_b64_tr_b16 v[68:69], v48 offset:4096
ds_read_b64_tr_b16 v[70:71], v48 offset:6144
ds_read_b64_tr_b16 v[72:73], v49 offset:4096
ds_read_b64_tr_b16 v[74:75], v49 offset:6144
ds_read_b64_tr_b16 v[76:77], v50 offset:4096
ds_read_b64_tr_b16 v[78:79], v50 offset:6144
ds_read_b64_tr_b16 v[80:81], v51 offset:4096
ds_read_b64_tr_b16 v[82:83], v51 offset:6144
ds_read_b64_tr_b16 v[84:85], v48 offset:8192
ds_read_b64_tr_b16 v[86:87], v48 offset:10240
ds_read_b64_tr_b16 v[88:89], v49 offset:8192
ds_read_b64_tr_b16 v[90:91], v49 offset:10240
ds_read_b64_tr_b16 v[92:93], v50 offset:8192
ds_read_b64_tr_b16 v[94:95], v50 offset:10240
ds_read_b64_tr_b16 v[96:97], v51 offset:8192
ds_read_b64_tr_b16 v[98:99], v51 offset:10240
ds_read_b64_tr_b16 v[100:101], v48 offset:12288
ds_read_b64_tr_b16 v[102:103], v48 offset:14336
ds_read_b64_tr_b16 v[104:105], v49 offset:12288
ds_read_b64_tr_b16 v[106:107], v49 offset:14336
ds_read_b64_tr_b16 v[108:109], v50 offset:12288
ds_read_b64_tr_b16 v[110:111], v50 offset:14336
ds_read_b64_tr_b16 v[192:193], v51 offset:12288
ds_read_b64_tr_b16 v[194:195], v51 offset:14336
ds_read_b64_tr_b16 v[196:197], v48 offset:16384
ds_read_b64_tr_b16 v[198:199], v48 offset:18432
ds_read_b64_tr_b16 v[200:201], v49 offset:16384
ds_read_b64_tr_b16 v[202:203], v49 offset:18432
ds_read_b64_tr_b16 v[204:205], v50 offset:16384
ds_read_b64_tr_b16 v[206:207], v50 offset:18432
ds_read_b64_tr_b16 v[208:209], v51 offset:16384
ds_read_b64_tr_b16 v[210:211], v51 offset:18432
ds_read_b64_tr_b16 v[212:213], v48 offset:20480
ds_read_b64_tr_b16 v[214:215], v48 offset:22528
ds_read_b64_tr_b16 v[216:217], v49 offset:20480
ds_read_b64_tr_b16 v[218:219], v49 offset:22528
ds_read_b64_tr_b16 v[220:221], v50 offset:20480
ds_read_b64_tr_b16 v[222:223], v50 offset:22528
ds_read_b64_tr_b16 v[224:225], v51 offset:20480
ds_read_b64_tr_b16 v[226:227], v51 offset:22528
ds_read_b64_tr_b16 v[228:229], v48 offset:24576
ds_read_b64_tr_b16 v[230:231], v48 offset:26624
ds_read_b64_tr_b16 v[232:233], v49 offset:24576
ds_read_b64_tr_b16 v[234:235], v49 offset:26624
ds_read_b64_tr_b16 v[236:237], v50 offset:24576
ds_read_b64_tr_b16 v[238:239], v50 offset:26624
ds_read_b64_tr_b16 v[240:241], v51 offset:24576
ds_read_b64_tr_b16 v[242:243], v51 offset:26624
ds_read_b64_tr_b16 v[244:245], v48 offset:28672
ds_read_b64_tr_b16 v[246:247], v48 offset:30720
ds_read_b64_tr_b16 v[248:249], v49 offset:28672
ds_read_b64_tr_b16 v[250:251], v49 offset:30720
buffer_load_dword v16, v17, s[24:27], s22 offen sc1
ds_read_b64_tr_b16 v[252:253], v50 offset:28672
ds_read_b64_tr_b16 v[254:255], v50 offset:30720
ds_read_b64_tr_b16 a[224:225], v51 offset:28672
ds_read_b64_tr_b16 a[226:227], v51 offset:30720
ds_read_b64_tr_b16 a[228:229], v48 offset:32768
ds_read_b64_tr_b16 a[230:231], v48 offset:34816
ds_read_b64_tr_b16 a[232:233], v49 offset:32768
ds_read_b64_tr_b16 a[234:235], v49 offset:34816
ds_read_b64_tr_b16 a[236:237], v50 offset:32768
ds_read_b64_tr_b16 a[238:239], v50 offset:34816
ds_read_b64_tr_b16 a[240:241], v51 offset:32768
ds_read_b64_tr_b16 a[242:243], v51 offset:34816
s_waitcnt vmcnt(0)
v_cmp_ne_u32 vcc, s49, v16
s_cbranch_vccz L50
buffer_load_dword v16, v17, s[24:27], s22 offen sc1
s_nop 7
buffer_load_dword v30, v17, s[24:27], s22 offen sc1
s_nop 7
buffer_load_dword v31, v17, s[24:27], s22 offen sc1
Lp53:
s_waitcnt vmcnt(2)
v_cmp_ne_u32 vcc, s49, v16
s_cbranch_vccz L50
buffer_load_dword v16, v17, s[24:27], s22 offen sc1
s_waitcnt vmcnt(2)
v_cmp_ne_u32 vcc, s49, v30
s_cbranch_vccz L50
buffer_load_dword v30, v17, s[24:27], s22 offen sc1
s_waitcnt vmcnt(2)
v_cmp_ne_u32 vcc, s49, v31
s_cbranch_vccz L50
buffer_load_dword v31, v17, s[24:27], s22 offen sc1
s_sub_u32 s62, s62, 1
s_cbranch_scc0 Lp53
s_mov_b32 s62, 0
Ld54:
s_branch L50
L51:
ds_read_b64_tr_b16 v[52:53], v48 offset:0
ds_read_b64_tr_b16 v[54:55], v48 offset:2048
ds_read_b64_tr_b16 v[56:57], v49 offset:0
ds_read_b64_tr_b16 v[58:59], v49 offset:2048
ds_read_b64_tr_b16 v[60:61], v50 offset:0
ds_read_b64_tr_b16 v[62:63], v50 offset:2048
ds_read_b64_tr_b16 v[64:65], v51 offset:0
ds_read_b64_tr_b16 v[66:67], v51 offset:2048
ds_read_b64_tr_b16 v[68:69], v48 offset:4096
ds_read_b64_tr_b16 v[70:71], v48 offset:6144
ds_read_b64_tr_b16 v[72:73], v49 offset:4096
ds_read_b64_tr_b16 v[74:75], v49 offset:6144
ds_read_b64_tr_b16 v[76:77], v50 offset:4096
ds_read_b64_tr_b16 v[78:79], v50 offset:6144
ds_read_b64_tr_b16 v[80:81], v51 offset:4096
ds_read_b64_tr_b16 v[82:83], v51 offset:6144
ds_read_b64_tr_b16 v[84:85], v48 offset:8192
ds_read_b64_tr_b16 v[86:87], v48 offset:10240
ds_read_b64_tr_b16 v[88:89], v49 offset:8192
ds_read_b64_tr_b16 v[90:91], v49 offset:10240
ds_read_b64_tr_b16 v[92:93], v50 offset:8192
ds_read_b64_tr_b16 v[94:95], v50 offset:10240
ds_read_b64_tr_b16 v[96:97], v51 offset:8192
ds_read_b64_tr_b16 v[98:99], v51 offset:10240
ds_read_b64_tr_b16 v[100:101], v48 offset:12288
ds_read_b64_tr_b16 v[102:103], v48 offset:14336
ds_read_b64_tr_b16 v[104:105], v49 offset:12288
ds_read_b64_tr_b16 v[106:107], v49 offset:14336
ds_read_b64_tr_b16 v[108:109], v50 offset:12288
ds_read_b64_tr_b16 v[110:111], v50 offset:14336
ds_read_b64_tr_b16 v[192:193], v51 offset:12288
ds_read_b64_tr_b16 v[194:195], v51 offset:14336
ds_read_b64_tr_b16 v[196:197], v48 offset:16384
ds_read_b64_tr_b16 v[198:199], v48 offset:18432
ds_read_b64_tr_b16 v[200:201], v49 offset:16384
ds_read_b64_tr_b16 v[202:203], v49 offset:18432
ds_read_b64_tr_b16 v[204:205], v50 offset:16384
ds_read_b64_tr_b16 v[206:207], v50 offset:18432
ds_read_b64_tr_b16 v[208:209], v51 offset:16384
ds_read_b64_tr_b16 v[210:211], v51 offset:18432
ds_read_b64_tr_b16 v[212:213], v48 offset:20480
ds_read_b64_tr_b16 v[214:215], v48 offset:22528
ds_read_b64_tr_b16 v[216:217], v49 offset:20480
ds_read_b64_tr_b16 v[218:219], v49 offset:22528
ds_read_b64_tr_b16 v[220:221], v50 offset:20480
ds_read_b64_tr_b16 v[222:223], v50 offset:22528
ds_read_b64_tr_b16 v[224:225], v51 offset:20480
ds_read_b64_tr_b16 v[226:227], v51 offset:22528
ds_read_b64_tr_b16 v[228:229], v48 offset:24576
ds_read_b64_tr_b16 v[230:231], v48 offset:26624
ds_read_b64_tr_b16 v[232:233], v49 offset:24576
ds_read_b64_tr_b16 v[234:235], v49 offset:26624
ds_read_b64_tr_b16 v[236:237], v50 offset:24576
ds_read_b64_tr_b16 v[238:239], v50 offset:26624
ds_read_b64_tr_b16 v[240:241], v51 offset:24576
ds_read_b64_tr_b16 v[242:243], v51 offset:26624
ds_read_b64_tr_b16 v[244:245], v48 offset:28672
ds_read_b64_tr_b16 v[246:247], v48 offset:30720
ds_read_b64_tr_b16 v[248:249], v49 offset:28672
ds_read_b64_tr_b16 v[250:251], v49 offset:30720
ds_read_b64_tr_b16 v[252:253], v50 offset:28672
ds_read_b64_tr_b16 v[254:255], v50 offset:30720
ds_read_b64_tr_b16 a[224:225], v51 offset:28672
ds_read_b64_tr_b16 a[226:227], v51 offset:30720
ds_read_b64_tr_b16 a[228:229], v48 offset:32768
ds_read_b64_tr_b16 a[230:231], v48 offset:34816
ds_read_b64_tr_b16 a[232:233], v49 offset:32768
ds_read_b64_tr_b16 a[234:235], v49 offset:34816
ds_read_b64_tr_b16 a[236:237], v50 offset:32768
ds_read_b64_tr_b16 a[238:239], v50 offset:34816
ds_read_b64_tr_b16 a[240:241], v51 offset:32768
ds_read_b64_tr_b16 a[242:243], v51 offset:34816
s_cmp_lg_u32 s52, 1
s_cbranch_scc1 L52
buffer_wbl2 sc1
s_waitcnt vmcnt(0)
v_lshlrev_b32_e64 v30, 2, v1
s_mov_b64 exec, 15
buffer_store_dword v18, v30, s[24:27], s23 offen sc1
s_mov_b64 exec, -1
Lp55:
buffer_load_dword v16, v17, s[24:27], s22 offen sc1
s_waitcnt vmcnt(0)
v_cmp_ne_u32 vcc, s49, v16
s_cbranch_vccz Ld56
s_sub_u32 s62, s62, 1
s_cbranch_scc0 Lp55
s_mov_b32 s62, 0
Ld56:
buffer_inv sc1
s_waitcnt vmcnt(0)
s_branch L50
L52:
L50:
s_barrier
s_cmp_lg_u32 s53, 0
s_cbranch_scc1 Li57
buffer_load_dwordx4 v[128:131], v2, s[24:27], s36 offen offset:0 sc1
buffer_load_dwordx4 v[132:135], v2, s[24:27], s36 offen offset:1024 sc1
buffer_load_dwordx4 v[136:139], v2, s[24:27], s36 offen offset:2048 sc1
buffer_load_dwordx4 v[140:143], v2, s[24:27], s36 offen offset:3072 sc1
buffer_load_dwordx4 v[144:147], v2, s[24:27], s37 offen offset:0 sc1
buffer_load_dwordx4 v[148:151], v2, s[24:27], s37 offen offset:1024 sc1
buffer_load_dwordx4 v[152:155], v2, s[24:27], s37 offen offset:2048 sc1
buffer_load_dwordx4 v[156:159], v2, s[24:27], s37 offen offset:3072 sc1
s_waitcnt lgkmcnt(0)
s_waitcnt vmcnt(7)
v_mfma_f32_16x16x32_bf16 v[32:35], v[52:55], v[128:131], v[32:35]
buffer_load_dwordx4 v[160:163], v2, s[24:27], s38 offen offset:0 sc1
v_mfma_f32_16x16x32_bf16 v[36:39], v[56:59], v[128:131], v[36:39]
ds_read_b64_tr_b16 v[52:53], v48 offset:36864
ds_read_b64_tr_b16 v[54:55], v48 offset:38912
v_mfma_f32_16x16x32_bf16 v[40:43], v[60:63], v[128:131], v[40:43]
ds_read_b64_tr_b16 v[56:57], v49 offset:36864
ds_read_b64_tr_b16 v[58:59], v49 offset:38912
v_mfma_f32_16x16x32_bf16 v[44:47], v[64:67], v[128:131], v[44:47]
ds_read_b64_tr_b16 v[60:61], v50 offset:36864
ds_read_b64_tr_b16 v[62:63], v50 offset:38912
s_waitcnt vmcnt(7)
v_mfma_f32_16x16x32_bf16 v[32:35], v[68:71], v[132:135], v[32:35]
ds_read_b64_tr_b16 v[64:65], v51 offset:36864
ds_read_b64_tr_b16 v[66:67], v51 offset:38912
buffer_load_dwordx4 v[164:167], v2, s[24:27], s38 offen offset:1024 sc1
v_mfma_f32_16x16x32_bf16 v[36:39], v[72:75], v[132:135], v[36:39]
ds_read_b64_tr_b16 v[68:69], v48 offset:40960
ds_read_b64_tr_b16 v[70:71], v48 offset:43008
v_mfma_f32_16x16x32_bf16 v[40:43], v[76:79], v[132:135], v[40:43]
ds_read_b64_tr_b16 v[72:73], v49 offset:40960
ds_read_b64_tr_b16 v[74:75], v49 offset:43008
v_mfma_f32_16x16x32_bf16 v[44:47], v[80:83], v[132:135], v[44:47]
ds_read_b64_tr_b16 v[76:77], v50 offset:40960
ds_read_b64_tr_b16 v[78:79], v50 offset:43008
s_waitcnt vmcnt(7)
v_mfma_f32_16x16x32_bf16 v[32:35], v[84:87], v[136:139], v[32:35]
ds_read_b64_tr_b16 v[80:81], v51 offset:40960
ds_read_b64_tr_b16 v[82:83], v51 offset:43008
buffer_load_dwordx4 v[168:171], v2, s[24:27], s38 offen offset:2048 sc1
v_mfma_f32_16x16x32_bf16 v[36:39], v[88:91], v[136:139], v[36:39]
ds_read_b64_tr_b16 v[84:85], v48 offset:45056
ds_read_b64_tr_b16 v[86:87], v48 offset:47104
v_mfma_f32_16x16x32_bf16 v[40:43], v[92:95], v[136:139], v[40:43]
ds_read_b64_tr_b16 v[88:89], v49 offset:45056
ds_read_b64_tr_b16 v[90:91], v49 offset:47104
v_mfma_f32_16x16x32_bf16 v[44:47], v[96:99], v[136:139], v[44:47]
ds_read_b64_tr_b16 v[92:93], v50 offset:45056
ds_read_b64_tr_b16 v[94:95], v50 offset:47104
s_waitcnt vmcnt(7)
v_mfma_f32_16x16x32_bf16 v[32:35], v[100:103], v[140:143], v[32:35]
ds_read_b64_tr_b16 v[96:97], v51 offset:45056
ds_read_b64_tr_b16 v[98:99], v51 offset:47104
buffer_load_dwordx4 v[172:175], v2, s[24:27], s38 offen offset:3072 sc1
v_mfma_f32_16x16x32_bf16 v[36:39], v[104:107], v[140:143], v[36:39]
ds_read_b64_tr_b16 v[100:101], v48 offset:49152
ds_read_b64_tr_b16 v[102:103], v48 offset:51200
v_mfma_f32_16x16x32_bf16 v[40:43], v[108:111], v[140:143], v[40:43]
ds_read_b64_tr_b16 v[104:105], v49 offset:49152
ds_read_b64_tr_b16 v[106:107], v49 offset:51200
v_mfma_f32_16x16x32_bf16 v[44:47], v[192:195], v[140:143], v[44:47]
ds_read_b64_tr_b16 v[108:109], v50 offset:49152
ds_read_b64_tr_b16 v[110:111], v50 offset:51200
s_waitcnt vmcnt(7)
v_mfma_f32_16x16x32_bf16 v[32:35], v[196:199], v[144:147], v[32:35]
ds_read_b64_tr_b16 v[192:193], v51 offset:49152
ds_read_b64_tr_b16 v[194:195], v51 offset:51200
buffer_load_dwordx4 v[176:179], v2, s[24:27], s39 offen offset:0 sc1
v_mfma_f32_16x16x32_bf16 v[36:39], v[200:203], v[144:147], v[36:39]
ds_read_b64_tr_b16 v[196:197], v48 offset:53248
ds_read_b64_tr_b16 v[198:199], v48 offset:55296
v_mfma_f32_16x16x32_bf16 v[40:43], v[204:207], v[144:147], v[40:43]
ds_read_b64_tr_b16 v[200:201], v49 offset:53248
ds_read_b64_tr_b16 v[202:203], v49 offset:55296
v_mfma_f32_16x16x32_bf16 v[44:47], v[208:211], v[144:147], v[44:47]
ds_read_b64_tr_b16 v[204:205], v50 offset:53248
ds_read_b64_tr_b16 v[206:207], v50 offset:55296
s_waitcnt vmcnt(7)
v_mfma_f32_16x16x32_bf16 v[32:35], v[212:215], v[148:151], v[32:35]
ds_read_b64_tr_b16 v[208:209], v51 offset:53248
ds_read_b64_tr_b16 v[210:211], v51 offset:55296
buffer_load_dwordx4 v[180:183], v2, s[24:27], s39 offen offset:1024 sc1
v_mfma_f32_16x16x32_bf16 v[36:39], v[216:219], v[148:151], v[36:39]
ds_read_b64_tr_b16 v[212:213], v48 offset:57344
ds_read_b64_tr_b16 v[214:215], v48 offset:59392
v_mfma_f32_16x16x32_bf16 v[40:43], v[220:223], v[148:151], v[40:43]
ds_read_b64_tr_b16 v[216:217], v49 offset:57344
ds_read_b64_tr_b16 v[218:219], v49 offset:59392
v_mfma_f32_16x16x32_bf16 v[44:47], v[224:227], v[148:151], v[44:47]
ds_read_b64_tr_b16 v[220:221], v50 offset:57344
ds_read_b64_tr_b16 v[222:223], v50 offset:59392
s_waitcnt vmcnt(7)
v_mfma_f32_16x16x32_bf16 v[32:35], v[228:231], v[152:155], v[32:35]
ds_read_b64_tr_b16 v[224:225], v51 offset:57344
ds_read_b64_tr_b16 v[226:227], v51 offset:59392
buffer_load_dwordx4 v[184:187], v2, s[24:27], s39 offen offset:2048 sc1
v_mfma_f32_16x16x32_bf16 v[36:39], v[232:235], v[152:155], v[36:39]
ds_read_b64_tr_b16 v[228:229], v48 offset:61440
ds_read_b64_tr_b16 v[230:231], v48 offset:63488
v_mfma_f32_16x16x32_bf16 v[40:43], v[236:239], v[152:155], v[40:43]
ds_read_b64_tr_b16 v[232:233], v49 offset:61440
ds_read_b64_tr_b16 v[234:235], v49 offset:63488
v_mfma_f32_16x16x32_bf16 v[44:47], v[240:243], v[152:155], v[44:47]
ds_read_b64_tr_b16 v[236:237], v50 offset:61440
ds_read_b64_tr_b16 v[238:239], v50 offset:63488
s_waitcnt vmcnt(7)
v_mfma_f32_16x16x32_bf16 v[32:35], v[244:247], v[156:159], v[32:35]
ds_read_b64_tr_b16 v[240:241], v51 offset:61440
ds_read_b64_tr_b16 v[242:243], v51 offset:63488
buffer_load_dwordx4 v[188:191], v2, s[24:27], s39 offen offset:3072 sc1
v_mfma_f32_16x16x32_bf16 v[36:39], v[248:251], v[156:159], v[36:39]
v_mfma_f32_16x16x32_bf16 v[40:43], v[252:255], v[156:159], v[40:43]
v_mfma_f32_16x16x32_bf16 v[44:47], a[224:227], v[156:159], v[44:47]
s_waitcnt vmcnt(7)
v_mfma_f32_16x16x32_bf16 v[32:35], a[228:231], v[160:163], v[32:35]
v_mfma_f32_16x16x32_bf16 v[36:39], a[232:235], v[160:163], v[36:39]
v_mfma_f32_16x16x32_bf16 v[40:43], a[236:239], v[160:163], v[40:43]
s_add_u32 m0, s4, 57344
s_add_u32 s11, s10, 114688
buffer_load_dwordx4 v2, s[24:27], s11 offen offset:0 sc1 lds
v_mfma_f32_16x16x32_bf16 v[44:47], a[240:243], v[160:163], v[44:47]
s_waitcnt vmcnt(7) lgkmcnt(15)
v_mfma_f32_16x16x32_bf16 v[32:35], v[52:55], v[164:167], v[32:35]
v_mfma_f32_16x16x32_bf16 v[36:39], v[56:59], v[164:167], v[36:39]
v_mfma_f32_16x16x32_bf16 v[40:43], v[60:63], v[164:167], v[40:43]
buffer_load_dwordx4 v2, s[24:27], s11 offen offset:1024 sc1 lds
v_mfma_f32_16x16x32_bf16 v[44:47], v[64:67], v[164:167], v[44:47]
s_waitcnt vmcnt(7) lgkmcnt(15)
v_mfma_f32_16x16x32_bf16 v[32:35], v[68:71], v[168:171], v[32:35]
v_mfma_f32_16x16x32_bf16 v[36:39], v[72:75], v[168:171], v[36:39]
v_mfma_f32_16x16x32_bf16 v[40:43], v[76:79], v[168:171], v[40:43]
buffer_load_dwordx4 v2, s[24:27], s11 offen offset:2048 sc1 lds
v_mfma_f32_16x16x32_bf16 v[44:47], v[80:83], v[168:171], v[44:47]
s_waitcnt vmcnt(7) lgkmcnt(15)
v_mfma_f32_16x16x32_bf16 v[32:35], v[84:87], v[172:175], v[32:35]
v_mfma_f32_16x16x32_bf16 v[36:39], v[88:91], v[172:175], v[36:39]
v_mfma_f32_16x16x32_bf16 v[40:43], v[92:95], v[172:175], v[40:43]
buffer_load_dwordx4 v2, s[24:27], s11 offen offset:3072 sc1 lds
v_mfma_f32_16x16x32_bf16 v[44:47], v[96:99], v[172:175], v[44:47]
s_waitcnt vmcnt(7) lgkmcnt(15)
v_mfma_f32_16x16x32_bf16 v[32:35], v[100:103], v[176:179], v[32:35]
v_mfma_f32_16x16x32_bf16 v[36:39], v[104:107], v[176:179], v[36:39]
v_mfma_f32_16x16x32_bf16 v[40:43], v[108:111], v[176:179], v[40:43]
v_mfma_f32_16x16x32_bf16 v[44:47], v[192:195], v[176:179], v[44:47]
s_waitcnt vmcnt(6) lgkmcnt(15)
v_mfma_f32_16x16x32_bf16 v[32:35], v[196:199], v[180:183], v[32:35]
v_mfma_f32_16x16x32_bf16 v[36:39], v[200:203], v[180:183], v[36:39]
v_mfma_f32_16x16x32_bf16 v[40:43], v[204:207], v[180:183], v[40:43]
v_mfma_f32_16x16x32_bf16 v[44:47], v[208:211], v[180:183], v[44:47]
s_waitcnt vmcnt(5) lgkmcnt(8)
v_mfma_f32_16x16x32_bf16 v[32:35], v[212:215], v[184:187], v[32:35]
v_mfma_f32_16x16x32_bf16 v[36:39], v[216:219], v[184:187], v[36:39]
v_mfma_f32_16x16x32_bf16 v[40:43], v[220:223], v[184:187], v[40:43]
v_mfma_f32_16x16x32_bf16 v[44:47], v[224:227], v[184:187], v[44:47]
s_waitcnt vmcnt(4) lgkmcnt(0)
v_mfma_f32_16x16x32_bf16 v[32:35], v[228:231], v[188:191], v[32:35]
v_mfma_f32_16x16x32_bf16 v[36:39], v[232:235], v[188:191], v[36:39]
v_mfma_f32_16x16x32_bf16 v[40:43], v[236:239], v[188:191], v[40:43]
v_mfma_f32_16x16x32_bf16 v[44:47], v[240:243], v[188:191], v[44:47]
s_nop 4
v_cvt_pk_bf16_f32 v8, v32, v33
v_cvt_pk_bf16_f32 v9, v34, v35
v_cvt_pk_bf16_f32 v10, v36, v37
v_cvt_pk_bf16_f32 v11, v38, v39
v_cvt_pk_bf16_f32 v12, v40, v41
v_cvt_pk_bf16_f32 v13, v42, v43
v_cvt_pk_bf16_f32 v14, v44, v45
v_cvt_pk_bf16_f32 v15, v46, v47
buffer_store_dwordx4 v[8:11], v2, s[24:27], s40 offen offset:0
buffer_store_dwordx4 v[12:15], v2, s[24:27], s40 offen offset:1024
v_dot2_f32_bf16 v252, v8, v20, 0
v_dot2_f32_bf16 v253, v8, v8, 0
v_dot2_f32_bf16 v252, v9, v20, v252
v_dot2_f32_bf16 v253, v9, v9, v253
v_dot2_f32_bf16 v252, v10, v20, v252
v_dot2_f32_bf16 v253, v10, v10, v253
v_dot2_f32_bf16 v252, v11, v20, v252
v_dot2_f32_bf16 v253, v11, v11, v253
v_dot2_f32_bf16 v252, v12, v20, v252
v_dot2_f32_bf16 v253, v12, v12, v253
v_dot2_f32_bf16 v252, v13, v20, v252
v_dot2_f32_bf16 v253, v13, v13, v253
v_dot2_f32_bf16 v252, v14, v20, v252
v_dot2_f32_bf16 v253, v14, v14, v253
v_dot2_f32_bf16 v252, v15, v20, v252
v_dot2_f32_bf16 v253, v15, v15, v253
s_nop 1
v_mov_b32 v122, v252
v_mov_b32 v123, v253
s_nop 0
v_permlane16_swap_b32 v252, v122
v_permlane16_swap_b32 v253, v123
v_add_f32 v252, v252, v122
v_add_f32 v253, v253, v123
v_mov_b32 v122, v252
v_mov_b32 v123, v253
s_nop 0
v_permlane32_swap_b32 v252, v122
v_permlane32_swap_b32 v253, v123
v_add_f32 v252, v252, v122
v_add_f32 v253, v253, v123
v_lshlrev_b32 v29, 3, v6
s_mov_b64 exec, 0xffff
buffer_store_dwordx2 v[252:253], v29, s[24:27], s41 offen
s_mov_b64 exec, -1
s_waitcnt lgkmcnt(0)
Lj59:
s_lshl_b32 s22, s44, 11
s_add_u32 s22, s22, 229376
s_lshl_b32 s23, s45, 7
s_add_u32 s23, s23, s22
v_lshrrev_b32 v17, 2, v1
v_min_u32 v17, 13, v17
v_and_b32 v18, 3, v1
v_lshlrev_b32_e64 v18, 2, v18
v_lshl_add_u32 v17, v17, 7, v18
s_lshl2_add_u32 s94, s46, s23
s_add_u32 s94, s94, s63
v_mov_b32_e64 v18, s49
v_bfe_u32 v26, v1, 4, 1
v_lshrrev_b32 v27, 5, v1
v_lshlrev_b32 v28, 4, v6
v_lshl_add_u32 v28, v27, 8, v28
s_movk_i32 s55, 14336
v_mad_u32_u24 v128, v26, s55, v28
s_mul_i32 s36, s46, 28672
s_add_u32 s36, s36, s60
s_add_u32 s39, s36, 8400896
s_add_u32 s38, s36, 8396800
s_add_u32 s37, s36, 8392704
s_add_u32 s36, s36, 8388608
v_and_b32 v129, 31, v1
v_lshlrev_b32 v129, 3, v129
v_lshl_add_u32 v129, v27, 12, v129
v_cmp_eq_u32 vcc, 1, v27
v_bfrev_b32 v30, 1
s_nop 0
v_cndmask_b32 v130, v129, v30, vcc
s_lshl_b32 s42, s46, 8
s_add_u32 s42, s42, s60
s_add_u32 s42, s42, 8503296
s_mov_b32 s55, 57344
v_mad_u32_u24 v131, v26, s55, v28
v_lshlrev_b32_e64 v132, 4, v27
v_add_u32 v132, 160256, v132
s_mul_i32 s96, s46, 114688
s_mul_i32 s59, s45, 3584
s_add_u32 s96, s96, s59
s_add_u32 s96, s96, s61
s_add_u32 s96, s96, 20971520
s_add_u32 m0, s4, 61440
s_add_u32 s11, s10, 118784
buffer_load_dwordx4 v2, s[24:27], s11 offen offset:0 sc1 lds
buffer_load_dwordx4 v2, s[24:27], s11 offen offset:1024 sc1 lds
buffer_load_dwordx4 v2, s[24:27], s11 offen offset:2048 sc1 lds
s_cmp_lg_u32 s52, 0
s_waitcnt vmcnt(3)
s_mov_b64 exec, 1
buffer_store_dword v18, off, s[24:27], s94
s_mov_b64 exec, -1
s_barrier
s_cbranch_scc1 L61
buffer_load_dword v16, v17, s[24:27], s22 offen sc1
s_nop 7
buffer_load_dword v30, v17, s[24:27], s22 offen sc1
s_nop 7
buffer_load_dword v31, v17, s[24:27], s22 offen sc1
Lp63:
s_waitcnt vmcnt(2)
v_cmp_ne_u32 vcc, s49, v16
s_cbranch_vccz L60
buffer_load_dword v16, v17, s[24:27], s22 offen sc1
s_waitcnt vmcnt(2)
v_cmp_ne_u32_e64 vcc, s49, v30
s_cbranch_vccz L60
buffer_load_dword v30, v17, s[24:27], s22 offen sc1
s_waitcnt vmcnt(2)
v_cmp_ne_u32 vcc, s49, v31
s_cbranch_vccz L60
buffer_load_dword v31, v17, s[24:27], s22 offen sc1
s_sub_u32 s62, s62, 1
s_cbranch_scc0 Lp63
s_mov_b32 s62, 0
Ld64:
s_branch L60
L61:
s_cmp_lg_u32 s52, 1
s_cbranch_scc1 L62
buffer_wbl2 sc1
s_waitcnt vmcnt(0)
v_lshlrev_b32 v30, 2, v1
s_mov_b64 exec, 15
buffer_store_dword v18, v30, s[24:27], s23 offen sc1
s_mov_b64 exec, -1
Lp65:
buffer_load_dword v16, v17, s[24:27], s22 offen sc1
s_waitcnt vmcnt(0)
v_cmp_ne_u32 vcc, s49, v16
s_cbranch_vccz Ld66
s_sub_u32 s62, s62, 1
s_cbranch_scc0 Lp65
s_mov_b32 s62, 0
Ld66:
buffer_inv sc1
s_waitcnt vmcnt(0)
s_branch L60
L62:
L60:
s_waitcnt vmcnt(1)
s_barrier
buffer_load_dwordx4 v[144:147], v128, s[24:27], s36 offen offset:0 sc1
buffer_load_dwordx4 v[148:151], v128, s[24:27], s36 offen offset:512 sc1
buffer_load_dwordx4 v[152:155], v128, s[24:27], s36 offen offset:1024 sc1
buffer_load_dwordx4 v[156:159], v128, s[24:27], s36 offen offset:1536 sc1
buffer_load_dwordx4 v[160:163], v128, s[24:27], s36 offen offset:2048 sc1
ds_read_b128 a[224:227], v2 offset:0
ds_read_b128 a[228:231], v2 offset:28672
ds_read_b128 a[232:235], v2 offset:1024
ds_read_b128 a[236:239], v2 offset:29696
ds_read_b128 a[240:243], v2 offset:2048
ds_read_b128 a[244:247], v2 offset:30720
buffer_load_dwordx2 v[136:137], v129, s[24:27], s42 offen offset:0 sc1
buffer_load_dwordx2 v[138:139], v129, s[24:27], s42 offen offset:1024 sc1
buffer_load_dwordx2 v[140:141], v129, s[24:27], s42 offen offset:2048 sc1
buffer_load_dwordx2 v[142:143], v130, s[24:27], s42 offen offset:3072 sc1
s_waitcnt vmcnt(8) lgkmcnt(4)
v_mfma_f32_32x32x16_bf16 v[32:47], a[224:227], v[144:147], 0
ds_read_b128 a[248:251], v2 offset:3072
buffer_load_dwordx4 v[164:167], v128, s[24:27], s36 offen offset:2560 sc1
v_mfma_f32_32x32x16_bf16 v[48:63], a[228:231], v[144:147], 0
ds_read_b128 a[252:255], v2 offset:31744
buffer_load_dwordx4 v[168:171], v128, s[24:27], s36 offen offset:3072 sc1
s_waitcnt vmcnt(9) lgkmcnt(4)
v_mfma_f32_32x32x16_bf16 v[32:47], a[232:235], v[148:151], v[32:47]
ds_read_b128 a[224:227], v2 offset:4096
buffer_load_dwordx4 v[172:175], v128, s[24:27], s36 offen offset:3584 sc1
v_mfma_f32_32x32x16_bf16 v[48:63], a[236:239], v[148:151], v[48:63]
ds_read_b128 a[228:231], v2 offset:32768
buffer_load_dwordx4 v[176:179], v128, s[24:27], s37 offen offset:0 sc1
s_waitcnt vmcnt(10) lgkmcnt(4)
v_mfma_f32_32x32x16_bf16 v[32:47], a[240:243], v[152:155], v[32:47]
ds_read_b128 a[232:235], v2 offset:5120
buffer_load_dwordx4 v[180:183], v128, s[24:27], s37 offen offset:512 sc1
s_waitcnt vmcnt(5)
v_add_f32_e64 v136, v136, v138
v_mfma_f32_32x32x16_bf16 v[48:63], a[244:247], v[152:155], v[48:63]
ds_read_b128 a[236:239], v2 offset:33792
buffer_load_dwordx4 v[184:187], v128, s[24:27], s37 offen offset:1024 sc1
v_add_f32 v137, v137, v139
v_add_f32 v140, v140, v142
v_add_f32 v141, v141, v143
s_waitcnt lgkmcnt(4)
v_mfma_f32_32x32x16_bf16 v[32:47], a[248:251], v[156:159], v[32:47]
ds_read_b128 a[240:243], v2 offset:6144
buffer_load_dwordx4 v[188:191], v128, s[24:27], s37 offen offset:1536 sc1
v_add_f32 v136, v136, v140
v_add_f32 v137, v137, v141
v_mfma_f32_32x32x16_bf16 v[48:63], a[252:255], v[156:159], v[48:63]
ds_read_b128 a[244:247], v2 offset:34816
buffer_load_dwordx4 v[192:195], v128, s[24:27], s37 offen offset:2048 sc1
v_mov_b32_e64 v138, v136
v_mov_b32 v139, v137
s_waitcnt lgkmcnt(4)
v_mfma_f32_32x32x16_bf16 v[32:47], a[224:227], v[160:163], v[32:47]
ds_read_b128 a[248:251], v2 offset:7168
buffer_load_dwordx4 v[196:199], v128, s[24:27], s37 offen offset:2560 sc1
v_permlane32_swap_b32_e64 v136, v138
v_mfma_f32_32x32x16_bf16 v[48:63], a[228:231], v[160:163], v[48:63]
ds_read_b128 a[252:255], v2 offset:35840
buffer_load_dwordx4 v[200:203], v128, s[24:27], s37 offen offset:3072 sc1
v_permlane32_swap_b32_e64 v137, v139
v_add_f32 v136, v136, v138
s_waitcnt vmcnt(9) lgkmcnt(4)
v_mfma_f32_32x32x16_bf16 v[32:47], a[232:235], v[164:167], v[32:47]
ds_read_b128 a[224:227], v2 offset:8192
buffer_load_dwordx4 v[204:207], v128, s[24:27], s37 offen offset:3584 sc1
v_add_f32_e64 v137, v137, v139
v_mul_f32 v133, 0xbb124925, v136
v_mfma_f32_32x32x16_bf16 v[48:63], a[236:239], v[164:167], v[48:63]
ds_read_b128 a[228:231], v2 offset:36864
buffer_load_dwordx4 v[208:211], v128, s[24:27], s38 offen offset:0 sc1
v_mul_f32_e64 v138, v133, v133
v_fma_f32 v138, v137, s100, -v138
v_max_f32 v138, 0, v138
s_waitcnt vmcnt(10) lgkmcnt(4)
v_mfma_f32_32x32x16_bf16 v[32:47], a[240:243], v[168:171], v[32:47]
ds_read_b128 a[232:235], v2 offset:9216
buffer_load_dwordx4 v[212:215], v128, s[24:27], s38 offen offset:512 sc1
v_add_f32 v138, 0x3727c5ac, v138
v_mfma_f32_32x32x16_bf16 v[48:63], a[244:247], v[168:171], v[48:63]
ds_read_b128 a[236:239], v2 offset:37888
buffer_load_dwordx4 v[216:219], v128, s[24:27], s38 offen offset:1024 sc1
v_rsq_f32 v134, v138
s_nop 0
v_mul_f32 v135, 0xbfb8aa3b, v134
s_waitcnt vmcnt(11) lgkmcnt(4)
v_mfma_f32_32x32x16_bf16 v[32:47], a[248:251], v[172:175], v[32:47]
ds_read_b128 a[240:243], v2 offset:10240
buffer_load_dwordx4 v[220:223], v128, s[24:27], s38 offen offset:1536 sc1
ds_read_b128 v[96:99], v132 offset:768
ds_read_b128 v[100:103], v132 offset:800
v_mfma_f32_32x32x16_bf16 v[48:63], a[252:255], v[172:175], v[48:63]
ds_read_b128 a[244:247], v2 offset:38912
buffer_load_dwordx4 v[224:227], v128, s[24:27], s38 offen offset:2048 sc1
ds_read_b128 v[104:107], v132 offset:832
ds_read_b128 v[108:111], v132 offset:864
s_waitcnt vmcnt(12) lgkmcnt(8)
v_mfma_f32_32x32x16_bf16 v[32:47], a[224:227], v[176:179], v[32:47]
ds_read_b128 a[248:251], v2 offset:11264
buffer_load_dwordx4 v[228:231], v128, s[24:27], s38 offen offset:2560 sc1
v_mfma_f32_32x32x16_bf16 v[48:63], a[228:231], v[176:179], v[48:63]
ds_read_b128 a[252:255], v2 offset:39936
buffer_load_dwordx4 v[232:235], v128, s[24:27], s38 offen offset:3072 sc1
s_waitcnt vmcnt(13) lgkmcnt(8)
v_mfma_f32_32x32x16_bf16 v[32:47], a[232:235], v[180:183], v[32:47]
ds_read_b128 a[224:227], v2 offset:12288
buffer_load_dwordx4 v[236:239], v128, s[24:27], s38 offen offset:3584 sc1
v_mfma_f32_32x32x16_bf16 v[48:63], a[236:239], v[180:183], v[48:63]
ds_read_b128 a[228:231], v2 offset:40960
s_waitcnt vmcnt(13) lgkmcnt(6)
v_mfma_f32_32x32x16_bf16 v[32:47], a[240:243], v[184:187], v[32:47]
ds_read_b128 a[232:235], v2 offset:13312
buffer_load_dwordx4 v[240:243], v128, s[24:27], s39 offen offset:0 sc1
v_mfma_f32_32x32x16_bf16 v[48:63], a[244:247], v[184:187], v[48:63]
ds_read_b128 a[236:239], v2 offset:41984
s_waitcnt vmcnt(13) lgkmcnt(4)
v_mfma_f32_32x32x16_bf16 v[32:47], a[248:251], v[188:191], v[32:47]
ds_read_b128 a[240:243], v2 offset:14336
buffer_load_dwordx4 v[244:247], v128, s[24:27], s39 offen offset:512 sc1
v_mfma_f32_32x32x16_bf16 v[48:63], a[252:255], v[188:191], v[48:63]
ds_read_b128 a[244:247], v2 offset:43008
s_waitcnt vmcnt(13) lgkmcnt(4)
v_mfma_f32_32x32x16_bf16 v[32:47], a[224:227], v[192:195], v[32:47]
ds_read_b128 a[248:251], v2 offset:15360
buffer_load_dwordx4 v[248:251], v128, s[24:27], s39 offen offset:1024 sc1
s_add_u32 m0, s4, 86016
s_add_u32 s11, s10, 86016
buffer_load_dwordx4 v2, s[24:27], s11 offen offset:0 sc1 lds
v_mfma_f32_32x32x16_bf16 v[48:63], a[228:231], v[192:195], v[48:63]
ds_read_b128 a[252:255], v2 offset:44032
s_waitcnt vmcnt(14) lgkmcnt(4)
v_mfma_f32_32x32x16_bf16 v[32:47], a[232:235], v[196:199], v[32:47]
ds_read_b128 a[224:227], v2 offset:16384
buffer_load_dwordx4 v[252:255], v128, s[24:27], s39 offen offset:1536 sc1
v_mfma_f32_32x32x16_bf16 v[48:63], a[236:239], v[196:199], v[48:63]
ds_read_b128 a[228:231], v2 offset:45056
s_waitcnt vmcnt(14) lgkmcnt(4)
v_mfma_f32_32x32x16_bf16 v[32:47], a[240:243], v[200:203], v[32:47]
ds_read_b128 a[232:235], v2 offset:17408
buffer_load_dwordx4 v2, s[24:27], s11 offen offset:1024 sc1 lds
v_mfma_f32_32x32x16_bf16 v[48:63], a[244:247], v[200:203], v[48:63]
ds_read_b128 a[236:239], v2 offset:46080
s_waitcnt vmcnt(14) lgkmcnt(4)
v_mfma_f32_32x32x16_bf16 v[32:47], a[248:251], v[204:207], v[32:47]
ds_read_b128 a[240:243], v2 offset:18432
v_mfma_f32_32x32x16_bf16 v[48:63], a[252:255], v[204:207], v[48:63]
ds_read_b128 a[244:247], v2 offset:47104
s_waitcnt vmcnt(13) lgkmcnt(4)
v_mfma_f32_32x32x16_bf16 v[32:47], a[224:227], v[208:211], v[32:47]
ds_read_b128 a[248:251], v2 offset:19456
buffer_load_dwordx4 v2, s[24:27], s11 offen offset:2048 sc1 lds
v_mfma_f32_32x32x16_bf16 v[48:63], a[228:231], v[208:211], v[48:63]
ds_read_b128 a[252:255], v2 offset:48128
s_waitcnt vmcnt(13) lgkmcnt(4)
v_mfma_f32_32x32x16_bf16 v[32:47], a[232:235], v[212:215], v[32:47]
ds_read_b128 a[224:227], v2 offset:20480
v_mfma_f32_32x32x16_bf16 v[48:63], a[236:239], v[212:215], v[48:63]
ds_read_b128 a[228:231], v2 offset:49152
s_waitcnt vmcnt(12) lgkmcnt(4)
v_mfma_f32_32x32x16_bf16 v[32:47], a[240:243], v[216:219], v[32:47]
ds_read_b128 a[232:235], v2 offset:21504
buffer_load_dwordx4 v2, s[24:27], s11 offen offset:3072 sc1 lds
v_mfma_f32_32x32x16_bf16 v[48:63], a[244:247], v[216:219], v[48:63]
ds_read_b128 a[236:239], v2 offset:50176
s_waitcnt vmcnt(12) lgkmcnt(4)
v_mfma_f32_32x32x16_bf16 v[32:47], a[248:251], v[220:223], v[32:47]
ds_read_b128 a[240:243], v2 offset:22528
v_mfma_f32_32x32x16_bf16 v[48:63], a[252:255], v[220:223], v[48:63]
ds_read_b128 a[244:247], v2 offset:51200
s_waitcnt vmcnt(11) lgkmcnt(4)
v_mfma_f32_32x32x16_bf16 v[32:47], a[224:227], v[224:227], v[32:47]
ds_read_b128 a[248:251], v2 offset:23552
s_add_u32 m0, s4, 90112
s_add_u32 s11, s10, 90112
buffer_load_dwordx4 v2, s[24:27], s11 offen offset:0 sc1 lds
v_mfma_f32_32x32x16_bf16 v[48:63], a[228:231], v[224:227], v[48:63]
ds_read_b128 a[252:255], v2 offset:52224
s_waitcnt vmcnt(11) lgkmcnt(4)
v_mfma_f32_32x32x16_bf16 v[32:47], a[232:235], v[228:231], v[32:47]
ds_read_b128 a[224:227], v2 offset:24576
v_mfma_f32_32x32x16_bf16 v[48:63], a[236:239], v[228:231], v[48:63]
ds_read_b128 a[228:231], v2 offset:53248
s_waitcnt vmcnt(10) lgkmcnt(4)
v_mfma_f32_32x32x16_bf16 v[32:47], a[240:243], v[232:235], v[32:47]
ds_read_b128 a[232:235], v2 offset:25600
buffer_load_dwordx4 v2, s[24:27], s11 offen offset:1024 sc1 lds
v_mfma_f32_32x32x16_bf16 v[48:63], a[244:247], v[232:235], v[48:63]
ds_read_b128 a[236:239], v2 offset:54272
s_waitcnt vmcnt(10) lgkmcnt(4)
v_mfma_f32_32x32x16_bf16 v[32:47], a[248:251], v[236:239], v[32:47]
ds_read_b128 a[240:243], v2 offset:26624
v_mfma_f32_32x32x16_bf16 v[48:63], a[252:255], v[236:239], v[48:63]
ds_read_b128 a[244:247], v2 offset:55296
s_waitcnt vmcnt(9) lgkmcnt(4)
v_mfma_f32_32x32x16_bf16 v[32:47], a[224:227], v[240:243], v[32:47]
ds_read_b128 a[248:251], v2 offset:27648
buffer_load_dwordx4 v2, s[24:27], s11 offen offset:2048 sc1 lds
v_mfma_f32_32x32x16_bf16 v[48:63], a[228:231], v[240:243], v[48:63]
ds_read_b128 a[252:255], v2 offset:56320
s_waitcnt vmcnt(9) lgkmcnt(4)
v_mfma_f32_32x32x16_bf16 v[32:47], a[232:235], v[244:247], v[32:47]
ds_read_b128 a[224:227], v2 offset:57344
v_mfma_f32_32x32x16_bf16 v[48:63], a[236:239], v[244:247], v[48:63]
ds_read_b128 a[228:231], v2 offset:58368
s_waitcnt vmcnt(8) lgkmcnt(4)
v_mfma_f32_32x32x16_bf16 v[32:47], a[240:243], v[248:251], v[32:47]
ds_read_b128 a[232:235], v2 offset:59392
s_add_u32 m0, s4, 114688
s_add_u32 s11, s10, 57344
buffer_load_dwordx4 v2, s[24:27], s11 offen offset:0 sc1 lds
v_mfma_f32_32x32x16_bf16 v[48:63], a[244:247], v[248:251], v[48:63]
ds_read_b128 a[236:239], v2 offset:60416
s_waitcnt vmcnt(7) lgkmcnt(4)
v_mfma_f32_32x32x16_bf16 v[32:47], a[248:251], v[252:255], v[32:47]
ds_read_b128 a[240:243], v2 offset:61440
v_mfma_f32_32x32x16_bf16 v[48:63], a[252:255], v[252:255], v[48:63]
ds_read_b128 a[244:247], v2 offset:62464
buffer_load_dwordx4 v2, s[24:27], s11 offen offset:1024 sc1 lds
buffer_load_dwordx4 v2, s[24:27], s11 offen offset:2048 sc1 lds
buffer_load_dwordx4 v2, s[24:27], s11 offen offset:3072 sc1 lds
s_waitcnt vmcnt(4)
s_barrier
s_waitcnt lgkmcnt(3)
v_mfma_f32_32x32x16_bf16 v[64:79], a[224:227], v[144:147], 0
ds_read_b128 a[248:251], v2 offset:63488
s_getpc_b64 s[92:93]
Lc67:
s_sub_u32 s92, s92, Lc67-Lpc
s_subb_u32 s93, s93, 0
s_and_b32 s13, s44, 1
s_lshl_b32 s13, s13, 4
s_add_u32 s13, s13, s45
s_mul_i32 s13, s13, CODE_NL
v_min_u32 v30, CODE_NL-1, v1
v_add_u32 v30, s13, v30
v_lshlrev_b32_e64 v30, 7, v30
v_min_u32 v30, Lcode_end-Lpc-4, v30
global_load_dword v16, v30, s[92:93]
v_mfma_f32_32x32x16_bf16 v[64:79], a[228:231], v[148:151], v[64:79]
ds_read_b128 a[252:255], v2 offset:64512
v_fma_f32 v32, v96, v133, v32
v_fma_f32 v33, v97, v133, v33
v_fma_f32 v34, v98, v133, v34
v_mfma_f32_32x32x16_bf16 v[64:79], a[232:235], v[152:155], v[64:79]
ds_read_b128 a[224:227], v3 offset:0
v_fma_f32 v35, v99, v133, v35
v_fma_f32 v36, v100, v133, v36
v_fma_f32 v37, v101, v133, v37
v_fma_f32 v38, v102, v133, v38
s_waitcnt lgkmcnt(3)
v_mfma_f32_32x32x16_bf16 v[64:79], a[236:239], v[156:159], v[64:79]
ds_read_b128 a[228:231], v3 offset:1024
v_fma_f32 v39, v103, v133, v39
v_fma_f32 v40, v104, v133, v40
v_fma_f32 v41, v105, v133, v41
v_mfma_f32_32x32x16_bf16 v[64:79], a[240:243], v[160:163], v[64:79]
ds_read_b128 a[232:235], v3 offset:2048
s_add_u32 m0, s4, 118784
s_add_u32 s11, s10, 61440
buffer_load_dwordx4 v2, s[24:27], s11 offen offset:0 sc1 lds
v_fma_f32 v42, v106, v133, v42
v_mfma_f32_32x32x16_bf16 v[64:79], a[244:247], v[164:167], v[64:79]
ds_read_b128 a[236:239], v3 offset:3072
v_fma_f32 v43, v107, v133, v43
v_fma_f32 v44, v108, v133, v44
v_fma_f32 v45, v109, v133, v45
v_fma_f32 v46, v110, v133, v46
s_waitcnt lgkmcnt(3)
v_mfma_f32_32x32x16_bf16 v[64:79], a[248:251], v[168:171], v[64:79]
ds_read_b128 a[240:243], v3 offset:4096
v_fma_f32 v47, v111, v133, v47
ds_read_b128 v[96:99], v132 offset:640
ds_read_b128 v[100:103], v132 offset:672
v_mfma_f32_32x32x16_bf16 v[64:79], a[252:255], v[172:175], v[64:79]
ds_read_b128 a[244:247], v3 offset:5120
ds_read_b128 v[104:107], v132 offset:704
ds_read_b128 v[108:111], v132 offset:736
v_mul_f32 v112, v135, v32
v_mul_f32 v113, v135, v33
v_mfma_f32_32x32x16_bf16 v[64:79], a[224:227], v[176:179], v[64:79]
ds_read_b128 a[248:251], v3 offset:6144
buffer_load_dwordx4 v2, s[24:27], s11 offen offset:1024 sc1 lds
v_mul_f32 v114, v135, v34
v_mul_f32 v115, v135, v35
v_mul_f32 v116, v135, v36
s_waitcnt lgkmcnt(7)
v_mfma_f32_32x32x16_bf16 v[64:79], a[228:231], v[180:183], v[64:79]
ds_read_b128 a[252:255], v3 offset:7168
v_mul_f32 v117, v135, v37
v_mul_f32 v118, v135, v38
v_mul_f32_e64 v119, v135, v39
v_mfma_f32_32x32x16_bf16 v[64:79], a[232:235], v[184:187], v[64:79]
ds_read_b128 a[224:227], v3 offset:8192
v_exp_f32 v112, v112
v_exp_f32 v113, v113
v_mfma_f32_32x32x16_bf16 v[64:79], a[236:239], v[188:191], v[64:79]
ds_read_b128 a[228:231], v3 offset:9216
v_exp_f32_e64 v114, v114
v_exp_f32 v115, v115
s_waitcnt lgkmcnt(3)
v_mfma_f32_32x32x16_bf16 v[64:79], a[240:243], v[192:195], v[64:79]
ds_read_b128 a[232:235], v3 offset:10240
buffer_load_dwordx4 v2, s[24:27], s11 offen offset:2048 sc1 lds
v_exp_f32_e64 v116, v116
v_mfma_f32_32x32x16_bf16 v[64:79], a[244:247], v[196:199], v[64:79]
ds_read_b128 a[236:239], v3 offset:11264
v_exp_f32 v117, v117
v_exp_f32 v118, v118
v_mfma_f32_32x32x16_bf16 v[64:79], a[248:251], v[200:203], v[64:79]
ds_read_b128 a[240:243], v3 offset:12288
v_exp_f32 v119, v119
v_mul_f32 v32, v32, v40
v_mul_f32 v33, v33, v41
s_waitcnt lgkmcnt(3)
v_mfma_f32_32x32x16_bf16 v[64:79], a[252:255], v[204:207], v[64:79]
ds_read_b128 a[244:247], v3 offset:13312
v_mul_f32 v34, v34, v42
v_mul_f32 v35, v35, v43
v_mul_f32 v36, v36, v44
v_mfma_f32_32x32x16_bf16 v[64:79], a[224:227], v[208:211], v[64:79]
ds_read_b128 a[248:251], v3 offset:14336
s_add_u32 m0, s4, 0
s_add_u32 s11, s10, 28672
buffer_load_dwordx4 v2, s[24:27], s11 offen offset:0 sc1 lds
v_mul_f32_e64 v37, v37, v45
v_mfma_f32_32x32x16_bf16 v[64:79], a[228:231], v[212:215], v[64:79]
ds_read_b128 a[252:255], v3 offset:15360
v_mul_f32 v38, v38, v46
v_mul_f32 v39, v39, v47
v_add_f32_e64 v112, 1.0, v112
v_add_f32 v113, 1.0, v113
s_waitcnt lgkmcnt(3)
v_mfma_f32_32x32x16_bf16 v[64:79], a[232:235], v[216:219], v[64:79]
ds_read_b128 a[224:227], v3 offset:16384
v_add_f32 v114, 1.0, v114
v_add_f32 v115, 1.0, v115
v_add_f32_e64 v116, 1.0, v116
v_mfma_f32_32x32x16_bf16 v[64:79], a[236:239], v[220:223], v[64:79]
ds_read_b128 a[228:231], v3 offset:17408
v_add_f32 v117, 1.0, v117
v_add_f32 v118, 1.0, v118
v_add_f32_e64 v119, 1.0, v119
v_mfma_f32_32x32x16_bf16 v[64:79], a[240:243], v[224:227], v[64:79]
ds_read_b128 a[232:235], v3 offset:18432
buffer_load_dwordx4 v2, s[24:27], s11 offen offset:1024 sc1 lds
v_rcp_f32 v112, v112
s_waitcnt lgkmcnt(3)
v_mfma_f32_32x32x16_bf16 v[64:79], a[244:247], v[228:231], v[64:79]
ds_read_b128 a[236:239], v3 offset:19456
v_rcp_f32_e64 v113, v113
v_mfma_f32_32x32x16_bf16 v[64:79], a[248:251], v[232:235], v[64:79]
ds_read_b128 a[240:243], v3 offset:20480
v_rcp_f32 v114, v114
v_rcp_f32 v115, v115
v_mfma_f32_32x32x16_bf16 v[64:79], a[252:255], v[236:239], v[64:79]
ds_read_b128 a[244:247], v3 offset:21504
v_rcp_f32_e64 v116, v116
v_rcp_f32 v117, v117
s_waitcnt lgkmcnt(3)
v_mfma_f32_32x32x16_bf16 v[64:79], a[224:227], v[240:243], v[64:79]
ds_read_b128 a[248:251], v3 offset:22528
buffer_load_dwordx4 v2, s[24:27], s11 offen offset:2048 sc1 lds
v_rcp_f32_e64 v118, v118
v_mfma_f32_32x32x16_bf16 v[64:79], a[228:231], v[244:247], v[64:79]
ds_read_b128 a[252:255], v3 offset:23552
v_rcp_f32 v119, v119
v_mul_f32 v32, v32, v112
v_mul_f32_e64 v33, v33, v113
v_mfma_f32_32x32x16_bf16 v[64:79], a[232:235], v[248:251], v[64:79]
ds_read_b128 a[224:227], v3 offset:24576
v_mul_f32 v34, v34, v114
v_mul_f32 v35, v35, v115
v_mul_f32_e64 v36, v36, v116
v_mul_f32 v37, v37, v117
s_waitcnt lgkmcnt(3)
v_mfma_f32_32x32x16_bf16 v[64:79], a[236:239], v[252:255], v[64:79]
ds_read_b128 a[228:231], v3 offset:25600
v_mul_f32 v38, v38, v118
v_mul_f32 v39, v39, v119
v_cvt_pk_bf16_f32 v120, v32, v33
v_mfma_f32_32x32x16_bf16 v[80:95], a[240:243], v[144:147], 0
ds_read_b128 a[232:235], v3 offset:26624
buffer_load_dwordx4 v2, s[24:27], s11 offen offset:3072 sc1 lds
v_mfma_f32_32x32x16_bf16 v[80:95], a[244:247], v[148:151], v[80:95]
ds_read_b128 a[236:239], v3 offset:27648
v_cvt_pk_bf16_f32 v121, v34, v35
v_cvt_pk_bf16_f32 v122, v36, v37
v_cvt_pk_bf16_f32 v123, v38, v39
buffer_store_dwordx4 v[120:123], v131, s[24:27], s96 offen offset:3072 sc1
s_waitcnt lgkmcnt(3)
v_mfma_f32_32x32x16_bf16 v[80:95], a[248:251], v[152:155], v[80:95]
ds_read_b128 a[240:243], v3 offset:28672
v_fma_f32 v48, v96, v133, v48
v_fma_f32 v49, v97, v133, v49
v_mfma_f32_32x32x16_bf16 v[80:95], a[252:255], v[156:159], v[80:95]
ds_read_b128 a[244:247], v3 offset:29696
v_fma_f32 v50, v98, v133, v50
v_fma_f32 v51, v99, v133, v51
v_fma_f32 v52, v100, v133, v52
v_fma_f32 v53, v101, v133, v53
v_mfma_f32_32x32x16_bf16 v[80:95], a[224:227], v[160:163], v[80:95]
ds_read_b128 a[248:251], v3 offset:30720
s_add_u32 m0, s4, 4096
s_add_u32 s11, s10, 32768
buffer_load_dwordx4 v2, s[24:27], s11 offen offset:0 sc1 lds
v_fma_f32 v54, v102, v133, v54
s_waitcnt lgkmcnt(3)
v_mfma_f32_32x32x16_bf16 v[80:95], a[228:231], v[164:167], v[80:95]
ds_read_b128 a[252:255], v3 offset:31744
v_fma_f32 v55, v103, v133, v55
v_fma_f32 v56, v104, v133, v56
v_fma_f32 v57, v105, v133, v57
v_mfma_f32_32x32x16_bf16 v[80:95], a[232:235], v[168:171], v[80:95]
ds_read_b128 a[224:227], v3 offset:32768
v_fma_f32 v58, v106, v133, v58
v_fma_f32 v59, v107, v133, v59
v_fma_f32 v60, v108, v133, v60
v_fma_f32 v61, v109, v133, v61
v_mfma_f32_32x32x16_bf16 v[80:95], a[236:239], v[172:175], v[80:95]
ds_read_b128 a[228:231], v3 offset:33792
v_fma_f32 v62, v110, v133, v62
v_fma_f32 v63, v111, v133, v63
ds_read_b128 v[96:99], v132 offset:512
ds_read_b128 v[100:103], v132 offset:544
s_waitcnt lgkmcnt(5)
v_mfma_f32_32x32x16_bf16 v[80:95], a[240:243], v[176:179], v[80:95]
ds_read_b128 a[232:235], v3 offset:34816
buffer_load_dwordx4 v2, s[24:27], s11 offen offset:1024 sc1 lds
ds_read_b128 v[104:107], v132 offset:576
ds_read_b128 v[108:111], v132 offset:608
v_mfma_f32_32x32x16_bf16 v[80:95], a[244:247], v[180:183], v[80:95]
ds_read_b128 a[236:239], v3 offset:35840
v_mul_f32 v112, v135, v48
v_mul_f32 v113, v135, v49
v_mul_f32 v114, v135, v50
v_mul_f32_e64 v115, v135, v51
v_mfma_f32_32x32x16_bf16 v[80:95], a[248:251], v[184:187], v[80:95]
ds_read_b128 a[240:243], v3 offset:36864
v_mul_f32 v116, v135, v52
v_mul_f32 v117, v135, v53
v_mul_f32_e64 v118, v135, v54
v_mul_f32 v119, v135, v55
s_waitcnt lgkmcnt(7)
v_mfma_f32_32x32x16_bf16 v[80:95], a[252:255], v[188:191], v[80:95]
ds_read_b128 a[244:247], v3 offset:37888
v_exp_f32_e64 v112, v112
v_mfma_f32_32x32x16_bf16 v[80:95], a[224:227], v[192:195], v[80:95]
ds_read_b128 a[248:251], v3 offset:38912
buffer_load_dwordx4 v2, s[24:27], s11 offen offset:2048 sc1 lds
v_exp_f32_e64 v113, v113
v_mfma_f32_32x32x16_bf16 v[80:95], a[228:231], v[196:199], v[80:95]
ds_read_b128 a[252:255], v3 offset:39936
v_exp_f32_e64 v114, v114
v_exp_f32 v115, v115
s_waitcnt lgkmcnt(3)
v_mfma_f32_32x32x16_bf16 v[80:95], a[232:235], v[200:203], v[80:95]
ds_read_b128 a[224:227], v3 offset:40960
v_exp_f32_e64 v116, v116
v_mfma_f32_32x32x16_bf16 v[80:95], a[236:239], v[204:207], v[80:95]
ds_read_b128 a[228:231], v3 offset:41984
v_exp_f32 v117, v117
v_exp_f32 v118, v118
v_mfma_f32_32x32x16_bf16 v[80:95], a[240:243], v[208:211], v[80:95]
ds_read_b128 a[232:235], v3 offset:43008
s_add_u32 m0, s4, 28672
s_add_u32 s11, s10, 0
buffer_load_dwordx4 v2, s[24:27], s11 offen offset:0 sc1 lds
s_waitcnt lgkmcnt(3)
v_mfma_f32_32x32x16_bf16 v[80:95], a[244:247], v[212:215], v[80:95]
ds_read_b128 a[236:239], v3 offset:44032
v_exp_f32 v119, v119
v_mul_f32 v48, v48, v56
v_mfma_f32_32x32x16_bf16 v[80:95], a[248:251], v[216:219], v[80:95]
ds_read_b128 a[240:243], v3 offset:45056
v_mul_f32 v49, v49, v57
v_mul_f32 v50, v50, v58
v_mul_f32 v51, v51, v59
v_mul_f32 v52, v52, v60
v_mfma_f32_32x32x16_bf16 v[80:95], a[252:255], v[220:223], v[80:95]
ds_read_b128 a[244:247], v3 offset:46080
v_mul_f32 v53, v53, v61
v_mul_f32 v54, v54, v62
v_mul_f32_e64 v55, v55, v63
v_add_f32 v112, 1.0, v112
s_waitcnt lgkmcnt(3)
v_mfma_f32_32x32x16_bf16 v[80:95], a[224:227], v[224:227], v[80:95]
ds_read_b128 a[248:251], v3 offset:47104
buffer_load_dwordx4 v2, s[24:27], s11 offen offset:1024 sc1 lds
v_add_f32 v113, 1.0, v113
v_add_f32 v114, 1.0, v114
v_mfma_f32_32x32x16_bf16 v[80:95], a[228:231], v[228:231], v[80:95]
ds_read_b128 a[252:255], v3 offset:48128
v_add_f32 v115, 1.0, v115
v_add_f32 v116, 1.0, v116
v_add_f32 v117, 1.0, v117
v_add_f32 v118, 1.0, v118
buffer_load_dwordx4 v2, s[24:27], s11 offen offset:2048 sc1 lds
buffer_load_dwordx4 v2, s[24:27], s11 offen offset:3072 sc1 lds
s_waitcnt vmcnt(12)
s_barrier
v_mfma_f32_32x32x16_bf16 v[80:95], a[232:235], v[232:235], v[80:95]
ds_read_b128 a[224:227], v3 offset:49152
s_add_u32 m0, s4, 32768
s_add_u32 s11, s10, 4096
buffer_load_dwordx4 v2, s[24:27], s11 offen offset:0 sc1 lds
v_add_f32 v119, 1.0, v119
s_waitcnt lgkmcnt(3)
v_mfma_f32_32x32x16_bf16 v[80:95], a[236:239], v[236:239], v[80:95]
ds_read_b128 a[228:231], v3 offset:50176
v_rcp_f32_e64 v112, v112
v_mfma_f32_32x32x16_bf16 v[80:95], a[240:243], v[240:243], v[80:95]
ds_read_b128 a[232:235], v3 offset:51200
v_rcp_f32 v113, v113
v_rcp_f32 v114, v114
v_mfma_f32_32x32x16_bf16 v[80:95], a[244:247], v[244:247], v[80:95]
ds_read_b128 a[236:239], v3 offset:52224
v_rcp_f32_e64 v115, v115
v_rcp_f32 v116, v116
s_waitcnt lgkmcnt(3)
v_mfma_f32_32x32x16_bf16 v[80:95], a[248:251], v[248:251], v[80:95]
ds_read_b128 a[240:243], v3 offset:53248
buffer_load_dwordx4 v2, s[24:27], s11 offen offset:1024 sc1 lds
v_rcp_f32_e64 v117, v117
v_mfma_f32_32x32x16_bf16 v[80:95], a[252:255], v[252:255], v[80:95]
ds_read_b128 a[244:247], v3 offset:54272
v_rcp_f32 v118, v118
v_rcp_f32 v119, v119
v_mfma_f32_32x32x16_bf16 v[32:47], a[224:227], v[144:147], 0
ds_read_b128 a[248:251], v3 offset:55296
buffer_load_dwordx4 v2, s[24:27], s11 offen offset:2048 sc1 lds
s_waitcnt lgkmcnt(3)
v_mfma_f32_32x32x16_bf16 v[32:47], a[228:231], v[148:151], v[32:47]
ds_read_b128 a[252:255], v3 offset:56320
v_mul_f32 v48, v48, v112
v_mul_f32 v49, v49, v113
v_mul_f32 v50, v50, v114
v_mfma_f32_32x32x16_bf16 v[32:47], a[232:235], v[152:155], v[32:47]
ds_read_b128 a[224:227], v3 offset:57344
v_mul_f32 v51, v51, v115
v_mul_f32 v52, v52, v116
v_mul_f32 v53, v53, v117
v_mul_f32 v54, v54, v118
v_mfma_f32_32x32x16_bf16 v[32:47], a[236:239], v[156:159], v[32:47]
ds_read_b128 a[228:231], v3 offset:58368
v_mul_f32_e64 v55, v55, v119
v_cvt_pk_bf16_f32 v124, v48, v49
v_cvt_pk_bf16_f32 v125, v50, v51
v_cvt_pk_bf16_f32 v126, v52, v53
s_waitcnt lgkmcnt(3)
v_mfma_f32_32x32x16_bf16 v[32:47], a[240:243], v[160:163], v[32:47]
ds_read_b128 a[232:235], v3 offset:59392
v_cvt_pk_bf16_f32 v127, v54, v55
buffer_store_dwordx4 v[124:127], v131, s[24:27], s96 offen offset:2560 sc1
v_mfma_f32_32x32x16_bf16 v[32:47], a[244:247], v[164:167], v[32:47]
ds_read_b128 a[236:239], v3 offset:60416
v_fma_f32 v64, v96, v133, v64
v_fma_f32 v65, v97, v133, v65
v_fma_f32 v66, v98, v133, v66
v_fma_f32 v67, v99, v133, v67
v_mfma_f32_32x32x16_bf16 v[32:47], a[248:251], v[168:171], v[32:47]
ds_read_b128 a[240:243], v3 offset:61440
v_fma_f32 v68, v100, v133, v68
v_fma_f32 v69, v101, v133, v69
v_fma_f32 v70, v102, v133, v70
v_fma_f32 v71, v103, v133, v71
s_waitcnt lgkmcnt(3)
v_mfma_f32_32x32x16_bf16 v[32:47], a[252:255], v[172:175], v[32:47]
ds_read_b128 a[244:247], v3 offset:62464
v_fma_f32 v72, v104, v133, v72
v_fma_f32 v73, v105, v133, v73
v_fma_f32 v74, v106, v133, v74
v_mfma_f32_32x32x16_bf16 v[32:47], a[224:227], v[176:179], v[32:47]
ds_read_b128 a[248:251], v3 offset:63488
v_fma_f32 v75, v107, v133, v75
v_fma_f32 v76, v108, v133, v76
v_fma_f32 v77, v109, v133, v77
v_fma_f32 v78, v110, v133, v78
v_mfma_f32_32x32x16_bf16 v[32:47], a[228:231], v[180:183], v[32:47]
ds_read_b128 a[252:255], v3 offset:64512
v_fma_f32 v79, v111, v133, v79
ds_read_b128 v[96:99], v132 offset:384
ds_read_b128 v[100:103], v132 offset:416
ds_read_b128 v[104:107], v132 offset:448
s_waitcnt lgkmcnt(6)
v_mfma_f32_32x32x16_bf16 v[32:47], a[232:235], v[184:187], v[32:47]
ds_read_b128 a[224:227], v4 offset:0
ds_read_b128 v[108:111], v132 offset:480
v_mul_f32 v112, v135, v64
v_mul_f32_e64 v113, v135, v65
v_mfma_f32_32x32x16_bf16 v[32:47], a[236:239], v[188:191], v[32:47]
ds_read_b128 a[228:231], v4 offset:1024
v_mul_f32 v114, v135, v66
v_mul_f32 v115, v135, v67
v_mul_f32 v116, v135, v68
v_mul_f32 v117, v135, v69
v_mfma_f32_32x32x16_bf16 v[32:47], a[240:243], v[192:195], v[32:47]
ds_read_b128 a[232:235], v4 offset:2048
v_mul_f32 v118, v135, v70
v_mul_f32 v119, v135, v71
v_exp_f32 v112, v112
s_waitcnt lgkmcnt(7)
v_mfma_f32_32x32x16_bf16 v[32:47], a[244:247], v[196:199], v[32:47]
ds_read_b128 a[236:239], v4 offset:3072
v_exp_f32_e64 v113, v113
v_mfma_f32_32x32x16_bf16 v[32:47], a[248:251], v[200:203], v[32:47]
ds_read_b128 a[240:243], v4 offset:4096
v_exp_f32 v114, v114
v_exp_f32 v115, v115
v_mfma_f32_32x32x16_bf16 v[32:47], a[252:255], v[204:207], v[32:47]
ds_read_b128 a[244:247], v4 offset:5120
v_exp_f32_e64 v116, v116
v_exp_f32 v117, v117
s_waitcnt lgkmcnt(3)
v_mfma_f32_32x32x16_bf16 v[32:47], a[224:227], v[208:211], v[32:47]
ds_read_b128 a[248:251], v4 offset:6144
v_exp_f32_e64 v118, v118
v_mfma_f32_32x32x16_bf16 v[32:47], a[228:231], v[212:215], v[32:47]
ds_read_b128 a[252:255], v4 offset:7168
v_exp_f32 v119, v119
v_mul_f32 v64, v64, v72
v_mul_f32_e64 v65, v65, v73
v_mfma_f32_32x32x16_bf16 v[32:47], a[232:235], v[216:219], v[32:47]
ds_read_b128 a[224:227], v4 offset:8192
v_mul_f32 v66, v66, v74
v_mul_f32 v67, v67, v75
v_mul_f32_e64 v68, v68, v76
v_mul_f32 v69, v69, v77
s_waitcnt lgkmcnt(3)
v_mfma_f32_32x32x16_bf16 v[32:47], a[236:239], v[220:223], v[32:47]
ds_read_b128 a[228:231], v4 offset:9216
v_mul_f32 v70, v70, v78
v_mul_f32 v71, v71, v79
v_add_f32_e64 v112, 1.0, v112
v_mfma_f32_32x32x16_bf16 v[32:47], a[240:243], v[224:227], v[32:47]
ds_read_b128 a[232:235], v4 offset:10240
v_add_f32 v113, 1.0, v113
v_add_f32 v114, 1.0, v114
v_add_f32 v115, 1.0, v115
v_add_f32 v116, 1.0, v116
v_mfma_f32_32x32x16_bf16 v[32:47], a[244:247], v[228:231], v[32:47]
ds_read_b128 a[236:239], v4 offset:11264
v_add_f32 v117, 1.0, v117
v_add_f32 v118, 1.0, v118
v_add_f32 v119, 1.0, v119
s_waitcnt vmcnt(1)
s_barrier
s_waitcnt lgkmcnt(3)
v_mfma_f32_32x32x16_bf16 v[32:47], a[248:251], v[232:235], v[32:47]
ds_read_b128 a[240:243], v2 offset:0
v_rcp_f32_e64 v112, v112
v_mfma_f32_32x32x16_bf16 v[32:47], a[252:255], v[236:239], v[32:47]
ds_read_b128 a[244:247], v2 offset:1024
v_rcp_f32 v113, v113
v_rcp_f32 v114, v114
v_mfma_f32_32x32x16_bf16 v[32:47], a[224:227], v[240:243], v[32:47]
ds_read_b128 a[248:251], v2 offset:2048
v_rcp_f32_e64 v115, v115
v_rcp_f32 v116, v116
s_waitcnt lgkmcnt(3)
v_mfma_f32_32x32x16_bf16 v[32:47], a[228:231], v[244:247], v[32:47]
ds_read_b128 a[252:255], v2 offset:3072
v_rcp_f32_e64 v117, v117
v_mfma_f32_32x32x16_bf16 v[32:47], a[232:235], v[248:251], v[32:47]
ds_read_b128 a[224:227], v2 offset:4096
v_rcp_f32 v118, v118
v_rcp_f32 v119, v119
v_mfma_f32_32x32x16_bf16 v[32:47], a[236:239], v[252:255], v[32:47]
ds_read_b128 a[228:231], v2 offset:5120
v_mul_f32 v64, v64, v112
v_mul_f32 v65, v65, v113
v_mul_f32_e64 v66, v66, v114
v_mul_f32 v67, v67, v115
s_waitcnt lgkmcnt(3)
v_mfma_f32_32x32x16_bf16 v[48:63], a[240:243], v[144:147], 0
ds_read_b128 a[232:235], v2 offset:6144
v_mfma_f32_32x32x16_bf16 v[48:63], a[244:247], v[148:151], v[48:63]
ds_read_b128 a[236:239], v2 offset:7168
v_mul_f32 v68, v68, v116
v_mul_f32 v69, v69, v117
v_mul_f32 v70, v70, v118
v_mul_f32 v71, v71, v119
v_mfma_f32_32x32x16_bf16 v[48:63], a[248:251], v[152:155], v[48:63]
ds_read_b128 a[240:243], v2 offset:8192
v_cvt_pk_bf16_f32 v120, v64, v65
v_cvt_pk_bf16_f32 v121, v66, v67
v_cvt_pk_bf16_f32 v122, v68, v69
v_cvt_pk_bf16_f32 v123, v70, v71
s_waitcnt lgkmcnt(3)
v_mfma_f32_32x32x16_bf16 v[48:63], a[252:255], v[156:159], v[48:63]
ds_read_b128 a[244:247], v2 offset:9216
buffer_store_dwordx4 v[120:123], v131, s[24:27], s96 offen offset:2048 sc1
v_fma_f32 v80, v96, v133, v80
v_mfma_f32_32x32x16_bf16 v[48:63], a[224:227], v[160:163], v[48:63]
ds_read_b128 a[248:251], v2 offset:10240
v_fma_f32 v81, v97, v133, v81
v_fma_f32 v82, v98, v133, v82
v_fma_f32 v83, v99, v133, v83
v_fma_f32 v84, v100, v133, v84
v_mfma_f32_32x32x16_bf16 v[48:63], a[228:231], v[164:167], v[48:63]
ds_read_b128 a[252:255], v2 offset:11264
v_fma_f32 v85, v101, v133, v85
v_fma_f32 v86, v102, v133, v86
v_fma_f32 v87, v103, v133, v87
v_fma_f32 v88, v104, v133, v88
s_waitcnt lgkmcnt(3)
v_mfma_f32_32x32x16_bf16 v[48:63], a[232:235], v[168:171], v[48:63]
ds_read_b128 a[224:227], v2 offset:12288
v_fma_f32 v89, v105, v133, v89
v_fma_f32 v90, v106, v133, v90
v_fma_f32 v91, v107, v133, v91
v_mfma_f32_32x32x16_bf16 v[48:63], a[236:239], v[172:175], v[48:63]
ds_read_b128 a[228:231], v2 offset:13312
v_fma_f32 v92, v108, v133, v92
v_fma_f32 v93, v109, v133, v93
v_fma_f32 v94, v110, v133, v94
v_fma_f32 v95, v111, v133, v95
v_mfma_f32_32x32x16_bf16 v[48:63], a[240:243], v[176:179], v[48:63]
ds_read_b128 a[232:235], v2 offset:14336
ds_read_b128 v[96:99], v132 offset:256
ds_read_b128 v[100:103], v132 offset:288
ds_read_b128 v[104:107], v132 offset:320
ds_read_b128 v[108:111], v132 offset:352
s_waitcnt lgkmcnt(7)
v_mfma_f32_32x32x16_bf16 v[48:63], a[244:247], v[180:183], v[48:63]
ds_read_b128 a[236:239], v2 offset:15360
v_mul_f32 v112, v135, v80
v_mul_f32 v113, v135, v81
v_mul_f32 v114, v135, v82
v_mfma_f32_32x32x16_bf16 v[48:63], a[248:251], v[184:187], v[48:63]
ds_read_b128 a[240:243], v2 offset:16384
v_mul_f32 v115, v135, v83
v_mul_f32 v116, v135, v84
v_mul_f32 v117, v135, v85
v_mul_f32 v118, v135, v86
v_mfma_f32_32x32x16_bf16 v[48:63], a[252:255], v[188:191], v[48:63]
ds_read_b128 a[244:247], v2 offset:17408
v_mul_f32_e64 v119, v135, v87
v_exp_f32 v112, v112
s_waitcnt lgkmcnt(7)
v_mfma_f32_32x32x16_bf16 v[48:63], a[224:227], v[192:195], v[48:63]
ds_read_b128 a[248:251], v2 offset:18432
v_exp_f32_e64 v113, v113
v_mfma_f32_32x32x16_bf16 v[48:63], a[228:231], v[196:199], v[48:63]
ds_read_b128 a[252:255], v2 offset:19456
v_exp_f32 v114, v114
v_exp_f32 v115, v115
v_mfma_f32_32x32x16_bf16 v[48:63], a[232:235], v[200:203], v[48:63]
ds_read_b128 a[224:227], v2 offset:20480
v_exp_f32_e64 v116, v116
v_exp_f32 v117, v117
s_waitcnt lgkmcnt(3)
v_mfma_f32_32x32x16_bf16 v[48:63], a[236:239], v[204:207], v[48:63]
ds_read_b128 a[228:231], v2 offset:21504
v_exp_f32_e64 v118, v118
v_mfma_f32_32x32x16_bf16 v[48:63], a[240:243], v[208:211], v[48:63]
ds_read_b128 a[232:235], v2 offset:22528
v_exp_f32 v119, v119
v_mul_f32 v80, v80, v88
v_mul_f32_e64 v81, v81, v89
v_mfma_f32_32x32x16_bf16 v[48:63], a[244:247], v[212:215], v[48:63]
ds_read_b128 a[236:239], v2 offset:23552
v_mul_f32 v82, v82, v90
v_mul_f32 v83, v83, v91
v_mul_f32_e64 v84, v84, v92
v_mul_f32 v85, v85, v93
s_waitcnt lgkmcnt(3)
v_mfma_f32_32x32x16_bf16 v[48:63], a[248:251], v[216:219], v[48:63]
ds_read_b128 a[240:243], v2 offset:24576
v_mul_f32 v86, v86, v94
v_mul_f32 v87, v87, v95
v_add_f32_e64 v112, 1.0, v112
v_mfma_f32_32x32x16_bf16 v[48:63], a[252:255], v[220:223], v[48:63]
ds_read_b128 a[244:247], v2 offset:25600
v_add_f32 v113, 1.0, v113
v_add_f32 v114, 1.0, v114
v_add_f32 v115, 1.0, v115
v_add_f32 v116, 1.0, v116
v_mfma_f32_32x32x16_bf16 v[48:63], a[224:227], v[224:227], v[48:63]
ds_read_b128 a[248:251], v2 offset:26624
v_add_f32 v117, 1.0, v117
v_add_f32 v118, 1.0, v118
v_add_f32 v119, 1.0, v119
s_waitcnt lgkmcnt(3)
v_mfma_f32_32x32x16_bf16 v[48:63], a[228:231], v[228:231], v[48:63]
ds_read_b128 a[252:255], v2 offset:27648
v_rcp_f32_e64 v112, v112
v_mfma_f32_32x32x16_bf16 v[48:63], a[232:235], v[232:235], v[48:63]
ds_read_b128 a[224:227], v2 offset:28672
v_rcp_f32 v113, v113
v_rcp_f32 v114, v114
v_mfma_f32_32x32x16_bf16 v[48:63], a[236:239], v[236:239], v[48:63]
ds_read_b128 a[228:231], v2 offset:29696
v_rcp_f32_e64 v115, v115
v_rcp_f32 v116, v116
s_waitcnt lgkmcnt(3)
v_mfma_f32_32x32x16_bf16 v[48:63], a[240:243], v[240:243], v[48:63]
ds_read_b128 a[232:235], v2 offset:30720
v_rcp_f32_e64 v117, v117
v_mfma_f32_32x32x16_bf16 v[48:63], a[244:247], v[244:247], v[48:63]
ds_read_b128 a[236:239], v2 offset:31744
v_rcp_f32 v118, v118
v_rcp_f32 v119, v119
v_mfma_f32_32x32x16_bf16 v[48:63], a[248:251], v[248:251], v[48:63]
ds_read_b128 a[240:243], v2 offset:32768
v_mul_f32 v80, v80, v112
v_mul_f32 v81, v81, v113
v_mul_f32_e64 v82, v82, v114
v_mul_f32 v83, v83, v115
s_waitcnt lgkmcnt(3)
v_mfma_f32_32x32x16_bf16 v[48:63], a[252:255], v[252:255], v[48:63]
ds_read_b128 a[244:247], v2 offset:33792
v_mul_f32 v84, v84, v116
v_mul_f32 v85, v85, v117
v_mul_f32_e64 v86, v86, v118
v_mfma_f32_32x32x16_bf16 v[64:79], a[224:227], v[144:147], 0
ds_read_b128 a[248:251], v2 offset:34816
v_mfma_f32_32x32x16_bf16 v[64:79], a[228:231], v[148:151], v[64:79]
ds_read_b128 a[252:255], v2 offset:35840
v_mul_f32_e64 v87, v87, v119
v_cvt_pk_bf16_f32 v124, v80, v81
v_cvt_pk_bf16_f32 v125, v82, v83
v_cvt_pk_bf16_f32 v126, v84, v85
s_waitcnt lgkmcnt(3)
v_mfma_f32_32x32x16_bf16 v[64:79], a[232:235], v[152:155], v[64:79]
ds_read_b128 a[224:227], v2 offset:36864
v_cvt_pk_bf16_f32 v127, v86, v87
buffer_store_dwordx4 v[124:127], v131, s[24:27], s96 offen offset:1536 sc1
v_mfma_f32_32x32x16_bf16 v[64:79], a[236:239], v[156:159], v[64:79]
ds_read_b128 a[228:231], v2 offset:37888
v_fma_f32 v32, v96, v133, v32
v_fma_f32 v33, v97, v133, v33
v_fma_f32 v34, v98, v133, v34
v_fma_f32 v35, v99, v133, v35
v_mfma_f32_32x32x16_bf16 v[64:79], a[240:243], v[160:163], v[64:79]
ds_read_b128 a[232:235], v2 offset:38912
v_fma_f32 v36, v100, v133, v36
v_fma_f32 v37, v101, v133, v37
v_fma_f32 v38, v102, v133, v38
v_fma_f32 v39, v103, v133, v39
s_waitcnt lgkmcnt(3)
v_mfma_f32_32x32x16_bf16 v[64:79], a[244:247], v[164:167], v[64:79]
ds_read_b128 a[236:239], v2 offset:39936
v_fma_f32 v40, v104, v133, v40
v_fma_f32 v41, v105, v133, v41
v_fma_f32 v42, v106, v133, v42
v_mfma_f32_32x32x16_bf16 v[64:79], a[248:251], v[168:171], v[64:79]
ds_read_b128 a[240:243], v2 offset:40960
v_fma_f32 v43, v107, v133, v43
v_fma_f32 v44, v108, v133, v44
v_fma_f32 v45, v109, v133, v45
v_fma_f32 v46, v110, v133, v46
v_mfma_f32_32x32x16_bf16 v[64:79], a[252:255], v[172:175], v[64:79]
ds_read_b128 a[244:247], v2 offset:41984
v_fma_f32 v47, v111, v133, v47
ds_read_b128 v[96:99], v132 offset:128
ds_read_b128 v[100:103], v132 offset:160
ds_read_b128 v[104:107], v132 offset:192
s_waitcnt lgkmcnt(6)
v_mfma_f32_32x32x16_bf16 v[64:79], a[224:227], v[176:179], v[64:79]
ds_read_b128 a[248:251], v2 offset:43008
ds_read_b128 v[108:111], v132 offset:224
v_mul_f32 v112, v135, v32
v_mul_f32_e64 v113, v135, v33
v_mfma_f32_32x32x16_bf16 v[64:79], a[228:231], v[180:183], v[64:79]
ds_read_b128 a[252:255], v2 offset:44032
v_mul_f32 v114, v135, v34
v_mul_f32 v115, v135, v35
v_mul_f32 v116, v135, v36
v_mul_f32 v117, v135, v37
v_mfma_f32_32x32x16_bf16 v[64:79], a[232:235], v[184:187], v[64:79]
ds_read_b128 a[224:227], v2 offset:45056
v_mul_f32 v118, v135, v38
v_mul_f32 v119, v135, v39
v_exp_f32 v112, v112
s_waitcnt lgkmcnt(7)
v_mfma_f32_32x32x16_bf16 v[64:79], a[236:239], v[188:191], v[64:79]
ds_read_b128 a[228:231], v2 offset:46080
v_exp_f32_e64 v113, v113
v_mfma_f32_32x32x16_bf16 v[64:79], a[240:243], v[192:195], v[64:79]
ds_read_b128 a[232:235], v2 offset:47104
v_exp_f32 v114, v114
v_exp_f32 v115, v115
v_mfma_f32_32x32x16_bf16 v[64:79], a[244:247], v[196:199], v[64:79]
ds_read_b128 a[236:239], v2 offset:48128
v_exp_f32_e64 v116, v116
v_exp_f32 v117, v117
s_waitcnt lgkmcnt(3)
v_mfma_f32_32x32x16_bf16 v[64:79], a[248:251], v[200:203], v[64:79]
ds_read_b128 a[240:243], v2 offset:49152
v_exp_f32_e64 v118, v118
v_mfma_f32_32x32x16_bf16 v[64:79], a[252:255], v[204:207], v[64:79]
ds_read_b128 a[244:247], v2 offset:50176
v_exp_f32 v119, v119
v_mul_f32 v32, v32, v40
v_mul_f32_e64 v33, v33, v41
v_mfma_f32_32x32x16_bf16 v[64:79], a[224:227], v[208:211], v[64:79]
ds_read_b128 a[248:251], v2 offset:51200
v_mul_f32 v34, v34, v42
v_mul_f32 v35, v35, v43
v_mul_f32_e64 v36, v36, v44
v_mul_f32 v37, v37, v45
s_waitcnt lgkmcnt(3)
v_mfma_f32_32x32x16_bf16 v[64:79], a[228:231], v[212:215], v[64:79]
ds_read_b128 a[252:255], v2 offset:52224
v_mul_f32 v38, v38, v46
v_mul_f32 v39, v39, v47
v_add_f32_e64 v112, 1.0, v112
v_mfma_f32_32x32x16_bf16 v[64:79], a[232:235], v[216:219], v[64:79]
ds_read_b128 a[224:227], v2 offset:53248
v_add_f32 v113, 1.0, v113
v_add_f32 v114, 1.0, v114
v_add_f32 v115, 1.0, v115
v_add_f32 v116, 1.0, v116
v_mfma_f32_32x32x16_bf16 v[64:79], a[236:239], v[220:223], v[64:79]
ds_read_b128 a[228:231], v2 offset:54272
v_add_f32 v117, 1.0, v117
v_add_f32 v118, 1.0, v118
v_add_f32 v119, 1.0, v119
s_waitcnt lgkmcnt(3)
v_mfma_f32_32x32x16_bf16 v[64:79], a[240:243], v[224:227], v[64:79]
ds_read_b128 a[232:235], v2 offset:55296
v_rcp_f32_e64 v112, v112
v_mfma_f32_32x32x16_bf16 v[64:79], a[244:247], v[228:231], v[64:79]
ds_read_b128 a[236:239], v2 offset:56320
v_rcp_f32 v113, v113
v_rcp_f32 v114, v114
v_mfma_f32_32x32x16_bf16 v[64:79], a[248:251], v[232:235], v[64:79]
v_rcp_f32_e64 v115, v115
v_rcp_f32 v116, v116
s_waitcnt lgkmcnt(2)
v_mfma_f32_32x32x16_bf16 v[64:79], a[252:255], v[236:239], v[64:79]
v_rcp_f32 v117, v117
v_rcp_f32 v118, v118
v_mfma_f32_32x32x16_bf16 v[64:79], a[224:227], v[240:243], v[64:79]
v_rcp_f32 v119, v119
v_mul_f32 v32, v32, v112
v_mul_f32 v33, v33, v113
v_mul_f32 v34, v34, v114
v_mfma_f32_32x32x16_bf16 v[64:79], a[228:231], v[244:247], v[64:79]
v_mul_f32 v35, v35, v115
v_mul_f32 v36, v36, v116
v_mul_f32 v37, v37, v117
v_mul_f32 v38, v38, v118
v_mul_f32 v39, v39, v119
s_waitcnt lgkmcnt(0)
v_mfma_f32_32x32x16_bf16 v[64:79], a[232:235], v[248:251], v[64:79]
v_cvt_pk_bf16_f32 v120, v32, v33
v_cvt_pk_bf16_f32 v121, v34, v35
v_cvt_pk_bf16_f32 v122, v36, v37
v_cvt_pk_bf16_f32 v123, v38, v39
v_mfma_f32_32x32x16_bf16 v[64:79], a[236:239], v[252:255], v[64:79]
buffer_store_dwordx4 v[120:123], v131, s[24:27], s96 offen offset:1024 sc1
v_pk_fma_f32 v[48:49], v[96:97], v[132:133], v[48:49] op_sel:[0,1,0] op_sel_hi:[1,1,1]
v_pk_fma_f32 v[50:51], v[98:99], v[132:133], v[50:51] op_sel:[0,1,0] op_sel_hi:[1,1,1]
v_pk_fma_f32 v[52:53], v[100:101], v[132:133], v[52:53] op_sel:[0,1,0] op_sel_hi:[1,1,1]
v_pk_fma_f32 v[54:55], v[102:103], v[132:133], v[54:55] op_sel:[0,1,0] op_sel_hi:[1,1,1]
v_pk_fma_f32 v[56:57], v[104:105], v[132:133], v[56:57] op_sel:[0,1,0] op_sel_hi:[1,1,1]
v_pk_fma_f32 v[58:59], v[106:107], v[132:133], v[58:59] op_sel:[0,1,0] op_sel_hi:[1,1,1]
v_pk_fma_f32 v[60:61], v[108:109], v[132:133], v[60:61] op_sel:[0,1,0] op_sel_hi:[1,1,1]
v_pk_fma_f32 v[62:63], v[110:111], v[132:133], v[62:63] op_sel:[0,1,0] op_sel_hi:[1,1,1]
ds_read_b128 v[96:99], v132 offset:0
ds_read_b128 v[100:103], v132 offset:32
ds_read_b128 v[104:107], v132 offset:64
ds_read_b128 v[108:111], v132 offset:96
v_pk_mul_f32 v[112:113], v[48:49], v[134:135] op_sel:[0,1] op_sel_hi:[1,1]
v_pk_mul_f32 v[114:115], v[50:51], v[134:135] op_sel:[0,1] op_sel_hi:[1,1]
v_pk_mul_f32 v[116:117], v[52:53], v[134:135] op_sel:[0,1] op_sel_hi:[1,1]
v_pk_mul_f32 v[118:119], v[54:55], v[134:135] op_sel:[0,1] op_sel_hi:[1,1]
v_exp_f32 v112, v112
v_exp_f32 v113, v113
v_exp_f32 v114, v114
v_exp_f32 v115, v115
v_exp_f32 v116, v116
v_exp_f32 v117, v117
v_exp_f32 v118, v118
v_exp_f32 v119, v119
v_pk_mul_f32 v[48:49], v[48:49], v[56:57]
v_pk_mul_f32 v[50:51], v[50:51], v[58:59]
v_pk_mul_f32 v[52:53], v[52:53], v[60:61]
v_pk_mul_f32 v[54:55], v[54:55], v[62:63]
v_pk_add_f32 v[112:113], v[112:113], 1.0 op_sel_hi:[1,0]
v_pk_add_f32 v[114:115], v[114:115], 1.0 op_sel_hi:[1,0]
v_pk_add_f32 v[116:117], v[116:117], 1.0 op_sel_hi:[1,0]
v_pk_add_f32 v[118:119], v[118:119], 1.0 op_sel_hi:[1,0]
v_rcp_f32 v112, v112
v_rcp_f32 v113, v113
v_rcp_f32 v114, v114
v_rcp_f32 v115, v115
v_rcp_f32 v116, v116
v_rcp_f32 v117, v117
v_rcp_f32_e64 v118, v118
v_rcp_f32 v119, v119
v_pk_mul_f32 v[48:49], v[48:49], v[112:113]
v_pk_mul_f32 v[50:51], v[50:51], v[114:115]
v_pk_mul_f32 v[52:53], v[52:53], v[116:117]
v_pk_mul_f32 v[54:55], v[54:55], v[118:119]
v_cvt_pk_bf16_f32 v124, v48, v49
v_cvt_pk_bf16_f32 v125, v50, v51
v_cvt_pk_bf16_f32 v126, v52, v53
v_cvt_pk_bf16_f32 v127, v54, v55
buffer_store_dwordx4 v[124:127], v131, s[24:27], s96 offen offset:512
s_waitcnt lgkmcnt(0)
v_pk_fma_f32 v[64:65], v[96:97], v[132:133], v[64:65] op_sel:[0,1,0] op_sel_hi:[1,1,1]
v_pk_fma_f32 v[66:67], v[98:99], v[132:133], v[66:67] op_sel:[0,1,0] op_sel_hi:[1,1,1]
v_pk_fma_f32 v[68:69], v[100:101], v[132:133], v[68:69] op_sel:[0,1,0] op_sel_hi:[1,1,1]
v_pk_fma_f32 v[70:71], v[102:103], v[132:133], v[70:71] op_sel:[0,1,0] op_sel_hi:[1,1,1]
v_pk_fma_f32 v[72:73], v[104:105], v[132:133], v[72:73] op_sel:[0,1,0] op_sel_hi:[1,1,1]
v_pk_fma_f32 v[74:75], v[106:107], v[132:133], v[74:75] op_sel:[0,1,0] op_sel_hi:[1,1,1]
v_pk_fma_f32 v[76:77], v[108:109], v[132:133], v[76:77] op_sel:[0,1,0] op_sel_hi:[1,1,1]
v_pk_fma_f32 v[78:79], v[110:111], v[132:133], v[78:79] op_sel:[0,1,0] op_sel_hi:[1,1,1]
v_pk_mul_f32 v[112:113], v[64:65], v[134:135] op_sel:[0,1] op_sel_hi:[1,1]
v_pk_mul_f32 v[114:115], v[66:67], v[134:135] op_sel:[0,1] op_sel_hi:[1,1]
v_pk_mul_f32 v[116:117], v[68:69], v[134:135] op_sel:[0,1] op_sel_hi:[1,1]
v_pk_mul_f32 v[118:119], v[70:71], v[134:135] op_sel:[0,1] op_sel_hi:[1,1]
v_exp_f32 v112, v112
v_exp_f32 v113, v113
v_exp_f32 v114, v114
v_exp_f32 v115, v115
v_exp_f32 v116, v116
v_exp_f32 v117, v117
v_exp_f32 v118, v118
v_exp_f32 v119, v119
v_pk_mul_f32 v[64:65], v[64:65], v[72:73]
v_pk_mul_f32 v[66:67], v[66:67], v[74:75]
v_pk_mul_f32 v[68:69], v[68:69], v[76:77]
v_pk_mul_f32 v[70:71], v[70:71], v[78:79]
v_pk_add_f32 v[112:113], v[112:113], 1.0 op_sel_hi:[1,0]
v_pk_add_f32 v[114:115], v[114:115], 1.0 op_sel_hi:[1,0]
v_pk_add_f32 v[116:117], v[116:117], 1.0 op_sel_hi:[1,0]
v_pk_add_f32 v[118:119], v[118:119], 1.0 op_sel_hi:[1,0]
v_rcp_f32 v112, v112
v_rcp_f32 v113, v113
v_rcp_f32 v114, v114
v_rcp_f32 v115, v115
v_rcp_f32 v116, v116
v_rcp_f32 v117, v117
v_rcp_f32 v118, v118
v_rcp_f32 v119, v119
v_pk_mul_f32 v[64:65], v[64:65], v[112:113]
v_pk_mul_f32 v[66:67], v[66:67], v[114:115]
v_pk_mul_f32 v[68:69], v[68:69], v[116:117]
v_pk_mul_f32 v[70:71], v[70:71], v[118:119]
v_cvt_pk_bf16_f32 v120, v64, v65
v_cvt_pk_bf16_f32 v121, v66, v67
v_cvt_pk_bf16_f32 v122, v68, v69
v_cvt_pk_bf16_f32 v123, v70, v71
buffer_store_dwordx4 v[120:123], v131, s[24:27], s96 offen offset:0
s_lshl_b32 s22, s44, 11
s_add_u32 s22, s22, 262144
s_lshl_b32 s23, s45, 7
s_add_u32 s23, s23, s22
v_lshrrev_b32 v17, 2, v1
v_min_u32 v17, 15, v17
v_and_b32 v18, 3, v1
v_lshlrev_b32_e64 v18, 2, v18
v_lshl_add_u32 v17, v17, 7, v18
s_lshl2_add_u32 s94, s46, s23
s_add_u32 s94, s94, s63
v_mov_b32 v18, s49
v_cmp_eq_u32 vcc, 3, v7
v_bfrev_b32 v28, 1
s_nop 0
v_cndmask_b32 v28, v25, v28, vcc
s_lshl2_add_u32 s54, s48, s46
s_lshl_b32 s54, s54, 7
s_add_u32 s54, s54, s60
s_add_u32 s54, s54, 8503296
buffer_load_dwordx2 v[120:121], v25, s[24:27], s54 offen sc1
buffer_load_dwordx2 v[122:123], v28, s[24:27], s54 offen offset:1024 sc1
s_mul_i32 s59, s46, 14336
s_add_u32 s59, s59, s61
s_add_u32 s59, s59, 20971520
s_add_u32 s36, s46, 1
s_and_b32 s36, s36, 3
s_mul_i32 s58, s36, 12288
s_add_u32 s58, s58, 110592
v_add_u32 v112, s58, v2
s_lshl2_add_u32 s36, s48, s36
s_mul_i32 s36, s36, 57344
s_add_u32 s36, s36, s59
s_add_u32 s37, s46, 2
s_and_b32 s37, s37, 3
s_mul_i32 s58, s37, 12288
s_add_u32 s58, s58, 114688
v_add_u32_e64 v113, s58, v2
s_lshl2_add_u32 s37, s48, s37
s_mul_i32 s37, s37, 57344
s_add_u32 s37, s37, s59
s_add_u32 s38, s46, 3
s_and_b32 s38, s38, 3
s_mul_i32 s58, s38, 12288
s_add_u32 s58, s58, 118784
v_add_u32 v114, s58, v2
s_lshl2_add_u32 s38, s48, s38
s_mul_i32 s38, s38, 57344
s_add_u32 s38, s38, s59
s_add_u32 s39, s46, 4
s_and_b32 s39, s39, 3
s_lshl2_add_u32 s39, s48, s39
s_mul_i32 s39, s39, 57344
s_add_u32 s39, s39, s59
s_lshl_b32 s54, s44, 7
s_lshl_b32 s55, s48, 6
s_add_u32 s54, s54, s55
s_lshl_b32 s55, s46, 4
s_add_u32 s54, s54, s55
v_add_u32_e64 v115, s54, v6
v_mul_u32_u24 v115, 896, v115
v_lshl_add_u32 v115, v7, 4, v115
s_lshl_b32 s40, s47, 7
s_cmp_lg_u32 s52, 0
s_waitcnt vmcnt(2)
s_mov_b64 exec, 1
buffer_store_dword v18, off, s[24:27], s94
s_mov_b64 exec, -1
s_barrier
s_cbranch_scc1 L69
buffer_load_dword v16, v17, s[24:27], s22 offen sc1
s_nop 7
buffer_load_dword v30, v17, s[24:27], s22 offen sc1
s_nop 7
buffer_load_dword v31, v17, s[24:27], s22 offen sc1
Lp71:
s_waitcnt vmcnt(2)
v_cmp_ne_u32 vcc, s49, v16
s_cbranch_vccz L68
buffer_load_dword v16, v17, s[24:27], s22 offen sc1
s_waitcnt vmcnt(2)
v_cmp_ne_u32 vcc, s49, v30
s_cbranch_vccz L68
buffer_load_dword v30, v17, s[24:27], s22 offen sc1
s_waitcnt vmcnt(2)
v_cmp_ne_u32 vcc, s49, v31
s_cbranch_vccz L68
buffer_load_dword v31, v17, s[24:27], s22 offen sc1
s_sub_u32 s62, s62, 1
s_cbranch_scc0 Lp71
s_mov_b32 s62, 0
Ld72:
s_branch L68
L69:
s_cmp_lg_u32 s52, 1
s_cbranch_scc1 L70
buffer_wbl2 sc1
s_waitcnt vmcnt(0)
v_lshlrev_b32 v30, 2, v1
s_mov_b64 exec, 15
buffer_store_dword v18, v30, s[24:27], s23 offen sc1
s_mov_b64 exec, -1
Lp73:
buffer_load_dword v16, v17, s[24:27], s22 offen sc1
s_waitcnt vmcnt(0)
v_cmp_ne_u32 vcc, s49, v16
s_cbranch_vccz Ld74
s_sub_u32 s62, s62, 1
s_cbranch_scc0 Lp73
s_mov_b32 s62, 0
Ld74:
buffer_inv sc1
s_waitcnt vmcnt(0)
s_branch L68
L70:
s_cmp_lg_u32 s46, 3
s_cbranch_scc1 L76
s_cmp_lg_u32 s45, 0
s_cbranch_scc1 L75
s_lshl_b32 s92, s44, 7
v_mov_b32_e64 v18, s49
s_mov_b64 exec, 1
buffer_store_dword v18, off, s[24:27], s92 sc1
s_mov_b64 exec, -1
L75:
s_cmp_lg_u32 s44, 0
s_cbranch_scc1 L76
s_cmp_ge_u32 s45, 7
s_cbranch_scc1 L76
s_lshl_b32 s92, s45, 7
s_add_u32 s92, s92, 4096
v_mov_b32 v18, s51
s_mov_b64 exec, 1
buffer_store_dword v18, off, s[24:27], s92 sc1
s_mov_b64 exec, -1
L76:
L68:
s_barrier
s_cmp_lg_u32 s53, 0
s_cbranch_scc1 Lfin
buffer_load_dwordx4 v[128:131], v2, s[24:27], s36 offen offset:0 sc1
buffer_load_dwordx4 v[132:135], v2, s[24:27], s36 offen offset:1024 sc1
buffer_load_dwordx4 v[136:139], v2, s[24:27], s36 offen offset:2048 sc1
buffer_load_dwordx4 v[140:143], v2, s[24:27], s36 offen offset:3072 sc1
s_add_u32 s36, s36, 4096
buffer_load_dwordx4 v[144:147], v2, s[24:27], s36 offen offset:0 sc1
buffer_load_dwordx4 v[148:151], v2, s[24:27], s36 offen offset:1024 sc1
buffer_load_dwordx4 v[152:155], v2, s[24:27], s36 offen offset:2048 sc1
buffer_load_dwordx4 v[156:159], v2, s[24:27], s36 offen offset:3072 sc1
s_waitcnt vmcnt(7)
v_mfma_f32_16x16x32_bf16 v[32:35], a[0:3], v[128:131], 0
s_add_u32 s36, s36, 4096
buffer_load_dwordx4 v[160:163], v2, s[24:27], s36 offen offset:0 sc1
v_mfma_f32_16x16x32_bf16 v[36:39], a[4:7], v[128:131], 0
v_mfma_f32_16x16x32_bf16 v[40:43], a[8:11], v[128:131], 0
buffer_load_dwordx4 v[164:167], v2, s[24:27], s36 offen offset:1024 sc1
v_mfma_f32_16x16x32_bf16 v[44:47], a[12:15], v[128:131], 0
s_waitcnt vmcnt(8)
v_mfma_f32_16x16x32_bf16 v[32:35], a[16:19], v[132:135], v[32:35]
buffer_load_dwordx4 v[168:171], v2, s[24:27], s36 offen offset:2048 sc1
v_mfma_f32_16x16x32_bf16 v[36:39], a[20:23], v[132:135], v[36:39]
v_add_f32_e64 v120, v120, v122
v_mfma_f32_16x16x32_bf16 v[40:43], a[24:27], v[132:135], v[40:43]
buffer_load_dwordx4 v[172:175], v2, s[24:27], s36 offen offset:3072 sc1
v_add_f32_e64 v121, v121, v123
v_mfma_f32_16x16x32_bf16 v[44:47], a[28:31], v[132:135], v[44:47]
v_mov_b32_e64 v122, v120
v_mov_b32 v123, v121
s_waitcnt vmcnt(9)
v_mfma_f32_16x16x32_bf16 v[32:35], a[32:35], v[136:139], v[32:35]
s_add_u32 s36, s36, 4096
buffer_load_dwordx4 v[176:179], v2, s[24:27], s36 offen offset:0 sc1
v_mfma_f32_16x16x32_bf16 v[36:39], a[36:39], v[136:139], v[36:39]
v_permlane16_swap_b32_e64 v120, v122
v_mfma_f32_16x16x32_bf16 v[40:43], a[40:43], v[136:139], v[40:43]
buffer_load_dwordx4 v[180:183], v2, s[24:27], s36 offen offset:1024 sc1
v_mfma_f32_16x16x32_bf16 v[44:47], a[44:47], v[136:139], v[44:47]
v_permlane16_swap_b32 v121, v123
s_waitcnt vmcnt(10)
v_mfma_f32_16x16x32_bf16 v[32:35], a[48:51], v[140:143], v[32:35]
buffer_load_dwordx4 v[184:187], v2, s[24:27], s37 offen offset:0 sc1
v_mfma_f32_16x16x32_bf16 v[36:39], a[52:55], v[140:143], v[36:39]
v_add_f32 v120, v120, v122
v_add_f32 v121, v121, v123
v_mfma_f32_16x16x32_bf16 v[40:43], a[56:59], v[140:143], v[40:43]
buffer_load_dwordx4 v[188:191], v2, s[24:27], s37 offen offset:1024 sc1
v_mov_b32_e64 v122, v120
v_mfma_f32_16x16x32_bf16 v[44:47], a[60:63], v[140:143], v[44:47]
v_mov_b32 v123, v121
s_waitcnt vmcnt(11)
v_mfma_f32_16x16x32_bf16 v[32:35], a[64:67], v[144:147], v[32:35]
buffer_load_dwordx4 v[192:195], v2, s[24:27], s37 offen offset:2048 sc1
v_mfma_f32_16x16x32_bf16 v[36:39], a[68:71], v[144:147], v[36:39]
v_permlane32_swap_b32_e64 v120, v122
v_mfma_f32_16x16x32_bf16 v[40:43], a[72:75], v[144:147], v[40:43]
v_permlane32_swap_b32_e64 v121, v123
v_mfma_f32_16x16x32_bf16 v[44:47], a[76:79], v[144:147], v[44:47]
v_add_f32_e64 v120, v120, v122
v_add_f32 v121, v121, v123
s_waitcnt vmcnt(11)
v_mfma_f32_16x16x32_bf16 v[32:35], a[80:83], v[148:151], v[32:35]
buffer_load_dwordx4 v[196:199], v2, s[24:27], s37 offen offset:3072 sc1
v_mfma_f32_16x16x32_bf16 v[36:39], a[84:87], v[148:151], v[36:39]
v_mul_f32 v122, 0xbb124925, v120
v_mul_f32_e64 v123, v122, v122
v_mfma_f32_16x16x32_bf16 v[40:43], a[88:91], v[148:151], v[40:43]
v_fma_f32 v123, v121, s100, -v123
v_max_f32 v123, 0, v123
v_mfma_f32_16x16x32_bf16 v[44:47], a[92:95], v[148:151], v[44:47]
v_add_f32 v123, 0x3727c5ac, v123
s_waitcnt vmcnt(11)
v_mfma_f32_16x16x32_bf16 v[32:35], a[96:99], v[152:155], v[32:35]
s_add_u32 s37, s37, 4096
buffer_load_dwordx4 v[200:203], v2, s[24:27], s37 offen offset:0 sc1
v_mfma_f32_16x16x32_bf16 v[36:39], a[100:103], v[152:155], v[36:39]
v_rsq_f32_e64 v124, v123
v_mfma_f32_16x16x32_bf16 v[40:43], a[104:107], v[152:155], v[40:43]
v_mul_f32 v124, v124, v124
v_lshlrev_b32 v96, 16, v8
v_mfma_f32_16x16x32_bf16 v[44:47], a[108:111], v[152:155], v[44:47]
v_and_b32 v97, 0xffff0000, v8
v_lshlrev_b32 v98, 16, v9
s_waitcnt vmcnt(11)
v_mfma_f32_16x16x32_bf16 v[32:35], a[112:115], v[156:159], v[32:35]
buffer_load_dwordx4 v[204:207], v2, s[24:27], s37 offen offset:1024 sc1
v_mfma_f32_16x16x32_bf16 v[36:39], a[116:119], v[156:159], v[36:39]
v_and_b32 v99, 0xffff0000, v9
v_lshlrev_b32_e64 v100, 16, v10
v_mfma_f32_16x16x32_bf16 v[40:43], a[120:123], v[156:159], v[40:43]
v_and_b32 v101, 0xffff0000, v10
v_lshlrev_b32_e64 v102, 16, v11
v_mfma_f32_16x16x32_bf16 v[44:47], a[124:127], v[156:159], v[44:47]
v_and_b32 v103, 0xffff0000, v11
v_lshlrev_b32 v104, 16, v12
s_waitcnt vmcnt(11)
v_mfma_f32_16x16x32_bf16 v[32:35], a[128:131], v[160:163], v[32:35]
buffer_load_dwordx4 v[208:211], v2, s[24:27], s37 offen offset:2048 sc1
v_mfma_f32_16x16x32_bf16 v[36:39], a[132:135], v[160:163], v[36:39]
v_and_b32 v105, 0xffff0000, v12
v_lshlrev_b32_e64 v106, 16, v13
v_mfma_f32_16x16x32_bf16 v[40:43], a[136:139], v[160:163], v[40:43]
v_and_b32 v107, 0xffff0000, v13
v_lshlrev_b32_e64 v108, 16, v14
v_mfma_f32_16x16x32_bf16 v[44:47], a[140:143], v[160:163], v[44:47]
v_and_b32 v109, 0xffff0000, v14
v_lshlrev_b32 v110, 16, v15
s_waitcnt vmcnt(11)
v_mfma_f32_16x16x32_bf16 v[32:35], a[144:147], v[164:167], v[32:35]
buffer_load_dwordx4 v[212:215], v2, s[24:27], s37 offen offset:3072 sc1
v_mfma_f32_16x16x32_bf16 v[36:39], a[148:151], v[164:167], v[36:39]
v_and_b32 v111, 0xffff0000, v15
s_mul_i32 s58, s46, 12288
v_mfma_f32_16x16x32_bf16 v[40:43], a[152:155], v[164:167], v[40:43]
s_add_u32 s58, s58, 110592
v_add_u32_e64 v116, s58, v2
v_mfma_f32_16x16x32_bf16 v[44:47], a[156:159], v[164:167], v[44:47]
s_waitcnt vmcnt(11)
v_mfma_f32_16x16x32_bf16 v[32:35], a[160:163], v[168:171], v[32:35]
s_add_u32 s37, s37, 4096
buffer_load_dwordx4 v[216:219], v2, s[24:27], s37 offen offset:0 sc1
v_mfma_f32_16x16x32_bf16 v[36:39], a[164:167], v[168:171], v[36:39]
v_mfma_f32_16x16x32_bf16 v[40:43], a[168:171], v[168:171], v[40:43]
v_mfma_f32_16x16x32_bf16 v[44:47], a[172:175], v[168:171], v[44:47]
s_waitcnt vmcnt(11)
v_mfma_f32_16x16x32_bf16 v[32:35], a[176:179], v[172:175], v[32:35]
buffer_load_dwordx4 v[220:223], v2, s[24:27], s37 offen offset:1024 sc1
v_mfma_f32_16x16x32_bf16 v[36:39], a[180:183], v[172:175], v[36:39]
v_mfma_f32_16x16x32_bf16 v[40:43], a[184:187], v[172:175], v[40:43]
v_mfma_f32_16x16x32_bf16 v[44:47], a[188:191], v[172:175], v[44:47]
s_waitcnt vmcnt(11)
v_mfma_f32_16x16x32_bf16 v[32:35], a[192:195], v[176:179], v[32:35]
buffer_load_dwordx4 v[224:227], v2, s[24:27], s37 offen offset:2048 sc1
v_mfma_f32_16x16x32_bf16 v[36:39], a[196:199], v[176:179], v[36:39]
v_mfma_f32_16x16x32_bf16 v[40:43], a[200:203], v[176:179], v[40:43]
v_mfma_f32_16x16x32_bf16 v[44:47], a[204:207], v[176:179], v[44:47]
s_waitcnt vmcnt(11)
v_mfma_f32_16x16x32_bf16 v[32:35], a[208:211], v[180:183], v[32:35]
buffer_load_dwordx4 v[228:231], v2, s[24:27], s37 offen offset:3072 sc1
v_mfma_f32_16x16x32_bf16 v[36:39], a[212:215], v[180:183], v[36:39]
v_mfma_f32_16x16x32_bf16 v[40:43], a[216:219], v[180:183], v[40:43]
v_mfma_f32_16x16x32_bf16 v[44:47], a[220:223], v[180:183], v[44:47]
s_waitcnt vmcnt(11)
v_mfma_f32_16x16x32_bf16 v[48:51], a[0:3], v[184:187], 0
s_add_u32 s37, s37, 4096
buffer_load_dwordx4 v[232:235], v2, s[24:27], s37 offen offset:0 sc1
v_mfma_f32_16x16x32_bf16 v[52:55], a[4:7], v[184:187], 0
v_mfma_f32_16x16x32_bf16 v[56:59], a[8:11], v[184:187], 0
v_mfma_f32_16x16x32_bf16 v[60:63], a[12:15], v[184:187], 0
s_waitcnt vmcnt(11)
v_mfma_f32_16x16x32_bf16 v[48:51], a[16:19], v[188:191], v[48:51]
buffer_load_dwordx4 v[236:239], v2, s[24:27], s37 offen offset:1024 sc1
v_mfma_f32_16x16x32_bf16 v[52:55], a[20:23], v[188:191], v[52:55]
ds_write_b128 v112, v[32:35] offset:0
ds_write_b128 v112, v[36:39] offset:1024
v_mfma_f32_16x16x32_bf16 v[56:59], a[24:27], v[188:191], v[56:59]
ds_write_b128 v112, v[40:43] offset:2048
ds_write_b128 v112, v[44:47] offset:3072
v_mfma_f32_16x16x32_bf16 v[60:63], a[28:31], v[188:191], v[60:63]
s_waitcnt vmcnt(11)
v_mfma_f32_16x16x32_bf16 v[48:51], a[32:35], v[192:195], v[48:51]
buffer_load_dwordx4 v[240:243], v2, s[24:27], s38 offen offset:0 sc1
v_mfma_f32_16x16x32_bf16 v[52:55], a[36:39], v[192:195], v[52:55]
v_mfma_f32_16x16x32_bf16 v[56:59], a[40:43], v[192:195], v[56:59]
v_mfma_f32_16x16x32_bf16 v[60:63], a[44:47], v[192:195], v[60:63]
s_waitcnt vmcnt(11)
v_mfma_f32_16x16x32_bf16 v[48:51], a[48:51], v[196:199], v[48:51]
buffer_load_dwordx4 v[244:247], v2, s[24:27], s38 offen offset:1024 sc1
v_mfma_f32_16x16x32_bf16 v[52:55], a[52:55], v[196:199], v[52:55]
v_mfma_f32_16x16x32_bf16 v[56:59], a[56:59], v[196:199], v[56:59]
v_mfma_f32_16x16x32_bf16 v[60:63], a[60:63], v[196:199], v[60:63]
s_waitcnt vmcnt(11)
v_mfma_f32_16x16x32_bf16 v[48:51], a[64:67], v[200:203], v[48:51]
buffer_load_dwordx4 v[248:251], v2, s[24:27], s38 offen offset:2048 sc1
v_mfma_f32_16x16x32_bf16 v[52:55], a[68:71], v[200:203], v[52:55]
v_mfma_f32_16x16x32_bf16 v[56:59], a[72:75], v[200:203], v[56:59]
v_mfma_f32_16x16x32_bf16 v[60:63], a[76:79], v[200:203], v[60:63]
s_waitcnt vmcnt(11)
v_mfma_f32_16x16x32_bf16 v[48:51], a[80:83], v[204:207], v[48:51]
buffer_load_dwordx4 v[252:255], v2, s[24:27], s38 offen offset:3072 sc1
v_mfma_f32_16x16x32_bf16 v[52:55], a[84:87], v[204:207], v[52:55]
v_mfma_f32_16x16x32_bf16 v[56:59], a[88:91], v[204:207], v[56:59]
v_mfma_f32_16x16x32_bf16 v[60:63], a[92:95], v[204:207], v[60:63]
s_waitcnt vmcnt(11)
v_mfma_f32_16x16x32_bf16 v[48:51], a[96:99], v[208:211], v[48:51]
s_add_u32 s38, s38, 4096
buffer_load_dwordx4 v[128:131], v2, s[24:27], s38 offen offset:0 sc1
v_mfma_f32_16x16x32_bf16 v[52:55], a[100:103], v[208:211], v[52:55]
v_mfma_f32_16x16x32_bf16 v[56:59], a[104:107], v[208:211], v[56:59]
v_mfma_f32_16x16x32_bf16 v[60:63], a[108:111], v[208:211], v[60:63]
s_waitcnt vmcnt(11)
v_mfma_f32_16x16x32_bf16 v[48:51], a[112:115], v[212:215], v[48:51]
buffer_load_dwordx4 v[132:135], v2, s[24:27], s38 offen offset:1024 sc1
v_mfma_f32_16x16x32_bf16 v[52:55], a[116:119], v[212:215], v[52:55]
v_mfma_f32_16x16x32_bf16 v[56:59], a[120:123], v[212:215], v[56:59]
v_mfma_f32_16x16x32_bf16 v[60:63], a[124:127], v[212:215], v[60:63]
s_waitcnt vmcnt(11)
v_mfma_f32_16x16x32_bf16 v[48:51], a[128:131], v[216:219], v[48:51]
buffer_load_dwordx4 v[136:139], v2, s[24:27], s38 offen offset:2048 sc1
v_mfma_f32_16x16x32_bf16 v[52:55], a[132:135], v[216:219], v[52:55]
v_mfma_f32_16x16x32_bf16 v[56:59], a[136:139], v[216:219], v[56:59]
v_mfma_f32_16x16x32_bf16 v[60:63], a[140:143], v[216:219], v[60:63]
s_waitcnt vmcnt(11)
v_mfma_f32_16x16x32_bf16 v[48:51], a[144:147], v[220:223], v[48:51]
buffer_load_dwordx4 v[140:143], v2, s[24:27], s38 offen offset:3072 sc1
v_mfma_f32_16x16x32_bf16 v[52:55], a[148:151], v[220:223], v[52:55]
v_mfma_f32_16x16x32_bf16 v[56:59], a[152:155], v[220:223], v[56:59]
v_mfma_f32_16x16x32_bf16 v[60:63], a[156:159], v[220:223], v[60:63]
s_waitcnt vmcnt(11)
v_mfma_f32_16x16x32_bf16 v[48:51], a[160:163], v[224:227], v[48:51]
s_add_u32 s38, s38, 4096
buffer_load_dwordx4 v[144:147], v2, s[24:27], s38 offen offset:0 sc1
v_mfma_f32_16x16x32_bf16 v[52:55], a[164:167], v[224:227], v[52:55]
v_mfma_f32_16x16x32_bf16 v[56:59], a[168:171], v[224:227], v[56:59]
v_mfma_f32_16x16x32_bf16 v[60:63], a[172:175], v[224:227], v[60:63]
s_waitcnt vmcnt(11)
v_mfma_f32_16x16x32_bf16 v[48:51], a[176:179], v[228:231], v[48:51]
buffer_load_dwordx4 v[148:151], v2, s[24:27], s38 offen offset:1024 sc1
v_mfma_f32_16x16x32_bf16 v[52:55], a[180:183], v[228:231], v[52:55]
v_mfma_f32_16x16x32_bf16 v[56:59], a[184:187], v[228:231], v[56:59]
v_mfma_f32_16x16x32_bf16 v[60:63], a[188:191], v[228:231], v[60:63]
s_waitcnt vmcnt(11)
v_mfma_f32_16x16x32_bf16 v[48:51], a[192:195], v[232:235], v[48:51]
buffer_load_dwordx4 v[152:155], v2, s[24:27], s38 offen offset:2048 sc1
v_mfma_f32_16x16x32_bf16 v[52:55], a[196:199], v[232:235], v[52:55]
v_mfma_f32_16x16x32_bf16 v[56:59], a[200:203], v[232:235], v[56:59]
v_mfma_f32_16x16x32_bf16 v[60:63], a[204:207], v[232:235], v[60:63]
s_waitcnt vmcnt(11)
v_mfma_f32_16x16x32_bf16 v[48:51], a[208:211], v[236:239], v[48:51]
buffer_load_dwordx4 v[156:159], v2, s[24:27], s38 offen offset:3072 sc1
v_mfma_f32_16x16x32_bf16 v[52:55], a[212:215], v[236:239], v[52:55]
v_mfma_f32_16x16x32_bf16 v[56:59], a[216:219], v[236:239], v[56:59]
v_mfma_f32_16x16x32_bf16 v[60:63], a[220:223], v[236:239], v[60:63]
s_waitcnt vmcnt(11)
v_mfma_f32_16x16x32_bf16 v[32:35], a[0:3], v[240:243], 0
s_add_u32 s38, s38, 4096
buffer_load_dwordx4 v[160:163], v2, s[24:27], s38 offen offset:0 sc1
v_mfma_f32_16x16x32_bf16 v[36:39], a[4:7], v[240:243], 0
v_mfma_f32_16x16x32_bf16 v[40:43], a[8:11], v[240:243], 0
v_mfma_f32_16x16x32_bf16 v[44:47], a[12:15], v[240:243], 0
s_waitcnt vmcnt(11)
v_mfma_f32_16x16x32_bf16 v[32:35], a[16:19], v[244:247], v[32:35]
buffer_load_dwordx4 v[164:167], v2, s[24:27], s38 offen offset:1024 sc1
v_mfma_f32_16x16x32_bf16 v[36:39], a[20:23], v[244:247], v[36:39]
ds_write_b128 v113, v[48:51] offset:0
ds_write_b128 v113, v[52:55] offset:1024
v_mfma_f32_16x16x32_bf16 v[40:43], a[24:27], v[244:247], v[40:43]
ds_write_b128 v113, v[56:59] offset:2048
ds_write_b128 v113, v[60:63] offset:3072
v_mfma_f32_16x16x32_bf16 v[44:47], a[28:31], v[244:247], v[44:47]
s_waitcnt vmcnt(11)
v_mfma_f32_16x16x32_bf16 v[32:35], a[32:35], v[248:251], v[32:35]
buffer_load_dwordx4 v[168:171], v2, s[24:27], s39 offen offset:0 sc1
v_mfma_f32_16x16x32_bf16 v[36:39], a[36:39], v[248:251], v[36:39]
v_mfma_f32_16x16x32_bf16 v[40:43], a[40:43], v[248:251], v[40:43]
v_mfma_f32_16x16x32_bf16 v[44:47], a[44:47], v[248:251], v[44:47]
s_waitcnt vmcnt(11)
v_mfma_f32_16x16x32_bf16 v[32:35], a[48:51], v[252:255], v[32:35]
buffer_load_dwordx4 v[172:175], v2, s[24:27], s39 offen offset:1024 sc1
v_mfma_f32_16x16x32_bf16 v[36:39], a[52:55], v[252:255], v[36:39]
v_mfma_f32_16x16x32_bf16 v[40:43], a[56:59], v[252:255], v[40:43]
v_mfma_f32_16x16x32_bf16 v[44:47], a[60:63], v[252:255], v[44:47]
s_waitcnt vmcnt(11)
v_mfma_f32_16x16x32_bf16 v[32:35], a[64:67], v[128:131], v[32:35]
buffer_load_dwordx4 v[176:179], v2, s[24:27], s39 offen offset:2048 sc1
v_mfma_f32_16x16x32_bf16 v[36:39], a[68:71], v[128:131], v[36:39]
v_mfma_f32_16x16x32_bf16 v[40:43], a[72:75], v[128:131], v[40:43]
v_mfma_f32_16x16x32_bf16 v[44:47], a[76:79], v[128:131], v[44:47]
s_waitcnt vmcnt(11)
v_mfma_f32_16x16x32_bf16 v[32:35], a[80:83], v[132:135], v[32:35]
buffer_load_dwordx4 v[180:183], v2, s[24:27], s39 offen offset:3072 sc1
v_mfma_f32_16x16x32_bf16 v[36:39], a[84:87], v[132:135], v[36:39]
v_mfma_f32_16x16x32_bf16 v[40:43], a[88:91], v[132:135], v[40:43]
v_mfma_f32_16x16x32_bf16 v[44:47], a[92:95], v[132:135], v[44:47]
s_waitcnt vmcnt(11)
v_mfma_f32_16x16x32_bf16 v[32:35], a[96:99], v[136:139], v[32:35]
s_add_u32 s39, s39, 4096
buffer_load_dwordx4 v[184:187], v2, s[24:27], s39 offen offset:0 sc1
v_mfma_f32_16x16x32_bf16 v[36:39], a[100:103], v[136:139], v[36:39]
v_mfma_f32_16x16x32_bf16 v[40:43], a[104:107], v[136:139], v[40:43]
v_mfma_f32_16x16x32_bf16 v[44:47], a[108:111], v[136:139], v[44:47]
s_waitcnt vmcnt(11)
v_mfma_f32_16x16x32_bf16 v[32:35], a[112:115], v[140:143], v[32:35]
buffer_load_dwordx4 v[188:191], v2, s[24:27], s39 offen offset:1024 sc1
v_mfma_f32_16x16x32_bf16 v[36:39], a[116:119], v[140:143], v[36:39]
v_mfma_f32_16x16x32_bf16 v[40:43], a[120:123], v[140:143], v[40:43]
v_mfma_f32_16x16x32_bf16 v[44:47], a[124:127], v[140:143], v[44:47]
s_waitcnt vmcnt(11)
v_mfma_f32_16x16x32_bf16 v[32:35], a[128:131], v[144:147], v[32:35]
buffer_load_dwordx4 v[192:195], v2, s[24:27], s39 offen offset:2048 sc1
v_mfma_f32_16x16x32_bf16 v[36:39], a[132:135], v[144:147], v[36:39]
v_mfma_f32_16x16x32_bf16 v[40:43], a[136:139], v[144:147], v[40:43]
v_mfma_f32_16x16x32_bf16 v[44:47], a[140:143], v[144:147], v[44:47]
s_waitcnt vmcnt(11)
v_mfma_f32_16x16x32_bf16 v[32:35], a[144:147], v[148:151], v[32:35]
buffer_load_dwordx4 v[196:199], v2, s[24:27], s39 offen offset:3072 sc1
v_mfma_f32_16x16x32_bf16 v[36:39], a[148:151], v[148:151], v[36:39]
v_mfma_f32_16x16x32_bf16 v[40:43], a[152:155], v[148:151], v[40:43]
v_mfma_f32_16x16x32_bf16 v[44:47], a[156:159], v[148:151], v[44:47]
s_waitcnt vmcnt(11)
v_mfma_f32_16x16x32_bf16 v[32:35], a[160:163], v[152:155], v[32:35]
s_add_u32 s39, s39, 4096
buffer_load_dwordx4 v[200:203], v2, s[24:27], s39 offen offset:0 sc1
v_mfma_f32_16x16x32_bf16 v[36:39], a[164:167], v[152:155], v[36:39]
v_mfma_f32_16x16x32_bf16 v[40:43], a[168:171], v[152:155], v[40:43]
v_mfma_f32_16x16x32_bf16 v[44:47], a[172:175], v[152:155], v[44:47]
s_waitcnt vmcnt(11)
v_mfma_f32_16x16x32_bf16 v[32:35], a[176:179], v[156:159], v[32:35]
buffer_load_dwordx4 v[204:207], v2, s[24:27], s39 offen offset:1024 sc1
v_mfma_f32_16x16x32_bf16 v[36:39], a[180:183], v[156:159], v[36:39]
v_mfma_f32_16x16x32_bf16 v[40:43], a[184:187], v[156:159], v[40:43]
v_mfma_f32_16x16x32_bf16 v[44:47], a[188:191], v[156:159], v[44:47]
s_waitcnt vmcnt(11)
v_mfma_f32_16x16x32_bf16 v[32:35], a[192:195], v[160:163], v[32:35]
buffer_load_dwordx4 v[208:211], v2, s[24:27], s39 offen offset:2048 sc1
v_mfma_f32_16x16x32_bf16 v[36:39], a[196:199], v[160:163], v[36:39]
v_mfma_f32_16x16x32_bf16 v[40:43], a[200:203], v[160:163], v[40:43]
v_mfma_f32_16x16x32_bf16 v[44:47], a[204:207], v[160:163], v[44:47]
s_waitcnt vmcnt(11)
v_mfma_f32_16x16x32_bf16 v[32:35], a[208:211], v[164:167], v[32:35]
buffer_load_dwordx4 v[212:215], v2, s[24:27], s39 offen offset:3072 sc1
v_mfma_f32_16x16x32_bf16 v[36:39], a[212:215], v[164:167], v[36:39]
v_mfma_f32_16x16x32_bf16 v[40:43], a[216:219], v[164:167], v[40:43]
v_mfma_f32_16x16x32_bf16 v[44:47], a[220:223], v[164:167], v[44:47]
s_waitcnt vmcnt(11)
v_mfma_f32_16x16x32_bf16 v[48:51], a[0:3], v[168:171], 0
s_add_u32 s39, s39, 4096
buffer_load_dwordx4 v[216:219], v2, s[24:27], s39 offen offset:0 sc1
v_mfma_f32_16x16x32_bf16 v[52:55], a[4:7], v[168:171], 0
v_mfma_f32_16x16x32_bf16 v[56:59], a[8:11], v[168:171], 0
v_mfma_f32_16x16x32_bf16 v[60:63], a[12:15], v[168:171], 0
s_waitcnt vmcnt(11)
v_mfma_f32_16x16x32_bf16 v[48:51], a[16:19], v[172:175], v[48:51]
buffer_load_dwordx4 v[220:223], v2, s[24:27], s39 offen offset:1024 sc1
v_mfma_f32_16x16x32_bf16 v[52:55], a[20:23], v[172:175], v[52:55]
ds_write_b128 v114, v[32:35] offset:0
ds_write_b128 v114, v[36:39] offset:1024
v_mfma_f32_16x16x32_bf16 v[56:59], a[24:27], v[172:175], v[56:59]
ds_write_b128 v114, v[40:43] offset:2048
ds_write_b128 v114, v[44:47] offset:3072
v_mfma_f32_16x16x32_bf16 v[60:63], a[28:31], v[172:175], v[60:63]
s_waitcnt vmcnt(11)
v_mfma_f32_16x16x32_bf16 v[48:51], a[32:35], v[176:179], v[48:51]
v_mfma_f32_16x16x32_bf16 v[52:55], a[36:39], v[176:179], v[52:55]
v_mfma_f32_16x16x32_bf16 v[56:59], a[40:43], v[176:179], v[56:59]
v_mfma_f32_16x16x32_bf16 v[60:63], a[44:47], v[176:179], v[60:63]
s_waitcnt vmcnt(10)
v_mfma_f32_16x16x32_bf16 v[48:51], a[48:51], v[180:183], v[48:51]
v_mfma_f32_16x16x32_bf16 v[52:55], a[52:55], v[180:183], v[52:55]
v_mfma_f32_16x16x32_bf16 v[56:59], a[56:59], v[180:183], v[56:59]
v_mfma_f32_16x16x32_bf16 v[60:63], a[60:63], v[180:183], v[60:63]
s_waitcnt vmcnt(9)
v_mfma_f32_16x16x32_bf16 v[48:51], a[64:67], v[184:187], v[48:51]
v_mfma_f32_16x16x32_bf16 v[52:55], a[68:71], v[184:187], v[52:55]
v_mfma_f32_16x16x32_bf16 v[56:59], a[72:75], v[184:187], v[56:59]
v_mfma_f32_16x16x32_bf16 v[60:63], a[76:79], v[184:187], v[60:63]
s_waitcnt lgkmcnt(0)
s_barrier
s_waitcnt vmcnt(8)
v_mfma_f32_16x16x32_bf16 v[48:51], a[80:83], v[188:191], v[48:51]
ds_read_b128 v[64:67], v116 offset:0
v_mfma_f32_16x16x32_bf16 v[52:55], a[84:87], v[188:191], v[52:55]
ds_read_b128 v[68:71], v116 offset:1024
ds_read_b128 v[72:75], v116 offset:2048
v_mfma_f32_16x16x32_bf16 v[56:59], a[88:91], v[188:191], v[56:59]
ds_read_b128 v[76:79], v116 offset:3072
ds_read_b128 v[80:83], v116 offset:4096
v_mfma_f32_16x16x32_bf16 v[60:63], a[92:95], v[188:191], v[60:63]
ds_read_b128 v[84:87], v116 offset:5120
ds_read_b128 v[88:91], v116 offset:6144
s_waitcnt vmcnt(7)
v_mfma_f32_16x16x32_bf16 v[48:51], a[96:99], v[192:195], v[48:51]
ds_read_b128 v[92:95], v116 offset:7168
v_mfma_f32_16x16x32_bf16 v[52:55], a[100:103], v[192:195], v[52:55]
s_waitcnt lgkmcnt(0)
v_add_f32_e64 v64, v64, v80
v_mfma_f32_16x16x32_bf16 v[56:59], a[104:107], v[192:195], v[56:59]
v_add_f32 v65, v65, v81
v_add_f32 v66, v66, v82
v_mfma_f32_16x16x32_bf16 v[60:63], a[108:111], v[192:195], v[60:63]
v_add_f32_e64 v67, v67, v83
v_add_f32 v68, v68, v84
s_waitcnt vmcnt(6)
v_mfma_f32_16x16x32_bf16 v[48:51], a[112:115], v[196:199], v[48:51]
v_add_f32_e64 v69, v69, v85
v_mfma_f32_16x16x32_bf16 v[52:55], a[116:119], v[196:199], v[52:55]
v_add_f32 v70, v70, v86
v_add_f32 v71, v71, v87
v_mfma_f32_16x16x32_bf16 v[56:59], a[120:123], v[196:199], v[56:59]
v_add_f32 v72, v72, v88
v_add_f32 v73, v73, v89
v_mfma_f32_16x16x32_bf16 v[60:63], a[124:127], v[196:199], v[60:63]
v_add_f32_e64 v74, v74, v90
v_add_f32 v75, v75, v91
s_waitcnt vmcnt(5)
v_mfma_f32_16x16x32_bf16 v[48:51], a[128:131], v[200:203], v[48:51]
v_add_f32_e64 v76, v76, v92
v_mfma_f32_16x16x32_bf16 v[52:55], a[132:135], v[200:203], v[52:55]
v_add_f32 v77, v77, v93
v_add_f32 v78, v78, v94
v_mfma_f32_16x16x32_bf16 v[56:59], a[136:139], v[200:203], v[56:59]
v_add_f32 v79, v79, v95
ds_read_b128 v[80:83], v116 offset:8192
v_mfma_f32_16x16x32_bf16 v[60:63], a[140:143], v[200:203], v[60:63]
ds_read_b128 v[84:87], v116 offset:9216
ds_read_b128 v[88:91], v116 offset:10240
s_waitcnt vmcnt(4)
v_mfma_f32_16x16x32_bf16 v[48:51], a[144:147], v[204:207], v[48:51]
ds_read_b128 v[92:95], v116 offset:11264
v_mfma_f32_16x16x32_bf16 v[52:55], a[148:151], v[204:207], v[52:55]
v_fma_f32 v96, v64, v124, v96
v_fma_f32 v97, v65, v124, v97
v_mfma_f32_16x16x32_bf16 v[56:59], a[152:155], v[204:207], v[56:59]
v_fma_f32 v98, v66, v124, v98
v_fma_f32 v99, v67, v124, v99
v_mfma_f32_16x16x32_bf16 v[60:63], a[156:159], v[204:207], v[60:63]
v_fma_f32 v100, v68, v124, v100
v_fma_f32 v101, v69, v124, v101
s_waitcnt vmcnt(3)
v_mfma_f32_16x16x32_bf16 v[48:51], a[160:163], v[208:211], v[48:51]
v_fma_f32 v102, v70, v124, v102
v_mfma_f32_16x16x32_bf16 v[52:55], a[164:167], v[208:211], v[52:55]
v_fma_f32 v103, v71, v124, v103
v_fma_f32 v104, v72, v124, v104
v_mfma_f32_16x16x32_bf16 v[56:59], a[168:171], v[208:211], v[56:59]
v_fma_f32 v105, v73, v124, v105
v_fma_f32 v106, v74, v124, v106
v_mfma_f32_16x16x32_bf16 v[60:63], a[172:175], v[208:211], v[60:63]
v_fma_f32 v107, v75, v124, v107
v_fma_f32 v108, v76, v124, v108
s_waitcnt vmcnt(2)
v_mfma_f32_16x16x32_bf16 v[48:51], a[176:179], v[212:215], v[48:51]
v_fma_f32 v109, v77, v124, v109
v_mfma_f32_16x16x32_bf16 v[52:55], a[180:183], v[212:215], v[52:55]
v_fma_f32 v110, v78, v124, v110
v_fma_f32 v111, v79, v124, v111
v_mfma_f32_16x16x32_bf16 v[56:59], a[184:187], v[212:215], v[56:59]
s_waitcnt lgkmcnt(0)
v_fma_f32 v96, v80, v124, v96
v_mfma_f32_16x16x32_bf16 v[60:63], a[188:191], v[212:215], v[60:63]
v_fma_f32 v97, v81, v124, v97
v_fma_f32 v98, v82, v124, v98
s_waitcnt vmcnt(1)
v_mfma_f32_16x16x32_bf16 v[48:51], a[192:195], v[216:219], v[48:51]
v_fma_f32 v99, v83, v124, v99
v_mfma_f32_16x16x32_bf16 v[52:55], a[196:199], v[216:219], v[52:55]
v_fma_f32 v100, v84, v124, v100
v_fma_f32 v101, v85, v124, v101
v_mfma_f32_16x16x32_bf16 v[56:59], a[200:203], v[216:219], v[56:59]
v_fma_f32 v102, v86, v124, v102
v_fma_f32 v103, v87, v124, v103
v_mfma_f32_16x16x32_bf16 v[60:63], a[204:207], v[216:219], v[60:63]
v_fma_f32 v104, v88, v124, v104
v_fma_f32 v105, v89, v124, v105
s_waitcnt vmcnt(0)
v_mfma_f32_16x16x32_bf16 v[48:51], a[208:211], v[220:223], v[48:51]
v_fma_f32 v106, v90, v124, v106
v_mfma_f32_16x16x32_bf16 v[52:55], a[212:215], v[220:223], v[52:55]
v_fma_f32 v107, v91, v124, v107
v_fma_f32 v108, v92, v124, v108
v_mfma_f32_16x16x32_bf16 v[56:59], a[216:219], v[220:223], v[56:59]
v_fma_f32 v109, v93, v124, v109
v_fma_f32 v110, v94, v124, v110
v_mfma_f32_16x16x32_bf16 v[60:63], a[220:223], v[220:223], v[60:63]
v_fma_f32 v111, v95, v124, v111
v_pk_fma_f32 v[48:49], v[48:49], v[124:125], v[96:97] op_sel_hi:[1,0,1]
v_pk_fma_f32 v[50:51], v[50:51], v[124:125], v[98:99] op_sel_hi:[1,0,1]
v_pk_fma_f32 v[52:53], v[52:53], v[124:125], v[100:101] op_sel_hi:[1,0,1]
v_pk_fma_f32 v[54:55], v[54:55], v[124:125], v[102:103] op_sel_hi:[1,0,1]
v_pk_fma_f32 v[56:57], v[56:57], v[124:125], v[104:105] op_sel_hi:[1,0,1]
v_pk_fma_f32 v[58:59], v[58:59], v[124:125], v[106:107] op_sel_hi:[1,0,1]
s_nop 0
v_pk_fma_f32 v[60:61], v[60:61], v[124:125], v[108:109] op_sel_hi:[1,0,1]
v_pk_fma_f32 v[62:63], v[62:63], v[124:125], v[110:111] op_sel_hi:[1,0,1]
v_cvt_pk_bf16_f32 v116, v48, v49
v_cvt_pk_bf16_f32 v117, v50, v51
v_cvt_pk_bf16_f32 v118, v52, v53
v_cvt_pk_bf16_f32 v119, v54, v55
v_cvt_pk_bf16_f32 v120, v56, v57
v_cvt_pk_bf16_f32 v121, v58, v59
v_cvt_pk_bf16_f32 v122, v60, v61
v_cvt_pk_bf16_f32 v123, v62, v63
v_permlane32_swap_b32 v116, v118
v_permlane32_swap_b32 v117, v119
v_permlane32_swap_b32 v120, v122
v_permlane32_swap_b32 v121, v123
v_permlane16_swap_b32 v116, v118
v_permlane16_swap_b32 v117, v119
v_permlane16_swap_b32 v120, v122
v_permlane16_swap_b32 v121, v123
buffer_store_dwordx4 v[116:119], v115, s[32:35], s40 offen offset:0 sc1
buffer_store_dwordx4 v[120:123], v115, s[32:35], s40 offen offset:64 sc1
Lfin:
Lend:
s_endpgm
Li14:
s_lshl_b32 s55, s46, 8
v_lshl_add_u32 v26, v1, 2, s55
v_cmp_gt_u32 vcc, 896, v26
v_bfrev_b32 v27, 1
s_nop 0
v_cndmask_b32_e64 v26, v27, v26, vcc
s_mul_i32 s54, s45, 12544
s_add_u32 s55, s54, 7864320
buffer_load_dword v112, v26, s[24:27], s55 offen offset:0 sc1
buffer_load_dword v113, v26, s[24:27], s55 offen offset:896 sc1
buffer_load_dword v114, v26, s[24:27], s55 offen offset:1792 sc1
buffer_load_dword v115, v26, s[24:27], s55 offen offset:2688 sc1
s_add_u32 s55, s54, 7867904
buffer_load_dword v116, v26, s[24:27], s55 offen offset:0 sc1
buffer_load_dword v117, v26, s[24:27], s55 offen offset:896 sc1
buffer_load_dword v118, v26, s[24:27], s55 offen offset:1792 sc1
buffer_load_dword v119, v26, s[24:27], s55 offen offset:2688 sc1
s_add_u32 s55, s54, 7871488
buffer_load_dword v120, v26, s[24:27], s55 offen offset:0 sc1
buffer_load_dword v121, v26, s[24:27], s55 offen offset:896 sc1
buffer_load_dword v122, v26, s[24:27], s55 offen offset:1792 sc1
buffer_load_dword v123, v26, s[24:27], s55 offen offset:2688 sc1
s_add_u32 s55, s54, 7875072
buffer_load_dword v124, v26, s[24:27], s55 offen offset:0 sc1
buffer_load_dword v125, v26, s[24:27], s55 offen offset:896 sc1
s_waitcnt vmcnt(0)
v_add_f32 v112, v112, v113
v_add_f32 v112, v112, v114
v_add_f32 v112, v112, v115
v_add_f32 v112, v112, v116
v_add_f32 v112, v112, v117
v_add_f32 v112, v112, v118
v_add_f32 v112, v112, v119
v_add_f32 v112, v112, v120
v_add_f32 v112, v112, v121
v_add_f32 v112, v112, v122
v_add_f32 v112, v112, v123
v_add_f32 v112, v112, v124
v_add_f32 v112, v112, v125
s_lshl_b32 s55, s46, 8
s_add_u32 s55, s55, 160256
v_lshl_add_u32 v26, v1, 2, s55
ds_write_b32 v26, v112
s_add_u32 m0, s4, 28672
s_add_u32 s11, s10, 0
buffer_load_dwordx4 v2, s[24:27], s11 offen offset:0 sc1 lds
buffer_load_dwordx4 v2, s[24:27], s11 offen offset:1024 sc1 lds
buffer_load_dwordx4 v2, s[24:27], s11 offen offset:2048 sc1 lds
buffer_load_dwordx4 v2, s[24:27], s11 offen offset:3072 sc1 lds
s_add_u32 m0, s4, 32768
s_add_u32 s11, s10, 4096
buffer_load_dwordx4 v2, s[24:27], s11 offen offset:0 sc1 lds
buffer_load_dwordx4 v2, s[24:27], s11 offen offset:1024 sc1 lds
buffer_load_dwordx4 v2, s[24:27], s11 offen offset:2048 sc1 lds
s_add_u32 m0, s4, 57344
s_add_u32 s11, s10, 28672
buffer_load_dwordx4 v2, s[24:27], s11 offen offset:0 sc1 lds
buffer_load_dwordx4 v2, s[24:27], s11 offen offset:1024 sc1 lds
buffer_load_dwordx4 v2, s[24:27], s11 offen offset:2048 sc1 lds
buffer_load_dwordx4 v2, s[24:27], s11 offen offset:3072 sc1 lds
s_add_u32 m0, s4, 61440
s_add_u32 s11, s10, 32768
buffer_load_dwordx4 v2, s[24:27], s11 offen offset:0 sc1 lds
buffer_load_dwordx4 v2, s[24:27], s11 offen offset:1024 sc1 lds
buffer_load_dwordx4 v2, s[24:27], s11 offen offset:2048 sc1 lds
s_waitcnt vmcnt(0) lgkmcnt(0)
s_branch Lj16
Li32:
s_add_u32 m0, s4, 0
s_add_u32 s11, s7, 0
buffer_load_dwordx4 v2, s[24:27], s11 offen offset:0 sc1 lds
buffer_load_dwordx4 v2, s[24:27], s11 offen offset:1024 sc1 lds
buffer_load_dwordx4 v2, s[24:27], s11 offen offset:2048 sc1 lds
buffer_load_dwordx4 v2, s[24:27], s11 offen offset:3072 sc1 lds
s_add_u32 m0, s4, 4096
s_add_u32 s11, s7, 4096
buffer_load_dwordx4 v2, s[24:27], s11 offen offset:0 sc1 lds
buffer_load_dwordx4 v2, s[24:27], s11 offen offset:1024 sc1 lds
buffer_load_dwordx4 v2, s[24:27], s11 offen offset:2048 sc1 lds
s_add_u32 m0, s4, 28672
s_add_u32 s11, s7, 28672
buffer_load_dwordx4 v2, s[24:27], s11 offen offset:0 sc1 lds
buffer_load_dwordx4 v2, s[24:27], s11 offen offset:1024 sc1 lds
buffer_load_dwordx4 v2, s[24:27], s11 offen offset:2048 sc1 lds
buffer_load_dwordx4 v2, s[24:27], s11 offen offset:3072 sc1 lds
s_add_u32 m0, s4, 32768
s_add_u32 s11, s7, 32768
buffer_load_dwordx4 v2, s[24:27], s11 offen offset:0 sc1 lds
buffer_load_dwordx4 v2, s[24:27], s11 offen offset:1024 sc1 lds
buffer_load_dwordx4 v2, s[24:27], s11 offen offset:2048 sc1 lds
s_add_u32 m0, s4, 57344
s_add_u32 s11, s7, 57344
buffer_load_dwordx4 v2, s[24:27], s11 offen offset:0 sc1 lds
buffer_load_dwordx4 v2, s[24:27], s11 offen offset:1024 sc1 lds
buffer_load_dwordx4 v2, s[24:27], s11 offen offset:2048 sc1 lds
buffer_load_dwordx4 v2, s[24:27], s11 offen offset:3072 sc1 lds
s_add_u32 m0, s4, 61440
s_add_u32 s11, s7, 61440
buffer_load_dwordx4 v2, s[24:27], s11 offen offset:0 sc1 lds
buffer_load_dwordx4 v2, s[24:27], s11 offen offset:1024 sc1 lds
buffer_load_dwordx4 v2, s[24:27], s11 offen offset:2048 sc1 lds
s_waitcnt vmcnt(0) lgkmcnt(0)
s_branch Lj35
Li57:
s_add_u32 m0, s4, 57344
s_add_u32 s11, s10, 114688
buffer_load_dwordx4 v2, s[24:27], s11 offen offset:0 sc1 lds
buffer_load_dwordx4 v2, s[24:27], s11 offen offset:1024 sc1 lds
buffer_load_dwordx4 v2, s[24:27], s11 offen offset:2048 sc1 lds
buffer_load_dwordx4 v2, s[24:27], s11 offen offset:3072 sc1 lds
s_and_b32 s54, s44, 1
s_lshl1_add_u32 s54, s54, s45
s_sub_u32 s54, s54, 14
s_lshl2_add_u32 s54, s54, s46
s_mul_i32 s54, s54, 200704
v_lshlrev_b32 v30, 7, v1
v_min_u32 v31, 31, v1
v_lshlrev_b32_e64 v31, 7, v31
s_add_u32 s55, s54, 2969600
buffer_load_dword v16, v30, s[24:27], s55 offen sc1
s_add_u32 s55, s54, 2977792
buffer_load_dword v16, v30, s[24:27], s55 offen sc1
s_add_u32 s55, s54, 2985984
buffer_load_dword v16, v30, s[24:27], s55 offen sc1
s_add_u32 s55, s54, 2994176
buffer_load_dword v16, v31, s[24:27], s55 offen sc1
s_waitcnt vmcnt(0) lgkmcnt(0)
s_branch Lj59
Lcode_end:
.section .rodata,"a"
.p2align 6
.amdhsa_kernel interleave_layers__sliding_local_dilated__glu_gated_swiglu__prompt_kernel
  .amdhsa_next_free_vgpr 512
  .amdhsa_next_free_sgpr 102
  .amdhsa_accum_offset 256
  .amdhsa_group_segment_fixed_size 0
  .amdhsa_kernarg_size 80
  .amdhsa_user_sgpr_count 2
  .amdhsa_user_sgpr_kernarg_segment_ptr 1
  .amdhsa_system_sgpr_workgroup_id_x 1
  .amdhsa_float_denorm_mode_32 3
.end_amdhsa_kernel
```
